```python
import torch

def _softmax(x, axis=-1):
    return torch.softmax(x, dim=axis)

def _gelu(x):
    return torch.nn.functional.gelu(x, approximate='tanh')

def _silu(x):
    return torch.nn.functional.silu(x)

def _sigmoid(x):
    return torch.sigmoid(x)

def _layernorm(x, axis=-1, eps=1e-05):
    m = x.mean(dim=axis, keepdim=True)
    v = x.var(dim=axis, keepdim=True, unbiased=False)
    return (x - m) / torch.sqrt(v + eps)

def _scatter_add(tgt, idx, src, axis=0):
    return tgt.clone().index_add_(axis, idx, src)

def _segment_sum(src, seg, n):
    out = torch.zeros((n,) + src.shape[1:], dtype=src.dtype)
    return out.index_add_(0, seg, src)

def _pad(x, pw):
    flat = tuple((v for pair in reversed(pw) for v in pair))
    return torch.nn.functional.pad(x, flat)
kernel_name = 'adaLN_cond__ssm_conv_h3__glu_gated_bilinear__prompt'

def setup_inputs():

    _w = lambda a: (lambda t: t.to(torch.bfloat16) if t.is_floating_point() else t)(torch.as_tensor(a))

    def _A_setup():
        B, S, D = (1, 2048, 640)
        ks = 4
        return {'q': _w((lambda *s: torch.randn(*s, dtype=torch.bfloat16) * 0.05)(B, S, D)), 'k': _w((lambda *s: torch.randn(*s, dtype=torch.bfloat16) * 1.6)(B, S, D)), 'v': _w((lambda *s: torch.randn(*s, dtype=torch.bfloat16) * 1.6)(B, S, D)), 'shift_k': _w((lambda *s: torch.randn(*s, dtype=torch.bfloat16) * 1.6)(D, ks) * 0.5), 'ssm_k': _w((lambda *s: torch.randn(*s, dtype=torch.bfloat16) * 1.6)(D, S) * (1.0 / S ** 0.5)), 'ssm_D': _w((lambda *s: torch.randn(*s, dtype=torch.bfloat16) * 1.6)(D))}
    _A_in = _A_setup()

    def _B_setup():
        B, S, D, F = (1, 2048, 640, 1728)
        return {'x': _w((lambda *s: torch.randn(*s, dtype=torch.bfloat16) * 0.05)(B, S, D)), 'w_gate': _w((lambda *s: torch.randn(*s, dtype=torch.bfloat16) * 3.2)(D, F) * D ** (-0.5)), 'w_up': _w((lambda *s: torch.randn(*s, dtype=torch.bfloat16) * 3.2)(D, F) * D ** (-0.5)), 'w_down': _w((lambda *s: torch.randn(*s, dtype=torch.bfloat16) * 3.2)(F, D) * F ** (-0.5))}
    _B_in = _B_setup()
    return {'A_q': _A_in['q'], 'A_k': _A_in['k'], 'A_v': _A_in['v'], 'A_shift_k': _A_in['shift_k'], 'A_ssm_k': _A_in['ssm_k'], 'A_ssm_D': _A_in['ssm_D'], 'B_x': _B_in['x'], 'B_w_gate': _B_in['w_gate'], 'B_w_up': _B_in['w_up'], 'B_w_down': _B_in['w_down'], 'c': _w((lambda *s: torch.randn(*s, dtype=torch.bfloat16) * 0.1)(1, 640) * 8.0), 'w_mod': _w((lambda *s: torch.randn(*s, dtype=torch.bfloat16) * 0.1)(640, 6 * 640) * 640 ** (-0.5) * 8.0)}

def reference(A_q, A_k, A_v, A_shift_k, A_ssm_k, A_ssm_D, B_x, B_w_gate, B_w_up, B_w_down, c, w_mod):

    def _A_ref(q, k, v, shift_k, ssm_k, ssm_D):
        B, S, D = q.shape
        ks = shift_k.shape[-1]
        k_pad = _pad(k, ((0, 0), (ks - 1, 0), (0, 0)))
        k_shift = torch.zeros_like(k)
        for t in range(ks):
            k_shift = k_shift + k_pad[:, t:t + S, :] * shift_k[:, ks - 1 - t][None, None, :]
        kv = k_shift * v
        L = 2 * S
        kv_pad = _pad(kv, ((0, 0), (0, S), (0, 0)))
        kf_pad = _pad(ssm_k, ((0, 0), (0, S)))
        kv_f = (lambda x, axes=(-2, -1): torch.fft.rfft2(x.float(), dim=axes))(kv_pad[:, None, :, :], axes=(1, 2))
        kf_f = (lambda x, axes=(-2, -1): torch.fft.rfft2(x.float(), dim=axes))(kf_pad[:, None, :], axes=(1, 2))
        kf_f = (lambda x, *d: x.permute(*d))(kf_f, 1, 2, 0)
        y_f = kv_f * kf_f[None, :, :, :]
        y = (lambda x, s, axes=(-2, -1): torch.fft.irfft2(x, s=s, dim=axes).to(torch.bfloat16))(y_f, (1, L), axes=(1, 2))[:, 0, :S, :]
        y = y + kv * ssm_D[None, None, :]
        return q * y

    def _B_ref(x, w_gate, w_up, w_down):
        g = torch.einsum('bsd,df->bsf', x, w_gate)
        u = torch.einsum('bsd,df->bsf', x, w_up)
        h = g * u
        return torch.einsum('bsf,fd->bsd', h, w_down)
    x = A_q
    mod = (_silu(c) @ w_mod).reshape(c.shape[0], 6, 1, -1)
    sa, ca, ga, sb, cb, gb = (mod[:, 0].clone(), mod[:, 1].clone(), mod[:, 2].clone(), mod[:, 3].clone(), mod[:, 4].clone(), mod[:, 5].clone())
    h = _layernorm(x, axis=-1) * (1 + ca) + sa
    x = x + ga * _A_ref(h, A_k, A_v, A_shift_k, A_ssm_k, A_ssm_D)
    h = _layernorm(x, axis=-1) * (1 + cb) + sb
    x = x + gb * _B_ref(h, B_w_gate, B_w_up, B_w_down)
    return x
```

```asm
; @launch grid=(256,1,1) block=(256,1,1) lds=163840
.amdgcn_target "amdgcn-amd-amdhsa--gfx950"
.text
.globl adaLN_cond__ssm_conv_h3__glu_gated_bilinear__prompt_kernel
.p2align 8
.type adaLN_cond__ssm_conv_h3__glu_gated_bilinear__prompt_kernel,@function
adaLN_cond__ssm_conv_h3__glu_gated_bilinear__prompt_kernel:
    s_cmp_ge_u32 s2, 256
    s_cbranch_scc1 L_end
    s_load_dwordx16 s[36:51], s[0:1], 0
    s_load_dwordx8 s[52:59], s[0:1], 64
    s_load_dwordx4 s[60:63], s[0:1], 96
    s_load_dwordx2 s[64:65], s[0:1], 112
    v_lshrrev_b32 v2, 6, v0
    v_and_b32 v1, 63, v0
    s_and_b32 s5, s2, 7
    s_lshr_b32 s6, s2, 3
    v_readfirstlane_b32 s4, v2
    v_lshlrev_b32 v4, 4, v1
    s_lshr_b32 s11, s6, 2
    s_and_b32 s3, s6, 3
    s_lshr_b32 s10, s5, 2
    s_lshl_b32 s10, s10, 3
    s_add_u32 s66, s10, s11
    s_and_b32 s10, s5, 3
    s_lshl_b32 s10, s10, 2
    s_add_u32 s67, s10, s3
    s_lshr_b32 s10, s5, 1
    s_lshl_b32 s10, s10, 3
    s_add_u32 s68, s10, s11
    s_and_b32 s10, s5, 1
    s_lshl_b32 s10, s10, 2
    s_add_u32 s69, s10, s3
    s_nop 0
    s_nop 0
    s_nop 0
    s_mul_i32 s7, s5, 20
    s_add_u32 s7, s7, s6
    s_lshr_b32 s70, s7, 4
    s_and_b32 s71, s7, 15
    s_lshl_b32 s71, s71, 7
    s_lshl_b32 s72, s4, 5
    s_add_u32 s71, s71, s72
    v_lshrrev_b32 v2, 3, v1
    v_and_b32 v3, 7, v1
    v_mul_u32_u24 v10, 1280, v2
    s_mul_i32 s72, s71, 1280
    s_lshl_b32 s73, s70, 7
    s_add_u32 s72, s72, s73
    v_add_u32 v10, s72, v10
    v_lshl_add_u32 v5, v3, 4, v10
    v_subrev_u32 v6, 10240, v5
    s_mul_i32 s76, s4, 9216
    s_add_u32 m0, s76, 84992
    s_add_u32 s76, s76, 84992
    s_waitcnt lgkmcnt(0)
    s_mov_b32 s12, s64
    s_and_b32 s13, s65, 0xffff
    s_mov_b32 s14, 36700160
    s_mov_b32 s15, 0x20000
    buffer_load_dword v243, off, s[12:15], 0 sc1
    s_cmp_ge_u32 s6, 20
    s_cbranch_scc1 L_side
    s_mov_b32 s16, s38
    s_and_b32 s17, s39, 0xffff
    s_mov_b32 s18, 2621440
    s_mov_b32 s19, 0x20000
    buffer_load_dwordx4 v6, s[16:19], 0 offen nt lds
    s_mov_b32 s20, s40
    s_and_b32 s21, s41, 0xffff
    s_mov_b32 s22, 2621440
    s_mov_b32 s23, 0x20000
    s_movk_i32 s73, 10240
    s_movk_i32 s74, 20480
    s_movk_i32 s75, 30720
    s_add_u32 m0, s76, 1024
    s_nop 0
    buffer_load_dwordx4 v5, s[16:19], 0 offen nt lds
    s_add_u32 m0, s76, 2048
    s_nop 0
    buffer_load_dwordx4 v5, s[16:19], s73 offen nt lds
    s_add_u32 m0, s76, 3072
    s_nop 0
    buffer_load_dwordx4 v5, s[16:19], s74 offen nt lds
    s_add_u32 m0, s76, 4096
    s_nop 0
    buffer_load_dwordx4 v5, s[16:19], s75 offen nt lds
    s_add_u32 m0, s76, 5120
    s_nop 0
    buffer_load_dwordx4 v5, s[20:23], 0 offen nt lds
    s_add_u32 m0, s76, 6144
    s_nop 0
    buffer_load_dwordx4 v5, s[20:23], s73 offen nt lds
    s_add_u32 m0, s76, 7168
    s_nop 0
    buffer_load_dwordx4 v5, s[20:23], s74 offen nt lds
    s_add_u32 m0, s76, 8192
    s_nop 0
    buffer_load_dwordx4 v5, s[20:23], s75 offen nt lds
    s_mov_b32 s24, s42
    s_and_b32 s25, s43, 0xffff
    s_mov_b32 s26, 5120
    s_mov_b32 s27, 0x20000
    v_lshrrev_b32 v11, 4, v1
    v_and_b32 v12, 15, v1
    s_lshl_b32 s10, s70, 9
    v_lshl_add_u32 v7, v12, 5, s10
    buffer_load_dwordx4 v[48:51], v7, s[24:27], 0 offen
    buffer_load_dwordx4 v[52:55], v7, s[24:27], 0 offen offset:16
    s_lshl_b32 s78, s7, 2
    s_add_u32 s78, s78, s4
    s_lshl_b32 s79, s78, 12
    v_lshlrev_b32 v8, 10, v11
    v_lshl_add_u32 v8, v12, 3, v8
    v_add_u32 v8, s76, v8
    s_mul_i32 s76, s4, 16640
    s_mul_i32 s77, s4, 4608
    s_add_u32 s77, s77, 66560
    v_add_u32 v9, 4, v4
    s_add_u32 s32, s44, s79
    s_addc_u32 s33, s45, 0
    s_and_b32 s33, s33, 0xffff
    s_mov_b32 s34, 4096
    s_mov_b32 s35, 0x20000
    s_mul_i32 s79, s78, 4352
    s_mov_b32 s28, s36
    s_and_b32 s29, s37, 0xffff
    s_mov_b32 s30, 2621440
    s_mov_b32 s31, 0x20000
    v_bfe_u32 v13, v2, 1, 1
    v_xor_b32 v13, v13, v3
    s_and_b32 s10, s4, 1
    s_lshl_b32 s10, s10, 2
    v_xor_b32 v13, s10, v13
    v_lshl_add_u32 v160, v13, 4, v10
    v_xor_b32 v13, 2, v13
    v_lshl_add_u32 v161, v13, 4, v10
    s_nop 0
    s_lshl_b32 s72, s4, 12
    s_add_u32 s72, s72, 121856
    s_movk_i32 s97, 10240
    s_movk_i32 s98, 20480
    s_movk_i32 s99, 30720
    s_mul_i32 s10, s7, 3
    s_add_u32 s10, s10, s4
    s_sub_u32 s96, s10, 1
    s_cmp_eq_u32 s4, 0
    s_cbranch_scc1 L_wf_a
    s_mov_b32 s20, s50
    s_and_b32 s21, s51, 0xffff
    s_mov_b32 s22, 2211840
    s_mov_b32 s23, 0x20000
    s_mov_b32 s24, s52
    s_and_b32 s25, s53, 0xffff
    s_mov_b32 s26, 2211840
    s_mov_b32 s27, 0x20000
    s_mul_hi_u32 s11, s96, 214748365
    s_mul_i32 s101, s11, 20
    s_sub_u32 s101, s96, s101
    s_mul_i32 s3, s101, 110592
    s_lshl_b32 s10, s11, 7
    s_add_u32 s3, s3, s10
    s_mul_i32 s11, s11, 163840
    s_lshl_b32 s101, s101, 10
    s_add_u32 s73, s11, s101
    s_add_u32 s73, s73, 17825792
    v_mul_u32_u24 v162, 13824, v2
    v_lshl_add_u32 v162, v3, 4, v162
    buffer_load_dwordx4 v[164:167], v162, s[20:23], s3 offen nt
    buffer_load_dwordx4 v[180:183], v162, s[24:27], s3 offen nt
    s_add_u32 s3, s3, 3456
    buffer_load_dwordx4 v[168:171], v162, s[20:23], s3 offen nt
    buffer_load_dwordx4 v[184:187], v162, s[24:27], s3 offen nt
    s_add_u32 s3, s3, 3456
    buffer_load_dwordx4 v[172:175], v162, s[20:23], s3 offen nt
    buffer_load_dwordx4 v[188:191], v162, s[24:27], s3 offen nt
    s_add_u32 s3, s3, 3456
    buffer_load_dwordx4 v[176:179], v162, s[20:23], s3 offen nt
    buffer_load_dwordx4 v[192:195], v162, s[24:27], s3 offen nt
L_wf_a:
    s_getpc_b64 s[100:101]
L_pc_1:
    s_lshl_b32 s3, s6, 2
    s_add_u32 s3, s3, s4
    s_lshl_b32 s3, s3, 10
    s_cmp_gt_u32 s3, (L_end-L_pc_1)-1024
    s_cselect_b32 s3, 0, s3
    v_add_u32 v252, s3, v4
    global_load_dwordx4 v[252:255], v252, s[100:101]
    s_mul_i32 s11, s70, 278528
    s_add_u32 s11, s11, 1052656
    s_lshl_b32 s10, s71, 1
    s_sub_u32 s11, s11, s10
    v_mul_u32_u24 v5, 17408, v12
    v_add_u32 v5, s11, v5
    v_lshlrev_b32 v6, 4, v11
    v_sub_u32 v5, v5, v6
    v_mov_b32 v244, 0
    v_mov_b32 v245, 0
    v_mov_b32 v246, 0
    v_mov_b32 v247, 0
    v_and_b32 v248, 31, v1
    v_lshl_add_u32 v248, v248, 4, s77
    ds_write_b128 v248, v[244:247] offset:4096
    v_and_b32 v249, 1, v1
    v_bfe_u32 v250, v1, 1, 2
    v_mul_u32_u24 v250, 4160, v250
    v_lshl_add_u32 v249, v249, 4, v250
    v_add_u32 v249, s76, v249
    ds_write_b128 v249, v[244:247]
    s_mov_b32 s74, 0x05040100
    s_mov_b32 s75, 0x07060302
    s_cmp_eq_u32 s4, 0
    s_cbranch_scc1 L_kv0
    s_waitcnt vmcnt(9)
    s_branch L_kv1
L_kv0:
    s_waitcnt vmcnt(1)
L_kv1:
    ds_read_b64 v[10:11], v8 offset:640
    ds_read_b64 v[12:13], v8 offset:768
    ds_read_b64 v[14:15], v8 offset:896
    ds_read_b64 v[16:17], v8 offset:1024
    ds_read_b64 v[18:19], v8 offset:1152
    ds_read_b64 v[20:21], v8 offset:1280
    ds_read_b64 v[22:23], v8 offset:1408
    ds_read_b64 v[24:25], v8 offset:1536
    ds_read_b64 v[26:27], v8 offset:1664
    ds_read_b64 v[28:29], v8 offset:1792
    ds_read_b64 v[30:31], v8 offset:1920
    ds_read_b64 v[32:33], v8 offset:5120
    ds_read_b64 v[34:35], v8 offset:5248
    ds_read_b64 v[36:37], v8 offset:5376
    ds_read_b64 v[38:39], v8 offset:5504
    ds_read_b64 v[40:41], v8 offset:5632
    ds_read_b64 v[42:43], v8 offset:5760
    ds_read_b64 v[44:45], v8 offset:5888
    ds_read_b64 v[46:47], v8 offset:6016
    v_readfirstlane_b32 s8, v243
    s_mul_i32 s8, s8, 0x9e3779b1
    s_add_u32 s8, s8, 0x7f4a7c15
    s_not_b32 s9, s8
    s_waitcnt lgkmcnt(15)
    v_perm_b32 v56, v10, v12, s74
    v_perm_b32 v57, v10, v12, s75
    v_perm_b32 v58, v11, v13, s74
    v_perm_b32 v59, v11, v13, s75
    v_perm_b32 v60, v12, v14, s74
    v_perm_b32 v61, v12, v14, s75
    v_perm_b32 v62, v13, v15, s74
    v_perm_b32 v63, v13, v15, s75
    v_perm_b32 v64, v14, v16, s74
    v_perm_b32 v65, v14, v16, s75
    v_perm_b32 v66, v15, v17, s74
    v_perm_b32 v67, v15, v17, s75
    s_waitcnt lgkmcnt(12)
    v_perm_b32 v68, v16, v18, s74
    v_perm_b32 v69, v16, v18, s75
    v_perm_b32 v70, v17, v19, s74
    v_perm_b32 v71, v17, v19, s75
    v_perm_b32 v72, v18, v20, s74
    v_perm_b32 v73, v18, v20, s75
    v_perm_b32 v74, v19, v21, s74
    v_perm_b32 v75, v19, v21, s75
    v_perm_b32 v76, v20, v22, s74
    v_perm_b32 v77, v20, v22, s75
    v_perm_b32 v78, v21, v23, s74
    v_perm_b32 v79, v21, v23, s75
    s_waitcnt lgkmcnt(8)
    v_perm_b32 v80, v22, v24, s74
    v_perm_b32 v81, v22, v24, s75
    v_perm_b32 v82, v23, v25, s74
    v_perm_b32 v83, v23, v25, s75
    v_perm_b32 v84, v24, v26, s74
    v_perm_b32 v85, v24, v26, s75
    v_perm_b32 v86, v25, v27, s74
    v_perm_b32 v87, v25, v27, s75
    v_perm_b32 v88, v26, v28, s74
    v_perm_b32 v89, v26, v28, s75
    v_perm_b32 v90, v27, v29, s74
    v_perm_b32 v91, v27, v29, s75
    v_perm_b32 v92, v28, v30, s74
    v_perm_b32 v93, v28, v30, s75
    v_perm_b32 v94, v29, v31, s74
    v_perm_b32 v95, v29, v31, s75
    s_waitcnt lgkmcnt(0)
    v_dot2_f32_bf16 v96, v64, v48, 0
    v_dot2_f32_bf16 v97, v65, v50, 0
    v_dot2_f32_bf16 v98, v66, v52, 0
    v_dot2_f32_bf16 v99, v67, v54, 0
    v_dot2_f32_bf16 v96, v56, v49, v96
    v_dot2_f32_bf16 v97, v57, v51, v97
    v_dot2_f32_bf16 v98, v58, v53, v98
    v_dot2_f32_bf16 v99, v59, v55, v99
    v_lshlrev_b32 v128, 16, v32
    v_and_b32 v129, 0xffff0000, v32
    v_lshlrev_b32 v130, 16, v33
    v_and_b32 v131, 0xffff0000, v33
    v_pk_mul_f32 v[96:97], v[96:97], v[128:129]
    v_pk_mul_f32 v[98:99], v[98:99], v[130:131]
    v_dot2_f32_bf16 v100, v68, v48, 0
    v_dot2_f32_bf16 v101, v69, v50, 0
    v_dot2_f32_bf16 v102, v70, v52, 0
    v_dot2_f32_bf16 v103, v71, v54, 0
    v_dot2_f32_bf16 v100, v60, v49, v100
    v_dot2_f32_bf16 v101, v61, v51, v101
    v_dot2_f32_bf16 v102, v62, v53, v102
    v_dot2_f32_bf16 v103, v63, v55, v103
    v_lshlrev_b32 v132, 16, v34
    v_and_b32 v133, 0xffff0000, v34
    v_lshlrev_b32 v134, 16, v35
    v_and_b32 v135, 0xffff0000, v35
    v_pk_mul_f32 v[100:101], v[100:101], v[132:133]
    v_pk_mul_f32 v[102:103], v[102:103], v[134:135]
    v_dot2_f32_bf16 v104, v72, v48, 0
    v_dot2_f32_bf16 v105, v73, v50, 0
    v_dot2_f32_bf16 v106, v74, v52, 0
    v_dot2_f32_bf16 v107, v75, v54, 0
    v_dot2_f32_bf16 v104, v64, v49, v104
    v_dot2_f32_bf16 v105, v65, v51, v105
    v_dot2_f32_bf16 v106, v66, v53, v106
    v_dot2_f32_bf16 v107, v67, v55, v107
    v_lshlrev_b32 v136, 16, v36
    v_and_b32 v137, 0xffff0000, v36
    v_lshlrev_b32 v138, 16, v37
    v_and_b32 v139, 0xffff0000, v37
    v_pk_mul_f32 v[104:105], v[104:105], v[136:137]
    v_pk_mul_f32 v[106:107], v[106:107], v[138:139]
    v_dot2_f32_bf16 v108, v76, v48, 0
    v_dot2_f32_bf16 v109, v77, v50, 0
    v_dot2_f32_bf16 v110, v78, v52, 0
    v_dot2_f32_bf16 v111, v79, v54, 0
    v_dot2_f32_bf16 v108, v68, v49, v108
    v_dot2_f32_bf16 v109, v69, v51, v109
    v_dot2_f32_bf16 v110, v70, v53, v110
    v_dot2_f32_bf16 v111, v71, v55, v111
    v_lshlrev_b32 v140, 16, v38
    v_and_b32 v141, 0xffff0000, v38
    v_lshlrev_b32 v142, 16, v39
    v_and_b32 v143, 0xffff0000, v39
    v_pk_mul_f32 v[108:109], v[108:109], v[140:141]
    v_pk_mul_f32 v[110:111], v[110:111], v[142:143]
    v_dot2_f32_bf16 v112, v80, v48, 0
    v_dot2_f32_bf16 v113, v81, v50, 0
    v_dot2_f32_bf16 v114, v82, v52, 0
    v_dot2_f32_bf16 v115, v83, v54, 0
    v_dot2_f32_bf16 v112, v72, v49, v112
    v_dot2_f32_bf16 v113, v73, v51, v113
    v_dot2_f32_bf16 v114, v74, v53, v114
    v_dot2_f32_bf16 v115, v75, v55, v115
    v_lshlrev_b32 v144, 16, v40
    v_and_b32 v145, 0xffff0000, v40
    v_lshlrev_b32 v146, 16, v41
    v_and_b32 v147, 0xffff0000, v41
    v_pk_mul_f32 v[112:113], v[112:113], v[144:145]
    v_pk_mul_f32 v[114:115], v[114:115], v[146:147]
    v_dot2_f32_bf16 v116, v84, v48, 0
    v_dot2_f32_bf16 v117, v85, v50, 0
    v_dot2_f32_bf16 v118, v86, v52, 0
    v_dot2_f32_bf16 v119, v87, v54, 0
    v_dot2_f32_bf16 v116, v76, v49, v116
    v_dot2_f32_bf16 v117, v77, v51, v117
    v_dot2_f32_bf16 v118, v78, v53, v118
    v_dot2_f32_bf16 v119, v79, v55, v119
    v_lshlrev_b32 v148, 16, v42
    v_and_b32 v149, 0xffff0000, v42
    v_lshlrev_b32 v150, 16, v43
    v_and_b32 v151, 0xffff0000, v43
    v_pk_mul_f32 v[116:117], v[116:117], v[148:149]
    v_pk_mul_f32 v[118:119], v[118:119], v[150:151]
    v_dot2_f32_bf16 v120, v88, v48, 0
    v_dot2_f32_bf16 v121, v89, v50, 0
    v_dot2_f32_bf16 v122, v90, v52, 0
    v_dot2_f32_bf16 v123, v91, v54, 0
    v_dot2_f32_bf16 v120, v80, v49, v120
    v_dot2_f32_bf16 v121, v81, v51, v121
    v_dot2_f32_bf16 v122, v82, v53, v122
    v_dot2_f32_bf16 v123, v83, v55, v123
    v_lshlrev_b32 v152, 16, v44
    v_and_b32 v153, 0xffff0000, v44
    v_lshlrev_b32 v154, 16, v45
    v_and_b32 v155, 0xffff0000, v45
    v_pk_mul_f32 v[120:121], v[120:121], v[152:153]
    v_pk_mul_f32 v[122:123], v[122:123], v[154:155]
    v_dot2_f32_bf16 v124, v92, v48, 0
    v_dot2_f32_bf16 v125, v93, v50, 0
    v_dot2_f32_bf16 v126, v94, v52, 0
    v_dot2_f32_bf16 v127, v95, v54, 0
    v_dot2_f32_bf16 v124, v84, v49, v124
    v_dot2_f32_bf16 v125, v85, v51, v125
    v_dot2_f32_bf16 v126, v86, v53, v126
    v_dot2_f32_bf16 v127, v87, v55, v127
    v_lshlrev_b32 v156, 16, v46
    v_and_b32 v157, 0xffff0000, v46
    v_lshlrev_b32 v158, 16, v47
    v_and_b32 v159, 0xffff0000, v47
    v_pk_mul_f32 v[124:125], v[124:125], v[156:157]
    v_pk_mul_f32 v[126:127], v[126:127], v[158:159]
    v_cvt_pk_bf16_f32 v10, v124, v120
    v_cvt_pk_bf16_f32 v11, v116, v112
    v_cvt_pk_bf16_f32 v12, v108, v104
    v_cvt_pk_bf16_f32 v13, v100, v96
    buffer_store_dwordx4 v[10:13], v5, s[12:15], 0 offen sc1
    v_cvt_pk_bf16_f32 v14, v125, v121
    v_cvt_pk_bf16_f32 v15, v117, v113
    v_cvt_pk_bf16_f32 v16, v109, v105
    v_cvt_pk_bf16_f32 v17, v101, v97
    s_movk_i32 s10, 4352
    buffer_store_dwordx4 v[14:17], v5, s[12:15], s10 offen sc1
    v_cvt_pk_bf16_f32 v18, v126, v122
    v_cvt_pk_bf16_f32 v19, v118, v114
    v_cvt_pk_bf16_f32 v20, v110, v106
    v_cvt_pk_bf16_f32 v21, v102, v98
    s_movk_i32 s10, 8704
    buffer_store_dwordx4 v[18:21], v5, s[12:15], s10 offen sc1
    v_cvt_pk_bf16_f32 v22, v127, v123
    v_cvt_pk_bf16_f32 v23, v119, v115
    v_cvt_pk_bf16_f32 v24, v111, v107
    v_cvt_pk_bf16_f32 v25, v103, v99
    s_movk_i32 s10, 13056
    buffer_store_dwordx4 v[22:25], v5, s[12:15], s10 offen sc1
    s_mov_b32 s100, s96
    s_cmp_eq_u32 s4, 0
    s_cbranch_scc1 L_wf_b
    s_mul_i32 s10, s4, 9216
    s_add_u32 s10, s10, 84992
    v_mul_u32_u24 v29, 1040, v3
    v_lshrrev_b32 v30, 1, v2
    v_lshl_add_u32 v29, v30, 8, v29
    v_and_b32 v30, 1, v2
    v_lshl_add_u32 v29, v30, 3, v29
    v_add_u32 v29, s10, v29
    v_add_u32 v30, s10, v4
    s_waitcnt vmcnt(5)
    v_perm_b32 v64, v168, v164, s74
    v_perm_b32 v65, v176, v172, s74
    ds_write_b64 v29, v[64:65] offset:0
    v_perm_b32 v66, v168, v164, s75
    v_perm_b32 v67, v176, v172, s75
    ds_write_b64 v29, v[66:67] offset:16
    v_perm_b32 v68, v169, v165, s74
    v_perm_b32 v69, v177, v173, s74
    ds_write_b64 v29, v[68:69] offset:64
    v_perm_b32 v70, v169, v165, s75
    v_perm_b32 v71, v177, v173, s75
    ds_write_b64 v29, v[70:71] offset:80
    v_perm_b32 v72, v170, v166, s74
    v_perm_b32 v73, v178, v174, s74
    ds_write_b64 v29, v[72:73] offset:128
    v_perm_b32 v74, v170, v166, s75
    v_perm_b32 v75, v178, v174, s75
    ds_write_b64 v29, v[74:75] offset:144
    v_perm_b32 v76, v171, v167, s74
    v_perm_b32 v77, v179, v175, s74
    ds_write_b64 v29, v[76:77] offset:192
    v_perm_b32 v78, v171, v167, s75
    v_perm_b32 v79, v179, v175, s75
    ds_write_b64 v29, v[78:79] offset:208
    v_perm_b32 v80, v184, v180, s74
    v_perm_b32 v81, v192, v188, s74
    ds_write_b64 v29, v[80:81] offset:32
    v_perm_b32 v82, v184, v180, s75
    v_perm_b32 v83, v192, v188, s75
    ds_write_b64 v29, v[82:83] offset:48
    v_perm_b32 v84, v185, v181, s74
    v_perm_b32 v85, v193, v189, s74
    ds_write_b64 v29, v[84:85] offset:96
    v_perm_b32 v86, v185, v181, s75
    v_perm_b32 v87, v193, v189, s75
    ds_write_b64 v29, v[86:87] offset:112
    v_perm_b32 v88, v186, v182, s74
    v_perm_b32 v89, v194, v190, s74
    ds_write_b64 v29, v[88:89] offset:160
    v_perm_b32 v90, v186, v182, s75
    v_perm_b32 v91, v194, v190, s75
    ds_write_b64 v29, v[90:91] offset:176
    v_perm_b32 v92, v187, v183, s74
    v_perm_b32 v93, v195, v191, s74
    ds_write_b64 v29, v[92:93] offset:224
    v_perm_b32 v94, v187, v183, s75
    v_perm_b32 v95, v195, v191, s75
    ds_write_b64 v29, v[94:95] offset:240
    ds_read_b128 v[208:211], v30 offset:0
    ds_read_b128 v[212:215], v30 offset:1040
    ds_read_b128 v[216:219], v30 offset:2080
    ds_read_b128 v[220:223], v30 offset:3120
    ds_read_b128 v[224:227], v30 offset:4160
    ds_read_b128 v[228:231], v30 offset:5200
    ds_read_b128 v[232:235], v30 offset:6240
    ds_read_b128 v[236:239], v30 offset:7280
    s_add_u32 s10, s73, 0
    s_waitcnt lgkmcnt(7)
    buffer_store_dwordx4 v[208:211], v4, s[12:15], s10 offen sc1
    s_add_u32 s10, s73, 20480
    s_waitcnt lgkmcnt(6)
    buffer_store_dwordx4 v[212:215], v4, s[12:15], s10 offen sc1
    s_add_u32 s10, s73, 40960
    s_waitcnt lgkmcnt(5)
    buffer_store_dwordx4 v[216:219], v4, s[12:15], s10 offen sc1
    s_add_u32 s10, s73, 61440
    s_waitcnt lgkmcnt(4)
    buffer_store_dwordx4 v[220:223], v4, s[12:15], s10 offen sc1
    s_add_u32 s10, s73, 81920
    s_waitcnt lgkmcnt(3)
    buffer_store_dwordx4 v[224:227], v4, s[12:15], s10 offen sc1
    s_add_u32 s10, s73, 102400
    s_waitcnt lgkmcnt(2)
    buffer_store_dwordx4 v[228:231], v4, s[12:15], s10 offen sc1
    s_add_u32 s10, s73, 122880
    s_waitcnt lgkmcnt(1)
    buffer_store_dwordx4 v[232:235], v4, s[12:15], s10 offen sc1
    s_add_u32 s10, s73, 143360
    s_waitcnt lgkmcnt(0)
    buffer_store_dwordx4 v[236:239], v4, s[12:15], s10 offen sc1
    s_add_u32 m0, s76, 32
    s_nop 0
    buffer_load_dwordx4 v4, s[32:35], 0 offen offset:0 nt lds
    buffer_load_dwordx4 v4, s[32:35], 0 offen offset:1024 nt lds
    buffer_load_dwordx4 v4, s[32:35], 0 offen offset:2048 nt lds
    buffer_load_dwordx4 v4, s[32:35], 0 offen offset:3072 nt lds
    s_add_u32 m0, s76, 8352
    s_nop 0
    buffer_load_dwordx4 v9, s[32:35], 0 offen offset:0 lds
    buffer_load_dwordx4 v9, s[32:35], 0 offen offset:1024 lds
    buffer_load_dwordx4 v9, s[32:35], 0 offen offset:2048 lds
    buffer_load_dwordx4 v9, s[32:35], 0 offen offset:3072 lds
    s_waitcnt vmcnt(16)
    s_branch L_wf_c
L_wf_b:
    s_add_u32 m0, s76, 32
    s_nop 0
    buffer_load_dwordx4 v4, s[32:35], 0 offen offset:0 nt lds
    buffer_load_dwordx4 v4, s[32:35], 0 offen offset:1024 nt lds
    buffer_load_dwordx4 v4, s[32:35], 0 offen offset:2048 nt lds
    buffer_load_dwordx4 v4, s[32:35], 0 offen offset:3072 nt lds
    s_add_u32 m0, s76, 8352
    s_nop 0
    buffer_load_dwordx4 v9, s[32:35], 0 offen offset:0 lds
    buffer_load_dwordx4 v9, s[32:35], 0 offen offset:1024 lds
    buffer_load_dwordx4 v9, s[32:35], 0 offen offset:2048 lds
    buffer_load_dwordx4 v9, s[32:35], 0 offen offset:3072 lds
    s_waitcnt vmcnt(8)
L_wf_c:
    v_add_u32 v14, s76, v4
    v_lshrrev_b32 v35, 4, v1
    v_and_b32 v9, 15, v1
    v_bfe_u32 v26, v1, 3, 1
    v_bfe_u32 v30, v1, 2, 2
    v_lshrrev_b32 v27, 1, v30
    v_and_b32 v29, 1, v35
    v_lshl_or_b32 v27, v29, 1, v27
    v_bfe_u32 v29, v1, 1, 1
    v_lshl_or_b32 v27, v29, 2, v27
    s_lshl_b32 s10, s4, 1
    v_xor_b32 v27, s10, v27
    v_lshlrev_b32 v29, 5, v29
    v_lshl_add_u32 v29, v35, 3, v29
    v_add_u32 v29, v29, v30
    v_lshlrev_b32 v29, 7, v29
    v_and_b32 v30, 1, v1
    v_lshl_add_u32 v29, v30, 3, v29
    v_add_u32 v29, 121856, v29
    v_lshl_add_u32 v32, v27, 4, v29
    v_xor_b32 v27, 1, v27
    v_lshl_add_u32 v33, v27, 4, v29
    s_lshl_b32 s10, s70, 6
    s_lshl_b32 s11, s4, 4
    s_add_u32 s10, s10, s11
    v_add_u32 v34, s10, v3
    v_mul_u32_u24 v34, 4352, v34
    v_lshl_add_u32 v34, v26, 6, v34
    v_lshl_add_u32 v34, v35, 4, v34
    s_and_b32 s10, s7, 15
    s_lshl_b32 s10, s10, 8
    s_add_u32 s10, s10, 4194304
    v_add_u32 v34, s10, v34
    s_barrier
    s_cmp_lg_u32 s4, 0
    s_cbranch_scc1 L_post_2
    s_lshl_b32 s10, s7, 7
    s_add_u32 s10, s10, 4096
    v_mov_b32 v192, s8
    v_mov_b32 v193, s9
    s_mov_b64 exec, 1
    buffer_store_dwordx2 v[192:193], off, s[12:15], s10 sc1
    s_mov_b64 exec, -1
L_post_2:
    s_add_u32 m0, s72, 0
    s_nop 0
    buffer_load_dwordx4 v160, s[28:31], 0 offen nt lds
    s_add_u32 m0, s72, 1024
    s_nop 0
    buffer_load_dwordx4 v161, s[28:31], s97 offen nt lds
    s_add_u32 m0, s72, 2048
    s_nop 0
    buffer_load_dwordx4 v160, s[28:31], s98 offen nt lds
    s_add_u32 m0, s72, 3072
    s_nop 0
    buffer_load_dwordx4 v161, s[28:31], s99 offen nt lds
    v_add_u32 v27, 1, v9
    v_and_b32 v13, 3, v27
    v_mul_u32_u24 v13, 4160, v13
    v_lshrrev_b32 v27, 2, v27
    v_lshl_add_u32 v13, v27, 3, v13
    v_lshl_add_u32 v13, v35, 4, v13
    v_add_u32 v6, s76, v13
    v_lshlrev_b32 v27, 4, v35
    v_lshlrev_b32 v13, 5, v9
    v_sub_u32 v27, v27, v13
    s_add_u32 s10, s77, 480
    v_add_u32 v7, s10, v27
    s_and_b32 s10, s7, 0xf0
    v_add_u32 v15, s10, v9
    v_lshlrev_b32 v15, 7, v15
    v_add_u32 v15, 4096, v15
    s_mov_b32 s10, 34816
    s_waitcnt lgkmcnt(0)
    s_waitcnt vmcnt(4)
    s_cmp_eq_u32 s4, 0
    s_cbranch_scc1 L_wf_d
    s_lshl_b32 s10, s100, 7
    s_add_u32 s10, s10, 149504
    v_mov_b32 v192, s8
    v_mov_b32 v193, s9
    s_mov_b64 exec, 1
    buffer_store_dwordx2 v[192:193], off, s[12:15], s10 sc1
    s_mov_b64 exec, -1
L_wf_d:
    ds_read_b128 v[36:39], v14 offset:32
    ds_read_b64 v[40:41], v14 offset:48
    ds_read_b128 v[42:45], v14 offset:1056
    ds_read_b64 v[46:47], v14 offset:1072
    ds_read_b128 v[48:51], v14 offset:2080
    ds_read_b64 v[52:53], v14 offset:2096
    ds_read_b128 v[54:57], v14 offset:3104
    ds_read_b64 v[58:59], v14 offset:3120
    s_waitcnt lgkmcnt(6)
    v_alignbyte_b32 v64, v37, v36, 2
    v_alignbyte_b32 v65, v38, v37, 2
    v_alignbyte_b32 v66, v39, v38, 2
    v_alignbyte_b32 v67, v40, v39, 2
    v_alignbyte_b32 v68, v38, v37, 2
    v_alignbyte_b32 v69, v39, v38, 2
    v_alignbyte_b32 v70, v40, v39, 2
    v_alignbyte_b32 v71, v41, v40, 2
    ds_write_b128 v14, v[64:67] offset:4192
    ds_write_b128 v14, v[68:71] offset:12512
    s_waitcnt lgkmcnt(6)
    v_alignbyte_b32 v72, v43, v42, 2
    v_alignbyte_b32 v73, v44, v43, 2
    v_alignbyte_b32 v74, v45, v44, 2
    v_alignbyte_b32 v75, v46, v45, 2
    v_alignbyte_b32 v76, v44, v43, 2
    v_alignbyte_b32 v77, v45, v44, 2
    v_alignbyte_b32 v78, v46, v45, 2
    v_alignbyte_b32 v79, v47, v46, 2
    ds_write_b128 v14, v[72:75] offset:5216
    ds_write_b128 v14, v[76:79] offset:13536
    s_waitcnt lgkmcnt(6)
    v_alignbyte_b32 v80, v49, v48, 2
    v_alignbyte_b32 v81, v50, v49, 2
    v_alignbyte_b32 v82, v51, v50, 2
    v_alignbyte_b32 v83, v52, v51, 2
    v_alignbyte_b32 v84, v50, v49, 2
    v_alignbyte_b32 v85, v51, v50, 2
    v_alignbyte_b32 v86, v52, v51, 2
    v_alignbyte_b32 v87, v53, v52, 2
    ds_write_b128 v14, v[80:83] offset:6240
    ds_write_b128 v14, v[84:87] offset:14560
    s_waitcnt lgkmcnt(6)
    v_alignbyte_b32 v88, v55, v54, 2
    v_alignbyte_b32 v89, v56, v55, 2
    v_alignbyte_b32 v90, v57, v56, 2
    v_alignbyte_b32 v91, v58, v57, 2
    v_alignbyte_b32 v92, v56, v55, 2
    v_alignbyte_b32 v93, v57, v56, 2
    v_alignbyte_b32 v94, v58, v57, 2
    v_alignbyte_b32 v95, v59, v58, 2
    ds_write_b128 v14, v[88:91] offset:7264
    ds_write_b128 v14, v[92:95] offset:15584
    v_lshlrev_b32 v222, 16, v36
    v_mov_b32 v223, s76
    s_mov_b64 exec, 1
    ds_write_b32 v223, v222 offset:4188
    ds_write_b32 v223, v36 offset:8348
    ds_write_b32 v223, v222 offset:12504
    ds_write_b32 v223, v64 offset:12508
    s_mov_b64 exec, -1
    s_cmp_eq_u32 s4, 0
    s_cbranch_scc1 L_w0_poll
    s_waitcnt vmcnt(0)
    s_branch L_w0_done
L_w0_poll:
    buffer_load_dwordx2 v[234:235], v15, s[12:15], 0 offen sc1
    s_waitcnt vmcnt(0)
    v_cmp_eq_u64 vcc, s[8:9], v[234:235]
    s_cmp_eq_u64 vcc, exec
    s_cbranch_scc1 L_pok_3
    s_mov_b32 s10, 0
L_plp_4:
    buffer_load_dwordx2 v[234:235], v15, s[12:15], 0 offen sc1
    s_add_u32 s10, s10, 1
    s_waitcnt vmcnt(0)
    v_cmp_eq_u64 vcc, s[8:9], v[234:235]
    s_cmp_eq_u64 vcc, exec
    s_cbranch_scc1 L_pok_3
    s_cmp_lt_u32 s10, 40000
    s_cbranch_scc1 L_plp_4
L_pok_3:
L_w0_done:
    s_barrier
    v_mov_b32 v2, v6
    v_mov_b32 v3, v7
    s_mov_b32 m0, s77
    s_add_u32 s10, s79, 1048576
    s_add_u32 s10, s79, 1048576
    buffer_load_dwordx4 v4, s[12:15], s10 offen offset:0 sc1 lds
    buffer_load_dwordx4 v4, s[12:15], s10 offen offset:1024 sc1 lds
    buffer_load_dwordx4 v4, s[12:15], s10 offen offset:2048 sc1 lds
    buffer_load_dwordx4 v4, s[12:15], s10 offen offset:3072 sc1 lds
    ds_read_b64_tr_b16 v[128:129], v32 offset:0
    ds_read_b64_tr_b16 v[130:131], v32 offset:512
    ds_read_b64_tr_b16 v[132:133], v32 offset:8192
    ds_read_b64_tr_b16 v[134:135], v32 offset:8704
    ds_read_b64_tr_b16 v[136:137], v33 offset:0
    ds_read_b64_tr_b16 v[138:139], v33 offset:512
    ds_read_b64_tr_b16 v[140:141], v33 offset:8192
    ds_read_b64_tr_b16 v[142:143], v33 offset:8704
    s_waitcnt lgkmcnt(0)
    s_mov_b32 s11, 34816
    buffer_store_dwordx4 v[128:131], v34, s[12:15], 0 offen offset:0 sc1
    buffer_store_dwordx4 v[132:135], v34, s[12:15], 0 offen offset:128 sc1
    buffer_store_dwordx4 v[136:139], v34, s[12:15], s11 offen offset:0 sc1
    buffer_store_dwordx4 v[140:143], v34, s[12:15], s11 offen offset:128 sc1
L_padz_a0:
    s_mul_i32 s70, s67, 14
    s_lshr_b32 s10, s4, 1
    s_mul_i32 s10, s10, 7
    s_add_u32 s70, s70, s10
    s_add_u32 s71, s70, 6
    s_and_b32 s10, s4, 1
    s_mul_i32 s10, s10, 3
    s_add_u32 s70, s70, s10
    s_mul_i32 s70, s70, 20480
    s_mul_i32 s71, s71, 20480
    s_add_u32 s28, s64, 17825792
    s_addc_u32 s29, s65, 0
    s_and_b32 s29, s29, 0xffff
    s_mov_b32 s30, 4423680
    s_mov_b32 s31, 0x20000
    s_mul_i32 s10, s67, 14
    s_lshr_b32 s11, s4, 1
    s_mul_i32 s11, s11, 7
    s_add_u32 s10, s10, s11
    s_add_u32 s11, s10, 6
    s_lshr_b32 s10, s10, 3
    s_lshr_b32 s11, s11, 3
    s_min_u32 s10, s10, 26
    s_min_u32 s11, s11, 26
    s_mul_i32 s10, s10, 20
    s_mul_i32 s11, s11, 20
    s_add_u32 s11, s11, 19
    v_add_u32 v5, s10, v1
    v_min_u32 v5, s11, v5
    v_lshlrev_b32 v5, 7, v5
    v_add_u32 v5, 149504, v5
    v_and_b32 v10, 15, v1
    v_lshrrev_b32 v11, 4, v1
    s_and_b32 s10, s7, 0xf0
    s_lshl_b32 s11, s4, 2
    s_add_u32 s10, s10, s11
    s_add_u32 s10, s10, 800
    v_add_u32 v6, s10, v10
    s_lshl_b32 s11, s4, 3
    s_add_u32 s11, s11, 196
    v_add_u32 v7, s11, v10
    v_cmp_gt_u32 vcc, 4, v10
    s_lshr_b32 s10, s78, 6
    s_mul_i32 s11, s4, 10
    v_cndmask_b32 v6, v7, v6, vcc
    s_add_u32 s10, s10, s11
    s_add_u32 s10, s10, 160
    v_mov_b32 v7, s10
    v_cmp_gt_u32 vcc, 12, v10
    s_nop 1
    v_cndmask_b32 v6, v7, v6, vcc
    v_lshlrev_b32 v6, 7, v6
    v_add_u32 v6, 4096, v6
    v_and_b32 v12, 1, v11
    v_lshlrev_b32 v12, 9, v12
    v_lshl_add_u32 v12, v10, 5, v12
    v_lshrrev_b32 v13, 1, v11
    v_lshl_add_u32 v12, v13, 4, v12
    s_add_u32 s10, s79, 4194304
    v_add_u32 v7, s10, v12
    s_add_u32 s10, s77, 1008
    v_sub_u32 v8, s10, v12
    v_lshlrev_b32 v13, 1, v13
    v_lshrrev_b32 v14, 2, v10
    v_xor_b32 v13, v13, v14
    v_and_b32 v14, 1, v11
    v_lshlrev_b32 v14, 10, v14
    v_lshl_add_u32 v14, v10, 6, v14
    v_add_u32 v14, 138240, v14
    v_lshl_add_u32 v9, v13, 4, v14
    v_xor_b32 v13, 1, v13
    v_lshl_add_u32 v13, v13, 4, v14
    v_xor_b32 v15, v11, v1
    v_lshlrev_b32 v15, 4, v15
    s_mov_b32 s16, s46
    s_and_b32 s17, s47, 0xffff
    s_mov_b32 s18, 1280
    s_mov_b32 s19, 0x20000
    s_waitcnt vmcnt(4)
    ds_read_b64 v[48:49], v2 offset:0
    ds_read_b64 v[50:51], v2 offset:8
    ds_read_b128 v[80:83], v3 offset:3584
    ds_read_b128 v[84:87], v3 offset:3072
    ds_read_b128 v[88:91], v3 offset:2560
    ds_read_b128 v[92:95], v3 offset:2048
    ds_read_b128 v[96:99], v3 offset:1536
    ds_read_b128 v[100:103], v3 offset:1024
    ds_read_b128 v[104:107], v3 offset:512
    ds_read_b128 v[108:111], v3 offset:0
    ds_read_b64 v[52:53], v2 offset:512
    ds_read_b64 v[54:55], v2 offset:520
    ds_read_b64 v[56:57], v2 offset:1024
    ds_read_b64 v[58:59], v2 offset:1032
    ds_read_b64 v[60:61], v2 offset:1536
    ds_read_b64 v[62:63], v2 offset:1544
    ds_read_b64 v[64:65], v2 offset:2048
    ds_read_b64 v[66:67], v2 offset:2056
    ds_read_b64 v[68:69], v2 offset:2560
    ds_read_b64 v[70:71], v2 offset:2568
    ds_read_b64 v[72:73], v2 offset:3072
    ds_read_b64 v[74:75], v2 offset:3080
    ds_read_b64 v[76:77], v2 offset:3584
    ds_read_b64 v[78:79], v2 offset:3592
    s_waitcnt lgkmcnt(14)
    v_mfma_f32_16x16x32_bf16 v[16:19], v[48:51], v[80:83], 0
    s_lshl_b32 s73, s78, 1
    buffer_load_ushort v192, off, s[16:19], s73
    v_mfma_f32_16x16x32_bf16 v[20:23], v[48:51], v[84:87], 0
    v_mfma_f32_16x16x32_bf16 v[24:27], v[48:51], v[88:91], 0
    v_mfma_f32_16x16x32_bf16 v[28:31], v[48:51], v[92:95], 0
    v_mfma_f32_16x16x32_bf16 v[32:35], v[48:51], v[96:99], 0
    v_mfma_f32_16x16x32_bf16 v[36:39], v[48:51], v[100:103], 0
    v_mfma_f32_16x16x32_bf16 v[40:43], v[48:51], v[104:107], 0
    v_mfma_f32_16x16x32_bf16 v[44:47], v[48:51], v[108:111], 0
    s_waitcnt lgkmcnt(8)
    v_mfma_f32_16x16x32_bf16 v[20:23], v[52:55], v[80:83], v[20:23]
    ds_read_b64 v[112:113], v2 offset:64
    v_mfma_f32_16x16x32_bf16 v[24:27], v[52:55], v[84:87], v[24:27]
    ds_read_b64 v[114:115], v2 offset:72
    v_mfma_f32_16x16x32_bf16 v[28:31], v[52:55], v[88:91], v[28:31]
    ds_read_b128 v[144:147], v3 offset:3648
    v_mfma_f32_16x16x32_bf16 v[32:35], v[52:55], v[92:95], v[32:35]
    ds_read_b128 v[148:151], v3 offset:3136
    v_mfma_f32_16x16x32_bf16 v[36:39], v[52:55], v[96:99], v[36:39]
    ds_read_b128 v[152:155], v3 offset:2624
    v_mfma_f32_16x16x32_bf16 v[40:43], v[52:55], v[100:103], v[40:43]
    ds_read_b128 v[156:159], v3 offset:2112
    v_mfma_f32_16x16x32_bf16 v[44:47], v[52:55], v[104:107], v[44:47]
    ds_read_b128 v[160:163], v3 offset:1600
    s_waitcnt lgkmcnt(7)
    v_mfma_f32_16x16x32_bf16 v[24:27], v[56:59], v[80:83], v[24:27]
    ds_read_b128 v[164:167], v3 offset:1088
    v_mfma_f32_16x16x32_bf16 v[28:31], v[56:59], v[84:87], v[28:31]
    ds_read_b128 v[168:171], v3 offset:576
    v_mfma_f32_16x16x32_bf16 v[32:35], v[56:59], v[88:91], v[32:35]
    ds_read_b128 v[172:175], v3 offset:64
    v_mfma_f32_16x16x32_bf16 v[36:39], v[56:59], v[92:95], v[36:39]
    ds_read_b64 v[116:117], v2 offset:576
    v_mfma_f32_16x16x32_bf16 v[40:43], v[56:59], v[96:99], v[40:43]
    ds_read_b64 v[118:119], v2 offset:584
    v_mfma_f32_16x16x32_bf16 v[44:47], v[56:59], v[100:103], v[44:47]
    ds_read_b64 v[120:121], v2 offset:1088
    v_mfma_f32_16x16x32_bf16 v[28:31], v[60:63], v[80:83], v[28:31]
    ds_read_b64 v[122:123], v2 offset:1096
    v_mfma_f32_16x16x32_bf16 v[32:35], v[60:63], v[84:87], v[32:35]
    ds_read_b64 v[124:125], v2 offset:1600
    v_mfma_f32_16x16x32_bf16 v[36:39], v[60:63], v[88:91], v[36:39]
    ds_read_b64 v[126:127], v2 offset:1608
    v_mfma_f32_16x16x32_bf16 v[40:43], v[60:63], v[92:95], v[40:43]
    ds_read_b64 v[128:129], v2 offset:2112
    v_mfma_f32_16x16x32_bf16 v[44:47], v[60:63], v[96:99], v[44:47]
    ds_read_b64 v[130:131], v2 offset:2120
    v_mfma_f32_16x16x32_bf16 v[32:35], v[64:67], v[80:83], v[32:35]
    ds_read_b64 v[132:133], v2 offset:2624
    v_mfma_f32_16x16x32_bf16 v[36:39], v[64:67], v[84:87], v[36:39]
    ds_read_b64 v[134:135], v2 offset:2632
    v_mfma_f32_16x16x32_bf16 v[40:43], v[64:67], v[88:91], v[40:43]
    ds_read_b64 v[136:137], v2 offset:3136
    v_mfma_f32_16x16x32_bf16 v[44:47], v[64:67], v[92:95], v[44:47]
    ds_read_b64 v[138:139], v2 offset:3144
    v_mfma_f32_16x16x32_bf16 v[36:39], v[68:71], v[80:83], v[36:39]
    ds_read_b64 v[140:141], v2 offset:3648
    v_mfma_f32_16x16x32_bf16 v[40:43], v[68:71], v[84:87], v[40:43]
    ds_read_b64 v[142:143], v2 offset:3656
    v_mfma_f32_16x16x32_bf16 v[44:47], v[68:71], v[88:91], v[44:47]
    v_mfma_f32_16x16x32_bf16 v[40:43], v[72:75], v[80:83], v[40:43]
    v_mfma_f32_16x16x32_bf16 v[44:47], v[72:75], v[84:87], v[44:47]
    v_mfma_f32_16x16x32_bf16 v[44:47], v[76:79], v[80:83], v[44:47]
    s_waitcnt lgkmcnt(0)
    v_mfma_f32_16x16x32_bf16 v[16:19], v[112:115], v[144:147], v[16:19]
    ds_read_b64 v[48:49], v2 offset:128
    v_mfma_f32_16x16x32_bf16 v[20:23], v[112:115], v[148:151], v[20:23]
    ds_read_b64 v[50:51], v2 offset:136
    v_mfma_f32_16x16x32_bf16 v[24:27], v[112:115], v[152:155], v[24:27]
    ds_read_b128 v[80:83], v3 offset:3712
    buffer_load_dwordx2 v[200:201], v5, s[12:15], 0 offen sc1
    v_mfma_f32_16x16x32_bf16 v[28:31], v[112:115], v[156:159], v[28:31]
    ds_read_b128 v[84:87], v3 offset:3200
    v_mfma_f32_16x16x32_bf16 v[32:35], v[112:115], v[160:163], v[32:35]
    ds_read_b128 v[88:91], v3 offset:2688
    v_mfma_f32_16x16x32_bf16 v[36:39], v[112:115], v[164:167], v[36:39]
    ds_read_b128 v[92:95], v3 offset:2176
    v_mfma_f32_16x16x32_bf16 v[40:43], v[112:115], v[168:171], v[40:43]
    ds_read_b128 v[96:99], v3 offset:1664
    v_mfma_f32_16x16x32_bf16 v[44:47], v[112:115], v[172:175], v[44:47]
    ds_read_b128 v[100:103], v3 offset:1152
    v_mfma_f32_16x16x32_bf16 v[20:23], v[116:119], v[144:147], v[20:23]
    ds_read_b128 v[104:107], v3 offset:640
    v_mfma_f32_16x16x32_bf16 v[24:27], v[116:119], v[148:151], v[24:27]
    ds_read_b128 v[108:111], v3 offset:128
    v_mfma_f32_16x16x32_bf16 v[28:31], v[116:119], v[152:155], v[28:31]
    ds_read_b64 v[52:53], v2 offset:640
    v_mfma_f32_16x16x32_bf16 v[32:35], v[116:119], v[156:159], v[32:35]
    ds_read_b64 v[54:55], v2 offset:648
    v_mfma_f32_16x16x32_bf16 v[36:39], v[116:119], v[160:163], v[36:39]
    ds_read_b64 v[56:57], v2 offset:1152
    v_mfma_f32_16x16x32_bf16 v[40:43], v[116:119], v[164:167], v[40:43]
    ds_read_b64 v[58:59], v2 offset:1160
    v_mfma_f32_16x16x32_bf16 v[44:47], v[116:119], v[168:171], v[44:47]
    ds_read_b64 v[60:61], v2 offset:1664
    v_mfma_f32_16x16x32_bf16 v[24:27], v[120:123], v[144:147], v[24:27]
    ds_read_b64 v[62:63], v2 offset:1672
    v_mfma_f32_16x16x32_bf16 v[28:31], v[120:123], v[148:151], v[28:31]
    ds_read_b64 v[64:65], v2 offset:2176
    v_mfma_f32_16x16x32_bf16 v[32:35], v[120:123], v[152:155], v[32:35]
    ds_read_b64 v[66:67], v2 offset:2184
    v_mfma_f32_16x16x32_bf16 v[36:39], v[120:123], v[156:159], v[36:39]
    ds_read_b64 v[68:69], v2 offset:2688
    v_mfma_f32_16x16x32_bf16 v[40:43], v[120:123], v[160:163], v[40:43]
    ds_read_b64 v[70:71], v2 offset:2696
    v_mfma_f32_16x16x32_bf16 v[44:47], v[120:123], v[164:167], v[44:47]
    ds_read_b64 v[72:73], v2 offset:3200
    v_mfma_f32_16x16x32_bf16 v[28:31], v[124:127], v[144:147], v[28:31]
    ds_read_b64 v[74:75], v2 offset:3208
    v_mfma_f32_16x16x32_bf16 v[32:35], v[124:127], v[148:151], v[32:35]
    ds_read_b64 v[76:77], v2 offset:3712
    v_mfma_f32_16x16x32_bf16 v[36:39], v[124:127], v[152:155], v[36:39]
    ds_read_b64 v[78:79], v2 offset:3720
    v_mfma_f32_16x16x32_bf16 v[40:43], v[124:127], v[156:159], v[40:43]
    v_mfma_f32_16x16x32_bf16 v[44:47], v[124:127], v[160:163], v[44:47]
    v_mfma_f32_16x16x32_bf16 v[32:35], v[128:131], v[144:147], v[32:35]
    v_mfma_f32_16x16x32_bf16 v[36:39], v[128:131], v[148:151], v[36:39]
    v_mfma_f32_16x16x32_bf16 v[40:43], v[128:131], v[152:155], v[40:43]
    v_mfma_f32_16x16x32_bf16 v[44:47], v[128:131], v[156:159], v[44:47]
    v_mfma_f32_16x16x32_bf16 v[36:39], v[132:135], v[144:147], v[36:39]
    v_mfma_f32_16x16x32_bf16 v[40:43], v[132:135], v[148:151], v[40:43]
    v_mfma_f32_16x16x32_bf16 v[44:47], v[132:135], v[152:155], v[44:47]
    v_mfma_f32_16x16x32_bf16 v[40:43], v[136:139], v[144:147], v[40:43]
    v_mfma_f32_16x16x32_bf16 v[44:47], v[136:139], v[148:151], v[44:47]
    v_mfma_f32_16x16x32_bf16 v[44:47], v[140:143], v[144:147], v[44:47]
    s_waitcnt vmcnt(0)
    v_cmp_eq_u64 vcc, s[8:9], v[200:201]
    s_cmp_eq_u64 vcc, exec
    s_cbranch_scc1 L_pok_5
    s_mov_b32 s10, 0
L_plp_6:
    s_sleep 1
    buffer_load_dwordx2 v[200:201], v5, s[12:15], 0 offen sc1
    s_add_u32 s10, s10, 1
    s_waitcnt vmcnt(0)
    v_cmp_eq_u64 vcc, s[8:9], v[200:201]
    s_cmp_eq_u64 vcc, exec
    s_cbranch_scc1 L_pok_5
    s_cmp_lt_u32 s10, 40000
    s_cbranch_scc1 L_plp_6
L_pok_5:
    s_waitcnt lgkmcnt(0)
    v_mfma_f32_16x16x32_bf16 v[16:19], v[48:51], v[80:83], v[16:19]
    ds_read_b64 v[112:113], v2 offset:192
    s_add_u32 s3, s70, 0
    v_mfma_f32_16x16x32_bf16 v[20:23], v[48:51], v[84:87], v[20:23]
    ds_read_b64 v[114:115], v2 offset:200
    buffer_load_dwordx4 a[0:3], v4, s[28:31], s3 offen offset:0 sc1
    v_mfma_f32_16x16x32_bf16 v[24:27], v[48:51], v[88:91], v[24:27]
    ds_read_b128 v[144:147], v3 offset:3776
    v_mfma_f32_16x16x32_bf16 v[28:31], v[48:51], v[92:95], v[28:31]
    ds_read_b128 v[148:151], v3 offset:3264
    v_mfma_f32_16x16x32_bf16 v[32:35], v[48:51], v[96:99], v[32:35]
    ds_read_b128 v[152:155], v3 offset:2752
    v_mfma_f32_16x16x32_bf16 v[36:39], v[48:51], v[100:103], v[36:39]
    ds_read_b128 v[156:159], v3 offset:2240
    buffer_load_dwordx4 a[16:19], v4, s[28:31], s3 offen offset:1024 sc1
    v_mfma_f32_16x16x32_bf16 v[40:43], v[48:51], v[104:107], v[40:43]
    ds_read_b128 v[160:163], v3 offset:1728
    v_mfma_f32_16x16x32_bf16 v[44:47], v[48:51], v[108:111], v[44:47]
    ds_read_b128 v[164:167], v3 offset:1216
    v_mfma_f32_16x16x32_bf16 v[20:23], v[52:55], v[80:83], v[20:23]
    ds_read_b128 v[168:171], v3 offset:704
    v_mfma_f32_16x16x32_bf16 v[24:27], v[52:55], v[84:87], v[24:27]
    ds_read_b128 v[172:175], v3 offset:192
    buffer_load_dwordx4 a[32:35], v4, s[28:31], s3 offen offset:2048 sc1
    v_mfma_f32_16x16x32_bf16 v[28:31], v[52:55], v[88:91], v[28:31]
    ds_read_b64 v[116:117], v2 offset:704
    v_mfma_f32_16x16x32_bf16 v[32:35], v[52:55], v[92:95], v[32:35]
    ds_read_b64 v[118:119], v2 offset:712
    v_mfma_f32_16x16x32_bf16 v[36:39], v[52:55], v[96:99], v[36:39]
    ds_read_b64 v[120:121], v2 offset:1216
    v_mfma_f32_16x16x32_bf16 v[40:43], v[52:55], v[100:103], v[40:43]
    ds_read_b64 v[122:123], v2 offset:1224
    buffer_load_dwordx4 a[48:51], v4, s[28:31], s3 offen offset:3072 sc1
    v_mfma_f32_16x16x32_bf16 v[44:47], v[52:55], v[104:107], v[44:47]
    ds_read_b64 v[124:125], v2 offset:1728
    s_add_u32 s3, s70, 20480
    v_mfma_f32_16x16x32_bf16 v[24:27], v[56:59], v[80:83], v[24:27]
    ds_read_b64 v[126:127], v2 offset:1736
    v_mfma_f32_16x16x32_bf16 v[28:31], v[56:59], v[84:87], v[28:31]
    ds_read_b64 v[128:129], v2 offset:2240
    v_mfma_f32_16x16x32_bf16 v[32:35], v[56:59], v[88:91], v[32:35]
    ds_read_b64 v[130:131], v2 offset:2248
    buffer_load_dwordx4 a[4:7], v4, s[28:31], s3 offen offset:0 sc1
    v_mfma_f32_16x16x32_bf16 v[36:39], v[56:59], v[92:95], v[36:39]
    ds_read_b64 v[132:133], v2 offset:2752
    v_mfma_f32_16x16x32_bf16 v[40:43], v[56:59], v[96:99], v[40:43]
    ds_read_b64 v[134:135], v2 offset:2760
    v_mfma_f32_16x16x32_bf16 v[44:47], v[56:59], v[100:103], v[44:47]
    ds_read_b64 v[136:137], v2 offset:3264
    v_mfma_f32_16x16x32_bf16 v[28:31], v[60:63], v[80:83], v[28:31]
    ds_read_b64 v[138:139], v2 offset:3272
    buffer_load_dwordx4 a[20:23], v4, s[28:31], s3 offen offset:1024 sc1
    v_mfma_f32_16x16x32_bf16 v[32:35], v[60:63], v[84:87], v[32:35]
    ds_read_b64 v[140:141], v2 offset:3776
    v_mfma_f32_16x16x32_bf16 v[36:39], v[60:63], v[88:91], v[36:39]
    ds_read_b64 v[142:143], v2 offset:3784
    v_mfma_f32_16x16x32_bf16 v[40:43], v[60:63], v[92:95], v[40:43]
    v_mfma_f32_16x16x32_bf16 v[44:47], v[60:63], v[96:99], v[44:47]
    buffer_load_dwordx4 a[36:39], v4, s[28:31], s3 offen offset:2048 sc1
    v_mfma_f32_16x16x32_bf16 v[32:35], v[64:67], v[80:83], v[32:35]
    v_mfma_f32_16x16x32_bf16 v[36:39], v[64:67], v[84:87], v[36:39]
    v_mfma_f32_16x16x32_bf16 v[40:43], v[64:67], v[88:91], v[40:43]
    v_mfma_f32_16x16x32_bf16 v[44:47], v[64:67], v[92:95], v[44:47]
    buffer_load_dwordx4 a[52:55], v4, s[28:31], s3 offen offset:3072 sc1
    s_add_u32 s3, s70, 40960
    v_mfma_f32_16x16x32_bf16 v[36:39], v[68:71], v[80:83], v[36:39]
    v_mfma_f32_16x16x32_bf16 v[40:43], v[68:71], v[84:87], v[40:43]
    v_mfma_f32_16x16x32_bf16 v[44:47], v[68:71], v[88:91], v[44:47]
    v_mfma_f32_16x16x32_bf16 v[40:43], v[72:75], v[80:83], v[40:43]
    buffer_load_dwordx4 a[8:11], v4, s[28:31], s3 offen offset:0 sc1
    v_mfma_f32_16x16x32_bf16 v[44:47], v[72:75], v[84:87], v[44:47]
    v_mfma_f32_16x16x32_bf16 v[44:47], v[76:79], v[80:83], v[44:47]
    s_barrier
    s_cmp_lg_u32 s4, 0
    s_cbranch_scc1 L_post_7
    s_lshl_b32 s10, s7, 7
    s_add_u32 s10, s10, 106496
    v_mov_b32 v204, s8
    v_mov_b32 v205, s9
    s_mov_b64 exec, 1
    buffer_store_dwordx2 v[204:205], off, s[12:15], s10 sc1
    s_mov_b64 exec, -1
L_post_7:
    s_waitcnt lgkmcnt(0)
    v_mfma_f32_16x16x32_bf16 v[16:19], v[112:115], v[144:147], v[16:19]
    ds_read_b64 v[48:49], v2 offset:256
    buffer_load_dwordx4 a[24:27], v4, s[28:31], s3 offen offset:1024 sc1
    v_mfma_f32_16x16x32_bf16 v[20:23], v[112:115], v[148:151], v[20:23]
    ds_read_b64 v[50:51], v2 offset:264
    v_mfma_f32_16x16x32_bf16 v[24:27], v[112:115], v[152:155], v[24:27]
    ds_read_b128 v[80:83], v3 offset:3840
    v_mfma_f32_16x16x32_bf16 v[28:31], v[112:115], v[156:159], v[28:31]
    ds_read_b128 v[84:87], v3 offset:3328
    v_mfma_f32_16x16x32_bf16 v[32:35], v[112:115], v[160:163], v[32:35]
    ds_read_b128 v[88:91], v3 offset:2816
    buffer_load_dwordx4 a[40:43], v4, s[28:31], s3 offen offset:2048 sc1
    v_mfma_f32_16x16x32_bf16 v[36:39], v[112:115], v[164:167], v[36:39]
    ds_read_b128 v[92:95], v3 offset:2304
    v_mfma_f32_16x16x32_bf16 v[40:43], v[112:115], v[168:171], v[40:43]
    ds_read_b128 v[96:99], v3 offset:1792
    v_mfma_f32_16x16x32_bf16 v[44:47], v[112:115], v[172:175], v[44:47]
    ds_read_b128 v[100:103], v3 offset:1280
    v_mfma_f32_16x16x32_bf16 v[20:23], v[116:119], v[144:147], v[20:23]
    ds_read_b128 v[104:107], v3 offset:768
    buffer_load_dwordx4 a[56:59], v4, s[28:31], s3 offen offset:3072 sc1
    v_mfma_f32_16x16x32_bf16 v[24:27], v[116:119], v[148:151], v[24:27]
    ds_read_b128 v[108:111], v3 offset:256
    s_add_u32 s3, s71, 0
    v_mfma_f32_16x16x32_bf16 v[28:31], v[116:119], v[152:155], v[28:31]
    ds_read_b64 v[52:53], v2 offset:768
    v_mfma_f32_16x16x32_bf16 v[32:35], v[116:119], v[156:159], v[32:35]
    ds_read_b64 v[54:55], v2 offset:776
    v_mfma_f32_16x16x32_bf16 v[36:39], v[116:119], v[160:163], v[36:39]
    ds_read_b64 v[56:57], v2 offset:1280
    buffer_load_dwordx4 a[12:15], v4, s[28:31], s3 offen offset:0 sc1
    v_mfma_f32_16x16x32_bf16 v[40:43], v[116:119], v[164:167], v[40:43]
    ds_read_b64 v[58:59], v2 offset:1288
    v_mfma_f32_16x16x32_bf16 v[44:47], v[116:119], v[168:171], v[44:47]
    ds_read_b64 v[60:61], v2 offset:1792
    v_mfma_f32_16x16x32_bf16 v[24:27], v[120:123], v[144:147], v[24:27]
    ds_read_b64 v[62:63], v2 offset:1800
    v_mfma_f32_16x16x32_bf16 v[28:31], v[120:123], v[148:151], v[28:31]
    ds_read_b64 v[64:65], v2 offset:2304
    buffer_load_dwordx4 a[28:31], v4, s[28:31], s3 offen offset:1024 sc1
    v_mfma_f32_16x16x32_bf16 v[32:35], v[120:123], v[152:155], v[32:35]
    ds_read_b64 v[66:67], v2 offset:2312
    v_mfma_f32_16x16x32_bf16 v[36:39], v[120:123], v[156:159], v[36:39]
    ds_read_b64 v[68:69], v2 offset:2816
    v_mfma_f32_16x16x32_bf16 v[40:43], v[120:123], v[160:163], v[40:43]
    ds_read_b64 v[70:71], v2 offset:2824
    v_mfma_f32_16x16x32_bf16 v[44:47], v[120:123], v[164:167], v[44:47]
    ds_read_b64 v[72:73], v2 offset:3328
    buffer_load_dwordx4 a[44:47], v4, s[28:31], s3 offen offset:2048 sc1
    v_mfma_f32_16x16x32_bf16 v[28:31], v[124:127], v[144:147], v[28:31]
    ds_read_b64 v[74:75], v2 offset:3336
    v_mfma_f32_16x16x32_bf16 v[32:35], v[124:127], v[148:151], v[32:35]
    ds_read_b64 v[76:77], v2 offset:3840
    v_mfma_f32_16x16x32_bf16 v[36:39], v[124:127], v[152:155], v[36:39]
    ds_read_b64 v[78:79], v2 offset:3848
    v_mfma_f32_16x16x32_bf16 v[40:43], v[124:127], v[156:159], v[40:43]
    buffer_load_dwordx4 a[60:63], v4, s[28:31], s3 offen offset:3072 sc1
    s_add_u32 s3, s70, 4096
    v_mfma_f32_16x16x32_bf16 v[44:47], v[124:127], v[160:163], v[44:47]
    v_mfma_f32_16x16x32_bf16 v[32:35], v[128:131], v[144:147], v[32:35]
    v_mfma_f32_16x16x32_bf16 v[36:39], v[128:131], v[148:151], v[36:39]
    v_mfma_f32_16x16x32_bf16 v[40:43], v[128:131], v[152:155], v[40:43]
    buffer_load_dwordx4 a[64:67], v4, s[28:31], s3 offen offset:0 sc1
    v_mfma_f32_16x16x32_bf16 v[44:47], v[128:131], v[156:159], v[44:47]
    v_mfma_f32_16x16x32_bf16 v[36:39], v[132:135], v[144:147], v[36:39]
    v_mfma_f32_16x16x32_bf16 v[40:43], v[132:135], v[148:151], v[40:43]
    v_mfma_f32_16x16x32_bf16 v[44:47], v[132:135], v[152:155], v[44:47]
    buffer_load_dwordx4 a[80:83], v4, s[28:31], s3 offen offset:1024 sc1
    v_mfma_f32_16x16x32_bf16 v[40:43], v[136:139], v[144:147], v[40:43]
    v_mfma_f32_16x16x32_bf16 v[44:47], v[136:139], v[148:151], v[44:47]
    v_mfma_f32_16x16x32_bf16 v[44:47], v[140:143], v[144:147], v[44:47]
    s_waitcnt lgkmcnt(0)
    v_mfma_f32_16x16x32_bf16 v[16:19], v[48:51], v[80:83], v[16:19]
    ds_read_b64 v[112:113], v2 offset:320
    buffer_load_dwordx4 a[96:99], v4, s[28:31], s3 offen offset:2048 sc1
    v_mfma_f32_16x16x32_bf16 v[20:23], v[48:51], v[84:87], v[20:23]
    ds_read_b64 v[114:115], v2 offset:328
    v_mfma_f32_16x16x32_bf16 v[24:27], v[48:51], v[88:91], v[24:27]
    ds_read_b128 v[144:147], v3 offset:3904
    v_mfma_f32_16x16x32_bf16 v[28:31], v[48:51], v[92:95], v[28:31]
    ds_read_b128 v[148:151], v3 offset:3392
    v_mfma_f32_16x16x32_bf16 v[32:35], v[48:51], v[96:99], v[32:35]
    ds_read_b128 v[152:155], v3 offset:2880
    buffer_load_dwordx4 a[112:115], v4, s[28:31], s3 offen offset:3072 sc1
    v_mfma_f32_16x16x32_bf16 v[36:39], v[48:51], v[100:103], v[36:39]
    ds_read_b128 v[156:159], v3 offset:2368
    s_add_u32 s3, s70, 24576
    v_mfma_f32_16x16x32_bf16 v[40:43], v[48:51], v[104:107], v[40:43]
    ds_read_b128 v[160:163], v3 offset:1856
    v_mfma_f32_16x16x32_bf16 v[44:47], v[48:51], v[108:111], v[44:47]
    ds_read_b128 v[164:167], v3 offset:1344
    v_mfma_f32_16x16x32_bf16 v[20:23], v[52:55], v[80:83], v[20:23]
    ds_read_b128 v[168:171], v3 offset:832
    buffer_load_dwordx4 a[68:71], v4, s[28:31], s3 offen offset:0 sc1
    v_mfma_f32_16x16x32_bf16 v[24:27], v[52:55], v[84:87], v[24:27]
    ds_read_b128 v[172:175], v3 offset:320
    v_mfma_f32_16x16x32_bf16 v[28:31], v[52:55], v[88:91], v[28:31]
    ds_read_b64 v[116:117], v2 offset:832
    v_mfma_f32_16x16x32_bf16 v[32:35], v[52:55], v[92:95], v[32:35]
    ds_read_b64 v[118:119], v2 offset:840
    v_mfma_f32_16x16x32_bf16 v[36:39], v[52:55], v[96:99], v[36:39]
    ds_read_b64 v[120:121], v2 offset:1344
    buffer_load_dwordx4 a[84:87], v4, s[28:31], s3 offen offset:1024 sc1
    v_mfma_f32_16x16x32_bf16 v[40:43], v[52:55], v[100:103], v[40:43]
    ds_read_b64 v[122:123], v2 offset:1352
    v_mfma_f32_16x16x32_bf16 v[44:47], v[52:55], v[104:107], v[44:47]
    ds_read_b64 v[124:125], v2 offset:1856
    v_mfma_f32_16x16x32_bf16 v[24:27], v[56:59], v[80:83], v[24:27]
    ds_read_b64 v[126:127], v2 offset:1864
    v_mfma_f32_16x16x32_bf16 v[28:31], v[56:59], v[84:87], v[28:31]
    ds_read_b64 v[128:129], v2 offset:2368
    buffer_load_dwordx4 a[100:103], v4, s[28:31], s3 offen offset:2048 sc1
    v_mfma_f32_16x16x32_bf16 v[32:35], v[56:59], v[88:91], v[32:35]
    ds_read_b64 v[130:131], v2 offset:2376
    v_mfma_f32_16x16x32_bf16 v[36:39], v[56:59], v[92:95], v[36:39]
    ds_read_b64 v[132:133], v2 offset:2880
    v_mfma_f32_16x16x32_bf16 v[40:43], v[56:59], v[96:99], v[40:43]
    ds_read_b64 v[134:135], v2 offset:2888
    v_mfma_f32_16x16x32_bf16 v[44:47], v[56:59], v[100:103], v[44:47]
    ds_read_b64 v[136:137], v2 offset:3392
    buffer_load_dwordx4 a[116:119], v4, s[28:31], s3 offen offset:3072 sc1
    v_mfma_f32_16x16x32_bf16 v[28:31], v[60:63], v[80:83], v[28:31]
    ds_read_b64 v[138:139], v2 offset:3400
    s_add_u32 s3, s70, 45056
    v_mfma_f32_16x16x32_bf16 v[32:35], v[60:63], v[84:87], v[32:35]
    ds_read_b64 v[140:141], v2 offset:3904
    v_mfma_f32_16x16x32_bf16 v[36:39], v[60:63], v[88:91], v[36:39]
    ds_read_b64 v[142:143], v2 offset:3912
    v_mfma_f32_16x16x32_bf16 v[40:43], v[60:63], v[92:95], v[40:43]
    buffer_load_dwordx4 a[72:75], v4, s[28:31], s3 offen offset:0 sc1
    v_mfma_f32_16x16x32_bf16 v[44:47], v[60:63], v[96:99], v[44:47]
    v_mfma_f32_16x16x32_bf16 v[32:35], v[64:67], v[80:83], v[32:35]
    v_mfma_f32_16x16x32_bf16 v[36:39], v[64:67], v[84:87], v[36:39]
    v_mfma_f32_16x16x32_bf16 v[40:43], v[64:67], v[88:91], v[40:43]
    buffer_load_dwordx4 a[88:91], v4, s[28:31], s3 offen offset:1024 sc1
    v_mfma_f32_16x16x32_bf16 v[44:47], v[64:67], v[92:95], v[44:47]
    v_mfma_f32_16x16x32_bf16 v[36:39], v[68:71], v[80:83], v[36:39]
    v_mfma_f32_16x16x32_bf16 v[40:43], v[68:71], v[84:87], v[40:43]
    v_mfma_f32_16x16x32_bf16 v[44:47], v[68:71], v[88:91], v[44:47]
    buffer_load_dwordx4 a[104:107], v4, s[28:31], s3 offen offset:2048 sc1
    v_mfma_f32_16x16x32_bf16 v[40:43], v[72:75], v[80:83], v[40:43]
    v_mfma_f32_16x16x32_bf16 v[44:47], v[72:75], v[84:87], v[44:47]
    v_mfma_f32_16x16x32_bf16 v[44:47], v[76:79], v[80:83], v[44:47]
    s_waitcnt lgkmcnt(0)
    v_mfma_f32_16x16x32_bf16 v[16:19], v[112:115], v[144:147], v[16:19]
    ds_read_b64 v[48:49], v2 offset:384
    buffer_load_dwordx2 v[202:203], v6, s[12:15], 0 offen sc1
    v_mfma_f32_16x16x32_bf16 v[20:23], v[112:115], v[148:151], v[20:23]
    ds_read_b64 v[50:51], v2 offset:392
    v_mfma_f32_16x16x32_bf16 v[24:27], v[112:115], v[152:155], v[24:27]
    ds_read_b128 v[80:83], v3 offset:3968
    v_mfma_f32_16x16x32_bf16 v[28:31], v[112:115], v[156:159], v[28:31]
    ds_read_b128 v[84:87], v3 offset:3456
    v_mfma_f32_16x16x32_bf16 v[32:35], v[112:115], v[160:163], v[32:35]
    ds_read_b128 v[88:91], v3 offset:2944
    buffer_load_dwordx4 a[120:123], v4, s[28:31], s3 offen offset:3072 sc1
    v_mfma_f32_16x16x32_bf16 v[36:39], v[112:115], v[164:167], v[36:39]
    ds_read_b128 v[92:95], v3 offset:2432
    s_add_u32 s3, s71, 4096
    v_mfma_f32_16x16x32_bf16 v[40:43], v[112:115], v[168:171], v[40:43]
    ds_read_b128 v[96:99], v3 offset:1920
    v_mfma_f32_16x16x32_bf16 v[44:47], v[112:115], v[172:175], v[44:47]
    ds_read_b128 v[100:103], v3 offset:1408
    v_mfma_f32_16x16x32_bf16 v[20:23], v[116:119], v[144:147], v[20:23]
    ds_read_b128 v[104:107], v3 offset:896
    buffer_load_dwordx4 a[76:79], v4, s[28:31], s3 offen offset:0 sc1
    v_mfma_f32_16x16x32_bf16 v[24:27], v[116:119], v[148:151], v[24:27]
    ds_read_b128 v[108:111], v3 offset:384
    v_mfma_f32_16x16x32_bf16 v[28:31], v[116:119], v[152:155], v[28:31]
    ds_read_b64 v[52:53], v2 offset:896
    v_mfma_f32_16x16x32_bf16 v[32:35], v[116:119], v[156:159], v[32:35]
    ds_read_b64 v[54:55], v2 offset:904
    v_mfma_f32_16x16x32_bf16 v[36:39], v[116:119], v[160:163], v[36:39]
    ds_read_b64 v[56:57], v2 offset:1408
    buffer_load_dwordx4 a[92:95], v4, s[28:31], s3 offen offset:1024 sc1
    v_mfma_f32_16x16x32_bf16 v[40:43], v[116:119], v[164:167], v[40:43]
    ds_read_b64 v[58:59], v2 offset:1416
    v_mfma_f32_16x16x32_bf16 v[44:47], v[116:119], v[168:171], v[44:47]
    ds_read_b64 v[60:61], v2 offset:1920
    v_mfma_f32_16x16x32_bf16 v[24:27], v[120:123], v[144:147], v[24:27]
    ds_read_b64 v[62:63], v2 offset:1928
    v_mfma_f32_16x16x32_bf16 v[28:31], v[120:123], v[148:151], v[28:31]
    ds_read_b64 v[64:65], v2 offset:2432
    buffer_load_dwordx4 a[108:111], v4, s[28:31], s3 offen offset:2048 sc1
    v_mfma_f32_16x16x32_bf16 v[32:35], v[120:123], v[152:155], v[32:35]
    ds_read_b64 v[66:67], v2 offset:2440
    v_mfma_f32_16x16x32_bf16 v[36:39], v[120:123], v[156:159], v[36:39]
    ds_read_b64 v[68:69], v2 offset:2944
    v_mfma_f32_16x16x32_bf16 v[40:43], v[120:123], v[160:163], v[40:43]
    ds_read_b64 v[70:71], v2 offset:2952
    v_mfma_f32_16x16x32_bf16 v[44:47], v[120:123], v[164:167], v[44:47]
    ds_read_b64 v[72:73], v2 offset:3456
    buffer_load_dwordx4 a[124:127], v4, s[28:31], s3 offen offset:3072 sc1
    v_mfma_f32_16x16x32_bf16 v[28:31], v[124:127], v[144:147], v[28:31]
    ds_read_b64 v[74:75], v2 offset:3464
    s_add_u32 s3, s70, 8192
    v_mfma_f32_16x16x32_bf16 v[32:35], v[124:127], v[148:151], v[32:35]
    ds_read_b64 v[76:77], v2 offset:3968
    v_mfma_f32_16x16x32_bf16 v[36:39], v[124:127], v[152:155], v[36:39]
    ds_read_b64 v[78:79], v2 offset:3976
    v_mfma_f32_16x16x32_bf16 v[40:43], v[124:127], v[156:159], v[40:43]
    buffer_load_dwordx4 a[128:131], v4, s[28:31], s3 offen offset:0 sc1
    v_mfma_f32_16x16x32_bf16 v[44:47], v[124:127], v[160:163], v[44:47]
    v_mfma_f32_16x16x32_bf16 v[32:35], v[128:131], v[144:147], v[32:35]
    v_mfma_f32_16x16x32_bf16 v[36:39], v[128:131], v[148:151], v[36:39]
    v_mfma_f32_16x16x32_bf16 v[40:43], v[128:131], v[152:155], v[40:43]
    buffer_load_dwordx4 a[144:147], v4, s[28:31], s3 offen offset:1024 sc1
    v_mfma_f32_16x16x32_bf16 v[44:47], v[128:131], v[156:159], v[44:47]
    v_mfma_f32_16x16x32_bf16 v[36:39], v[132:135], v[144:147], v[36:39]
    v_mfma_f32_16x16x32_bf16 v[40:43], v[132:135], v[148:151], v[40:43]
    v_mfma_f32_16x16x32_bf16 v[44:47], v[132:135], v[152:155], v[44:47]
    buffer_load_dwordx4 a[160:163], v4, s[28:31], s3 offen offset:2048 sc1
    v_mfma_f32_16x16x32_bf16 v[40:43], v[136:139], v[144:147], v[40:43]
    v_mfma_f32_16x16x32_bf16 v[44:47], v[136:139], v[148:151], v[44:47]
    v_mfma_f32_16x16x32_bf16 v[44:47], v[140:143], v[144:147], v[44:47]
    s_waitcnt vmcnt(8)
    v_cmp_eq_u64 vcc, s[8:9], v[202:203]
    s_cmp_eq_u64 vcc, exec
    s_cbranch_scc1 L_pok_8
    s_mov_b32 s10, 0
L_plp_9:
    s_sleep 1
    buffer_load_dwordx2 v[202:203], v6, s[12:15], 0 offen sc1
    s_add_u32 s10, s10, 1
    s_waitcnt vmcnt(0)
    v_cmp_eq_u64 vcc, s[8:9], v[202:203]
    s_cmp_eq_u64 vcc, exec
    s_cbranch_scc1 L_pok_8
    s_cmp_lt_u32 s10, 40000
    s_cbranch_scc1 L_plp_9
L_pok_8:
    s_barrier
    s_waitcnt lgkmcnt(0)
    v_mfma_f32_16x16x32_bf16 v[16:19], v[48:51], v[80:83], v[16:19]
    ds_read_b64 v[112:113], v2 offset:448
    s_lshl_b32 s72, s4, 12
    v_mfma_f32_16x16x32_bf16 v[20:23], v[48:51], v[84:87], v[20:23]
    ds_read_b64 v[114:115], v2 offset:456
    s_add_u32 m0, s72, 138240
    v_mfma_f32_16x16x32_bf16 v[24:27], v[48:51], v[88:91], v[24:27]
    ds_read_b128 v[144:147], v3 offset:4032
    s_add_u32 s72, s72, 13631488
    v_mfma_f32_16x16x32_bf16 v[28:31], v[48:51], v[92:95], v[28:31]
    ds_read_b128 v[148:151], v3 offset:3520
    buffer_load_dwordx4 v15, s[12:15], s72 offen offset:0 sc1 lds
    v_mfma_f32_16x16x32_bf16 v[32:35], v[48:51], v[96:99], v[32:35]
    ds_read_b128 v[152:155], v3 offset:3008
    v_mfma_f32_16x16x32_bf16 v[36:39], v[48:51], v[100:103], v[36:39]
    ds_read_b128 v[156:159], v3 offset:2496
    v_mfma_f32_16x16x32_bf16 v[40:43], v[48:51], v[104:107], v[40:43]
    ds_read_b128 v[160:163], v3 offset:1984
    v_mfma_f32_16x16x32_bf16 v[44:47], v[48:51], v[108:111], v[44:47]
    ds_read_b128 v[164:167], v3 offset:1472
    buffer_load_dwordx4 v15, s[12:15], s72 offen offset:1024 sc1 lds
    v_mfma_f32_16x16x32_bf16 v[20:23], v[52:55], v[80:83], v[20:23]
    ds_read_b128 v[168:171], v3 offset:960
    v_mfma_f32_16x16x32_bf16 v[24:27], v[52:55], v[84:87], v[24:27]
    ds_read_b128 v[172:175], v3 offset:448
    v_mfma_f32_16x16x32_bf16 v[28:31], v[52:55], v[88:91], v[28:31]
    ds_read_b64 v[116:117], v2 offset:960
    v_mfma_f32_16x16x32_bf16 v[32:35], v[52:55], v[92:95], v[32:35]
    ds_read_b64 v[118:119], v2 offset:968
    buffer_load_dwordx4 v15, s[12:15], s72 offen offset:2048 sc1 lds
    v_mfma_f32_16x16x32_bf16 v[36:39], v[52:55], v[96:99], v[36:39]
    ds_read_b64 v[120:121], v2 offset:1472
    v_mfma_f32_16x16x32_bf16 v[40:43], v[52:55], v[100:103], v[40:43]
    ds_read_b64 v[122:123], v2 offset:1480
    v_mfma_f32_16x16x32_bf16 v[44:47], v[52:55], v[104:107], v[44:47]
    ds_read_b64 v[124:125], v2 offset:1984
    v_mfma_f32_16x16x32_bf16 v[24:27], v[56:59], v[80:83], v[24:27]
    ds_read_b64 v[126:127], v2 offset:1992
    buffer_load_dwordx4 v15, s[12:15], s72 offen offset:3072 sc1 lds
    v_mfma_f32_16x16x32_bf16 v[28:31], v[56:59], v[84:87], v[28:31]
    ds_read_b64 v[128:129], v2 offset:2496
    s_lshl_b32 s73, s78, 4
    v_mfma_f32_16x16x32_bf16 v[32:35], v[56:59], v[88:91], v[32:35]
    ds_read_b64 v[130:131], v2 offset:2504
    s_add_u32 s73, s73, 13959168
    v_mfma_f32_16x16x32_bf16 v[36:39], v[56:59], v[92:95], v[36:39]
    ds_read_b64 v[132:133], v2 offset:3008
    v_mfma_f32_16x16x32_bf16 v[40:43], v[56:59], v[96:99], v[40:43]
    ds_read_b64 v[134:135], v2 offset:3016
    buffer_load_dwordx4 v[196:199], off, s[12:15], s73 sc1
    v_mfma_f32_16x16x32_bf16 v[44:47], v[56:59], v[100:103], v[44:47]
    ds_read_b64 v[136:137], v2 offset:3520
    v_mfma_f32_16x16x32_bf16 v[28:31], v[60:63], v[80:83], v[28:31]
    ds_read_b64 v[138:139], v2 offset:3528
    v_mfma_f32_16x16x32_bf16 v[32:35], v[60:63], v[84:87], v[32:35]
    ds_read_b64 v[140:141], v2 offset:4032
    v_mfma_f32_16x16x32_bf16 v[36:39], v[60:63], v[88:91], v[36:39]
    ds_read_b64 v[142:143], v2 offset:4040
    buffer_load_dwordx4 v[176:179], v7, s[12:15], 0 offen offset:0 sc1
    v_mfma_f32_16x16x32_bf16 v[40:43], v[60:63], v[92:95], v[40:43]
    v_mfma_f32_16x16x32_bf16 v[44:47], v[60:63], v[96:99], v[44:47]
    v_mfma_f32_16x16x32_bf16 v[32:35], v[64:67], v[80:83], v[32:35]
    v_mfma_f32_16x16x32_bf16 v[36:39], v[64:67], v[84:87], v[36:39]
    buffer_load_dwordx4 v[180:183], v7, s[12:15], 0 offen offset:1024 sc1
    v_mfma_f32_16x16x32_bf16 v[40:43], v[64:67], v[88:91], v[40:43]
    v_mfma_f32_16x16x32_bf16 v[44:47], v[64:67], v[92:95], v[44:47]
    v_mfma_f32_16x16x32_bf16 v[36:39], v[68:71], v[80:83], v[36:39]
    v_mfma_f32_16x16x32_bf16 v[40:43], v[68:71], v[84:87], v[40:43]
    buffer_load_dwordx4 v[184:187], v7, s[12:15], 0 offen offset:2048 sc1
    v_mfma_f32_16x16x32_bf16 v[44:47], v[68:71], v[88:91], v[44:47]
    v_mfma_f32_16x16x32_bf16 v[40:43], v[72:75], v[80:83], v[40:43]
    v_mfma_f32_16x16x32_bf16 v[44:47], v[72:75], v[84:87], v[44:47]
    v_mfma_f32_16x16x32_bf16 v[44:47], v[76:79], v[80:83], v[44:47]
    buffer_load_dwordx4 v[188:191], v7, s[12:15], 0 offen offset:3072 sc1
    s_waitcnt lgkmcnt(0)
    v_mfma_f32_16x16x32_bf16 v[16:19], v[112:115], v[144:147], v[16:19]
    buffer_load_dwordx4 a[176:179], v4, s[28:31], s3 offen offset:3072 sc1
    s_add_u32 s3, s70, 28672
    v_mfma_f32_16x16x32_bf16 v[20:23], v[112:115], v[148:151], v[20:23]
    v_mfma_f32_16x16x32_bf16 v[24:27], v[112:115], v[152:155], v[24:27]
    v_mfma_f32_16x16x32_bf16 v[28:31], v[112:115], v[156:159], v[28:31]
    v_mfma_f32_16x16x32_bf16 v[32:35], v[112:115], v[160:163], v[32:35]
    buffer_load_dwordx4 a[132:135], v4, s[28:31], s3 offen offset:0 sc1
    v_mfma_f32_16x16x32_bf16 v[36:39], v[112:115], v[164:167], v[36:39]
    v_mfma_f32_16x16x32_bf16 v[40:43], v[112:115], v[168:171], v[40:43]
    v_mfma_f32_16x16x32_bf16 v[44:47], v[112:115], v[172:175], v[44:47]
    v_mfma_f32_16x16x32_bf16 v[20:23], v[116:119], v[144:147], v[20:23]
    buffer_load_dwordx4 a[148:151], v4, s[28:31], s3 offen offset:1024 sc1
    v_mfma_f32_16x16x32_bf16 v[24:27], v[116:119], v[148:151], v[24:27]
    v_mfma_f32_16x16x32_bf16 v[28:31], v[116:119], v[152:155], v[28:31]
    v_mfma_f32_16x16x32_bf16 v[32:35], v[116:119], v[156:159], v[32:35]
    v_mfma_f32_16x16x32_bf16 v[36:39], v[116:119], v[160:163], v[36:39]
    buffer_load_dwordx4 a[164:167], v4, s[28:31], s3 offen offset:2048 sc1
    v_mfma_f32_16x16x32_bf16 v[40:43], v[116:119], v[164:167], v[40:43]
    v_mfma_f32_16x16x32_bf16 v[44:47], v[116:119], v[168:171], v[44:47]
    v_mfma_f32_16x16x32_bf16 v[24:27], v[120:123], v[144:147], v[24:27]
    v_mfma_f32_16x16x32_bf16 v[28:31], v[120:123], v[148:151], v[28:31]
    buffer_load_dwordx4 a[180:183], v4, s[28:31], s3 offen offset:3072 sc1
    s_add_u32 s3, s70, 49152
    v_mfma_f32_16x16x32_bf16 v[32:35], v[120:123], v[152:155], v[32:35]
    v_mfma_f32_16x16x32_bf16 v[36:39], v[120:123], v[156:159], v[36:39]
    v_mfma_f32_16x16x32_bf16 v[40:43], v[120:123], v[160:163], v[40:43]
    v_mfma_f32_16x16x32_bf16 v[44:47], v[120:123], v[164:167], v[44:47]
    buffer_load_dwordx4 a[136:139], v4, s[28:31], s3 offen offset:0 sc1
    v_mfma_f32_16x16x32_bf16 v[28:31], v[124:127], v[144:147], v[28:31]
    v_mfma_f32_16x16x32_bf16 v[32:35], v[124:127], v[148:151], v[32:35]
    v_mfma_f32_16x16x32_bf16 v[36:39], v[124:127], v[152:155], v[36:39]
    v_mfma_f32_16x16x32_bf16 v[40:43], v[124:127], v[156:159], v[40:43]
    buffer_load_dwordx4 a[152:155], v4, s[28:31], s3 offen offset:1024 sc1
    v_mfma_f32_16x16x32_bf16 v[44:47], v[124:127], v[160:163], v[44:47]
    v_mfma_f32_16x16x32_bf16 v[32:35], v[128:131], v[144:147], v[32:35]
    v_mfma_f32_16x16x32_bf16 v[36:39], v[128:131], v[148:151], v[36:39]
    v_mfma_f32_16x16x32_bf16 v[40:43], v[128:131], v[152:155], v[40:43]
    buffer_load_dwordx4 a[168:171], v4, s[28:31], s3 offen offset:2048 sc1
    v_mfma_f32_16x16x32_bf16 v[44:47], v[128:131], v[156:159], v[44:47]
    v_mfma_f32_16x16x32_bf16 v[36:39], v[132:135], v[144:147], v[36:39]
    v_mfma_f32_16x16x32_bf16 v[40:43], v[132:135], v[148:151], v[40:43]
    v_mfma_f32_16x16x32_bf16 v[44:47], v[132:135], v[152:155], v[44:47]
    buffer_load_dwordx4 a[184:187], v4, s[28:31], s3 offen offset:3072 sc1
    v_mfma_f32_16x16x32_bf16 v[40:43], v[136:139], v[144:147], v[40:43]
    v_mfma_f32_16x16x32_bf16 v[44:47], v[136:139], v[148:151], v[44:47]
    v_mfma_f32_16x16x32_bf16 v[44:47], v[140:143], v[144:147], v[44:47]
    s_waitcnt vmcnt(9)
    s_barrier
    ds_read_b128 v[200:203], v8 offset:3072
    ds_read_b128 v[204:207], v9 offset:0
    ds_read_b128 v[212:215], v9 offset:8192
    ds_read_b128 v[208:211], v13 offset:0
    ds_read_b128 v[216:219], v13 offset:8192
    v_lshlrev_b32 v193, 16, v192
    v_lshrrev_b32 v240, 16, v199
    v_and_b32 v241, 0xffff0000, v199
    v_mul_f32 v194, v198, v197
    v_mul_f32 v195, v198, v196
    v_add_u32 v6, s76, v12
    s_add_u32 s10, s79, 10485760
    v_add_u32 v14, s10, v12
    v_and_b32 v15, 7, v10
    v_lshlrev_b32 v15, 5, v15
    v_lshrrev_b32 v5, 1, v11
    v_lshl_add_u32 v15, v5, 4, v15
    v_and_b32 v5, 1, v11
    v_lshrrev_b32 v7, 3, v10
    v_lshl_add_u32 v7, v5, 1, v7
    v_mul_u32_u24 v7, 164096, v7
    s_lshl_b32 s10, s78, 8
    s_add_u32 s10, s10, 7340032
    v_add3_u32 v15, v15, v7, s10
    v_permlane16_swap_b32 v16, v20
    v_permlane16_swap_b32 v17, v21
    v_permlane16_swap_b32 v18, v22
    v_permlane16_swap_b32 v19, v23
    ds_read_b128 v[220:223], v8 offset:2048
    ds_read_b128 v[224:227], v9 offset:2048
    ds_read_b128 v[232:235], v9 offset:10240
    ds_read_b128 v[228:231], v13 offset:2048
    ds_read_b128 v[236:239], v13 offset:10240
    v_lshlrev_b32 v242, 16, v176
    v_and_b32 v243, 0xffff0000, v176
    v_lshlrev_b32 v244, 16, v177
    v_and_b32 v245, 0xffff0000, v177
    v_lshlrev_b32 v246, 16, v178
    v_and_b32 v247, 0xffff0000, v178
    v_lshlrev_b32 v248, 16, v179
    v_and_b32 v249, 0xffff0000, v179
    s_waitcnt lgkmcnt(5)
    v_pk_fma_f32 v[112:113], v[242:243], v[204:205], v[212:213] neg_lo:[0,0,1] neg_hi:[0,0,1]
    v_pk_fma_f32 v[114:115], v[244:245], v[206:207], v[214:215] neg_lo:[0,0,1] neg_hi:[0,0,1]
    v_pk_fma_f32 v[116:117], v[246:247], v[208:209], v[216:217] neg_lo:[0,0,1] neg_hi:[0,0,1]
    v_pk_fma_f32 v[118:119], v[248:249], v[210:211], v[218:219] neg_lo:[0,0,1] neg_hi:[0,0,1]
    v_dot2_f32_bf16 v16, v203, v193, v16
    v_dot2_f32_bf16 v17, v203, v192, v17
    v_dot2_f32_bf16 v18, v202, v193, v18
    v_dot2_f32_bf16 v19, v202, v192, v19
    v_dot2_f32_bf16 v20, v201, v193, v20
    v_dot2_f32_bf16 v21, v201, v192, v21
    v_dot2_f32_bf16 v22, v200, v193, v22
    v_dot2_f32_bf16 v23, v200, v192, v23
    v_pk_fma_f32 v[112:113], v[112:113], v[194:195], v[194:195] op_sel:[0,0,1] op_sel_hi:[1,0,1]
    v_pk_fma_f32 v[114:115], v[114:115], v[194:195], v[194:195] op_sel:[0,0,1] op_sel_hi:[1,0,1]
    v_pk_fma_f32 v[116:117], v[116:117], v[194:195], v[194:195] op_sel:[0,0,1] op_sel_hi:[1,0,1]
    v_pk_fma_f32 v[118:119], v[118:119], v[194:195], v[194:195] op_sel:[0,0,1] op_sel_hi:[1,0,1]
    v_pk_fma_f32 v[112:113], v[16:17], v[112:113], v[242:243]
    v_pk_fma_f32 v[114:115], v[18:19], v[114:115], v[244:245]
    v_pk_fma_f32 v[116:117], v[20:21], v[116:117], v[246:247]
    v_pk_fma_f32 v[118:119], v[22:23], v[118:119], v[248:249]
    v_cvt_pk_bf16_f32 v48, v112, v113
    v_cvt_pk_bf16_f32 v49, v114, v115
    v_cvt_pk_bf16_f32 v50, v116, v117
    v_cvt_pk_bf16_f32 v51, v118, v119
    ds_write_b128 v6, v[48:51] offset:0
    v_dot2_f32_bf16 v112, v48, v240, 0
    v_dot2_f32_bf16 v113, v48, v241, 0
    v_dot2_f32_bf16 v114, v49, v240, 0
    v_dot2_f32_bf16 v115, v49, v241, 0
    v_dot2_f32_bf16 v116, v50, v240, 0
    v_dot2_f32_bf16 v117, v50, v241, 0
    v_dot2_f32_bf16 v118, v51, v240, 0
    v_dot2_f32_bf16 v119, v51, v241, 0
    v_cvt_pk_bf16_f32 v52, v112, v113
    v_cvt_pk_bf16_f32 v53, v114, v115
    v_cvt_pk_bf16_f32 v54, v116, v117
    v_cvt_pk_bf16_f32 v55, v118, v119
    buffer_store_dwordx4 v[52:55], v15, s[12:15], 0 offen sc1
    buffer_store_dwordx4 v[48:51], v14, s[12:15], 0 offen offset:0 sc1
    v_permlane16_swap_b32 v24, v28
    v_permlane16_swap_b32 v25, v29
    v_permlane16_swap_b32 v26, v30
    v_permlane16_swap_b32 v27, v31
    ds_read_b128 v[200:203], v8 offset:1024
    ds_read_b128 v[204:207], v9 offset:4096
    ds_read_b128 v[212:215], v9 offset:12288
    ds_read_b128 v[208:211], v13 offset:4096
    ds_read_b128 v[216:219], v13 offset:12288
    v_lshlrev_b32 v242, 16, v180
    v_and_b32 v243, 0xffff0000, v180
    v_lshlrev_b32 v244, 16, v181
    v_and_b32 v245, 0xffff0000, v181
    v_lshlrev_b32 v246, 16, v182
    v_and_b32 v247, 0xffff0000, v182
    v_lshlrev_b32 v248, 16, v183
    v_and_b32 v249, 0xffff0000, v183
    s_waitcnt lgkmcnt(5)
    v_pk_fma_f32 v[112:113], v[242:243], v[224:225], v[232:233] neg_lo:[0,0,1] neg_hi:[0,0,1]
    v_pk_fma_f32 v[114:115], v[244:245], v[226:227], v[234:235] neg_lo:[0,0,1] neg_hi:[0,0,1]
    v_pk_fma_f32 v[116:117], v[246:247], v[228:229], v[236:237] neg_lo:[0,0,1] neg_hi:[0,0,1]
    v_pk_fma_f32 v[118:119], v[248:249], v[230:231], v[238:239] neg_lo:[0,0,1] neg_hi:[0,0,1]
    v_dot2_f32_bf16 v24, v223, v193, v24
    v_dot2_f32_bf16 v25, v223, v192, v25
    v_dot2_f32_bf16 v26, v222, v193, v26
    v_dot2_f32_bf16 v27, v222, v192, v27
    v_dot2_f32_bf16 v28, v221, v193, v28
    v_dot2_f32_bf16 v29, v221, v192, v29
    v_dot2_f32_bf16 v30, v220, v193, v30
    v_dot2_f32_bf16 v31, v220, v192, v31
    v_pk_fma_f32 v[112:113], v[112:113], v[194:195], v[194:195] op_sel:[0,0,1] op_sel_hi:[1,0,1]
    v_pk_fma_f32 v[114:115], v[114:115], v[194:195], v[194:195] op_sel:[0,0,1] op_sel_hi:[1,0,1]
    v_pk_fma_f32 v[116:117], v[116:117], v[194:195], v[194:195] op_sel:[0,0,1] op_sel_hi:[1,0,1]
    v_pk_fma_f32 v[118:119], v[118:119], v[194:195], v[194:195] op_sel:[0,0,1] op_sel_hi:[1,0,1]
    v_pk_fma_f32 v[112:113], v[24:25], v[112:113], v[242:243]
    v_pk_fma_f32 v[114:115], v[26:27], v[114:115], v[244:245]
    v_pk_fma_f32 v[116:117], v[28:29], v[116:117], v[246:247]
    v_pk_fma_f32 v[118:119], v[30:31], v[118:119], v[248:249]
    v_cvt_pk_bf16_f32 v56, v112, v113
    v_cvt_pk_bf16_f32 v57, v114, v115
    v_cvt_pk_bf16_f32 v58, v116, v117
    v_cvt_pk_bf16_f32 v59, v118, v119
    ds_write_b128 v6, v[56:59] offset:1024
    v_dot2_f32_bf16 v112, v56, v240, 0
    v_dot2_f32_bf16 v113, v56, v241, 0
    v_dot2_f32_bf16 v114, v57, v240, 0
    v_dot2_f32_bf16 v115, v57, v241, 0
    v_dot2_f32_bf16 v116, v58, v240, 0
    v_dot2_f32_bf16 v117, v58, v241, 0
    v_dot2_f32_bf16 v118, v59, v240, 0
    v_dot2_f32_bf16 v119, v59, v241, 0
    v_cvt_pk_bf16_f32 v60, v112, v113
    v_cvt_pk_bf16_f32 v61, v114, v115
    v_cvt_pk_bf16_f32 v62, v116, v117
    v_cvt_pk_bf16_f32 v63, v118, v119
    s_mov_b32 s10, 656384
    buffer_store_dwordx4 v[60:63], v15, s[12:15], s10 offen sc1
    buffer_store_dwordx4 v[56:59], v14, s[12:15], 0 offen offset:1024 sc1
    v_permlane16_swap_b32 v32, v36
    v_permlane16_swap_b32 v33, v37
    v_permlane16_swap_b32 v34, v38
    v_permlane16_swap_b32 v35, v39
    ds_read_b128 v[220:223], v8 offset:0
    ds_read_b128 v[224:227], v9 offset:6144
    ds_read_b128 v[232:235], v9 offset:14336
    ds_read_b128 v[228:231], v13 offset:6144
    ds_read_b128 v[236:239], v13 offset:14336
    v_lshlrev_b32 v242, 16, v184
    v_and_b32 v243, 0xffff0000, v184
    v_lshlrev_b32 v244, 16, v185
    v_and_b32 v245, 0xffff0000, v185
    v_lshlrev_b32 v246, 16, v186
    v_and_b32 v247, 0xffff0000, v186
    v_lshlrev_b32 v248, 16, v187
    v_and_b32 v249, 0xffff0000, v187
    s_waitcnt lgkmcnt(5)
    v_pk_fma_f32 v[112:113], v[242:243], v[204:205], v[212:213] neg_lo:[0,0,1] neg_hi:[0,0,1]
    v_pk_fma_f32 v[114:115], v[244:245], v[206:207], v[214:215] neg_lo:[0,0,1] neg_hi:[0,0,1]
    v_pk_fma_f32 v[116:117], v[246:247], v[208:209], v[216:217] neg_lo:[0,0,1] neg_hi:[0,0,1]
    v_pk_fma_f32 v[118:119], v[248:249], v[210:211], v[218:219] neg_lo:[0,0,1] neg_hi:[0,0,1]
    v_dot2_f32_bf16 v32, v203, v193, v32
    v_dot2_f32_bf16 v33, v203, v192, v33
    v_dot2_f32_bf16 v34, v202, v193, v34
    v_dot2_f32_bf16 v35, v202, v192, v35
    v_dot2_f32_bf16 v36, v201, v193, v36
    v_dot2_f32_bf16 v37, v201, v192, v37
    v_dot2_f32_bf16 v38, v200, v193, v38
    v_dot2_f32_bf16 v39, v200, v192, v39
    v_pk_fma_f32 v[112:113], v[112:113], v[194:195], v[194:195] op_sel:[0,0,1] op_sel_hi:[1,0,1]
    v_pk_fma_f32 v[114:115], v[114:115], v[194:195], v[194:195] op_sel:[0,0,1] op_sel_hi:[1,0,1]
    v_pk_fma_f32 v[116:117], v[116:117], v[194:195], v[194:195] op_sel:[0,0,1] op_sel_hi:[1,0,1]
    v_pk_fma_f32 v[118:119], v[118:119], v[194:195], v[194:195] op_sel:[0,0,1] op_sel_hi:[1,0,1]
    v_pk_fma_f32 v[112:113], v[32:33], v[112:113], v[242:243]
    v_pk_fma_f32 v[114:115], v[34:35], v[114:115], v[244:245]
    v_pk_fma_f32 v[116:117], v[36:37], v[116:117], v[246:247]
    v_pk_fma_f32 v[118:119], v[38:39], v[118:119], v[248:249]
    v_cvt_pk_bf16_f32 v64, v112, v113
    v_cvt_pk_bf16_f32 v65, v114, v115
    v_cvt_pk_bf16_f32 v66, v116, v117
    v_cvt_pk_bf16_f32 v67, v118, v119
    ds_write_b128 v6, v[64:67] offset:2048
    v_dot2_f32_bf16 v112, v64, v240, 0
    v_dot2_f32_bf16 v113, v64, v241, 0
    v_dot2_f32_bf16 v114, v65, v240, 0
    v_dot2_f32_bf16 v115, v65, v241, 0
    v_dot2_f32_bf16 v116, v66, v240, 0
    v_dot2_f32_bf16 v117, v66, v241, 0
    v_dot2_f32_bf16 v118, v67, v240, 0
    v_dot2_f32_bf16 v119, v67, v241, 0
    v_cvt_pk_bf16_f32 v68, v112, v113
    v_cvt_pk_bf16_f32 v69, v114, v115
    v_cvt_pk_bf16_f32 v70, v116, v117
    v_cvt_pk_bf16_f32 v71, v118, v119
    s_mov_b32 s10, 1312768
    buffer_store_dwordx4 v[68:71], v15, s[12:15], s10 offen sc1
    buffer_store_dwordx4 v[64:67], v14, s[12:15], 0 offen offset:2048 sc1
    v_permlane16_swap_b32 v40, v44
    v_permlane16_swap_b32 v41, v45
    v_permlane16_swap_b32 v42, v46
    v_permlane16_swap_b32 v43, v47
    v_lshlrev_b32 v242, 16, v188
    v_and_b32 v243, 0xffff0000, v188
    v_lshlrev_b32 v244, 16, v189
    v_and_b32 v245, 0xffff0000, v189
    v_lshlrev_b32 v246, 16, v190
    v_and_b32 v247, 0xffff0000, v190
    v_lshlrev_b32 v248, 16, v191
    v_and_b32 v249, 0xffff0000, v191
    s_waitcnt lgkmcnt(0)
    v_pk_fma_f32 v[112:113], v[242:243], v[224:225], v[232:233] neg_lo:[0,0,1] neg_hi:[0,0,1]
    v_pk_fma_f32 v[114:115], v[244:245], v[226:227], v[234:235] neg_lo:[0,0,1] neg_hi:[0,0,1]
    v_pk_fma_f32 v[116:117], v[246:247], v[228:229], v[236:237] neg_lo:[0,0,1] neg_hi:[0,0,1]
    v_pk_fma_f32 v[118:119], v[248:249], v[230:231], v[238:239] neg_lo:[0,0,1] neg_hi:[0,0,1]
    v_dot2_f32_bf16 v40, v223, v193, v40
    v_dot2_f32_bf16 v41, v223, v192, v41
    v_dot2_f32_bf16 v42, v222, v193, v42
    v_dot2_f32_bf16 v43, v222, v192, v43
    v_dot2_f32_bf16 v44, v221, v193, v44
    v_dot2_f32_bf16 v45, v221, v192, v45
    v_dot2_f32_bf16 v46, v220, v193, v46
    v_dot2_f32_bf16 v47, v220, v192, v47
    v_pk_fma_f32 v[112:113], v[112:113], v[194:195], v[194:195] op_sel:[0,0,1] op_sel_hi:[1,0,1]
    v_pk_fma_f32 v[114:115], v[114:115], v[194:195], v[194:195] op_sel:[0,0,1] op_sel_hi:[1,0,1]
    v_pk_fma_f32 v[116:117], v[116:117], v[194:195], v[194:195] op_sel:[0,0,1] op_sel_hi:[1,0,1]
    v_pk_fma_f32 v[118:119], v[118:119], v[194:195], v[194:195] op_sel:[0,0,1] op_sel_hi:[1,0,1]
    v_pk_fma_f32 v[112:113], v[40:41], v[112:113], v[242:243]
    v_pk_fma_f32 v[114:115], v[42:43], v[114:115], v[244:245]
    v_pk_fma_f32 v[116:117], v[44:45], v[116:117], v[246:247]
    v_pk_fma_f32 v[118:119], v[46:47], v[118:119], v[248:249]
    v_cvt_pk_bf16_f32 v72, v112, v113
    v_cvt_pk_bf16_f32 v73, v114, v115
    v_cvt_pk_bf16_f32 v74, v116, v117
    v_cvt_pk_bf16_f32 v75, v118, v119
    ds_write_b128 v6, v[72:75] offset:3072
    v_dot2_f32_bf16 v112, v72, v240, 0
    v_dot2_f32_bf16 v113, v72, v241, 0
    v_dot2_f32_bf16 v114, v73, v240, 0
    v_dot2_f32_bf16 v115, v73, v241, 0
    v_dot2_f32_bf16 v116, v74, v240, 0
    v_dot2_f32_bf16 v117, v74, v241, 0
    v_dot2_f32_bf16 v118, v75, v240, 0
    v_dot2_f32_bf16 v119, v75, v241, 0
    v_cvt_pk_bf16_f32 v76, v112, v113
    v_cvt_pk_bf16_f32 v77, v114, v115
    v_cvt_pk_bf16_f32 v78, v116, v117
    v_cvt_pk_bf16_f32 v79, v118, v119
    s_mov_b32 s10, 1969152
    buffer_store_dwordx4 v[76:79], v15, s[12:15], s10 offen sc1
    buffer_store_dwordx4 v[72:75], v14, s[12:15], 0 offen offset:3072 sc1
    s_lshl_b32 s10, s4, 10
    v_lshl_add_u32 v10, v1, 2, s10
    v_lshrrev_b32 v11, 3, v1
    s_lshl_b32 s10, s4, 5
    v_add_u32 v11, s10, v11
    v_mul_u32_u24 v11, 160, v11
    v_add_u32 v11, s7, v11
    v_lshlrev_b32 v11, 7, v11
    v_and_b32 v12, 7, v1
    v_lshl_add_u32 v11, v12, 4, v11
    v_add_u32 v11, 14680064, v11
    s_waitcnt lgkmcnt(0)
    s_barrier
    ds_read_b32 v80, v10 offset:0
    ds_read_b32 v81, v10 offset:16640
    ds_read_b32 v82, v10 offset:33280
    ds_read_b32 v83, v10 offset:49920
    ds_read_b32 v84, v10 offset:256
    ds_read_b32 v85, v10 offset:16896
    ds_read_b32 v86, v10 offset:33536
    ds_read_b32 v87, v10 offset:50176
    ds_read_b32 v88, v10 offset:512
    ds_read_b32 v89, v10 offset:17152
    ds_read_b32 v90, v10 offset:33792
    ds_read_b32 v91, v10 offset:50432
    ds_read_b32 v92, v10 offset:768
    ds_read_b32 v93, v10 offset:17408
    ds_read_b32 v94, v10 offset:34048
    ds_read_b32 v95, v10 offset:50688
    s_waitcnt lgkmcnt(12)
    v_lshlrev_b32 v100, 16, v80
    v_and_b32 v101, 0xffff0000, v80
    v_lshlrev_b32 v102, 16, v81
    v_and_b32 v103, 0xffff0000, v81
    v_lshlrev_b32 v104, 16, v82
    v_and_b32 v105, 0xffff0000, v82
    v_lshlrev_b32 v106, 16, v83
    v_and_b32 v107, 0xffff0000, v83
    v_pk_add_f32 v[120:121], v[100:101], v[102:103]
    v_pk_mul_f32 v[122:123], v[100:101], v[100:101]
    v_pk_add_f32 v[120:121], v[120:121], v[104:105]
    v_pk_fma_f32 v[122:123], v[102:103], v[102:103], v[122:123]
    v_pk_add_f32 v[120:121], v[120:121], v[106:107]
    v_pk_fma_f32 v[122:123], v[104:105], v[104:105], v[122:123]
    v_pk_fma_f32 v[122:123], v[106:107], v[106:107], v[122:123]
    buffer_store_dwordx4 v[120:123], v11, s[12:15], 0 offen sc1
    s_waitcnt lgkmcnt(8)
    v_lshlrev_b32 v108, 16, v84
    v_and_b32 v109, 0xffff0000, v84
    v_lshlrev_b32 v110, 16, v85
    v_and_b32 v111, 0xffff0000, v85
    v_lshlrev_b32 v112, 16, v86
    v_and_b32 v113, 0xffff0000, v86
    v_lshlrev_b32 v114, 16, v87
    v_and_b32 v115, 0xffff0000, v87
    v_pk_add_f32 v[124:125], v[108:109], v[110:111]
    v_pk_mul_f32 v[126:127], v[108:109], v[108:109]
    v_pk_add_f32 v[124:125], v[124:125], v[112:113]
    v_pk_fma_f32 v[126:127], v[110:111], v[110:111], v[126:127]
    v_pk_add_f32 v[124:125], v[124:125], v[114:115]
    v_pk_fma_f32 v[126:127], v[112:113], v[112:113], v[126:127]
    v_pk_fma_f32 v[126:127], v[114:115], v[114:115], v[126:127]
    s_mov_b32 s10, 163840
    buffer_store_dwordx4 v[124:127], v11, s[12:15], s10 offen sc1
    s_waitcnt lgkmcnt(4)
    v_lshlrev_b32 v100, 16, v88
    v_and_b32 v101, 0xffff0000, v88
    v_lshlrev_b32 v102, 16, v89
    v_and_b32 v103, 0xffff0000, v89
    v_lshlrev_b32 v104, 16, v90
    v_and_b32 v105, 0xffff0000, v90
    v_lshlrev_b32 v106, 16, v91
    v_and_b32 v107, 0xffff0000, v91
    v_pk_add_f32 v[128:129], v[100:101], v[102:103]
    v_pk_mul_f32 v[130:131], v[100:101], v[100:101]
    v_pk_add_f32 v[128:129], v[128:129], v[104:105]
    v_pk_fma_f32 v[130:131], v[102:103], v[102:103], v[130:131]
    v_pk_add_f32 v[128:129], v[128:129], v[106:107]
    v_pk_fma_f32 v[130:131], v[104:105], v[104:105], v[130:131]
    v_pk_fma_f32 v[130:131], v[106:107], v[106:107], v[130:131]
    s_mov_b32 s10, 327680
    buffer_store_dwordx4 v[128:131], v11, s[12:15], s10 offen sc1
    s_waitcnt lgkmcnt(0)
    v_lshlrev_b32 v108, 16, v92
    v_and_b32 v109, 0xffff0000, v92
    v_lshlrev_b32 v110, 16, v93
    v_and_b32 v111, 0xffff0000, v93
    v_lshlrev_b32 v112, 16, v94
    v_and_b32 v113, 0xffff0000, v94
    v_lshlrev_b32 v114, 16, v95
    v_and_b32 v115, 0xffff0000, v95
    v_pk_add_f32 v[132:133], v[108:109], v[110:111]
    v_pk_mul_f32 v[134:135], v[108:109], v[108:109]
    v_pk_add_f32 v[132:133], v[132:133], v[112:113]
    v_pk_fma_f32 v[134:135], v[110:111], v[110:111], v[134:135]
    v_pk_add_f32 v[132:133], v[132:133], v[114:115]
    v_pk_fma_f32 v[134:135], v[112:113], v[112:113], v[134:135]
    v_pk_fma_f32 v[134:135], v[114:115], v[114:115], v[134:135]
    s_mov_b32 s10, 491520
    buffer_store_dwordx4 v[132:135], v11, s[12:15], s10 offen sc1
    s_waitcnt vmcnt(0)
    s_barrier
    s_cmp_lg_u32 s4, 0
    s_cbranch_scc1 L_post_10
    s_lshl_b32 s10, s7, 7
    s_add_u32 s10, s10, 49152
    v_mov_b32 v10, s8
    v_mov_b32 v11, s9
    s_mov_b64 exec, 1
    buffer_store_dwordx2 v[10:11], off, s[12:15], s10 sc1
    s_mov_b64 exec, -1
L_post_10:
    s_add_u32 s3, s71, 8192
    buffer_load_dwordx4 a[140:143], v4, s[28:31], s3 offen offset:0 sc1
    buffer_load_dwordx4 a[156:159], v4, s[28:31], s3 offen offset:1024 sc1
    buffer_load_dwordx4 a[172:175], v4, s[28:31], s3 offen offset:2048 sc1
    buffer_load_dwordx4 a[188:191], v4, s[28:31], s3 offen offset:3072 sc1
    s_add_u32 s3, s70, 12288
    buffer_load_dwordx4 a[192:195], v4, s[28:31], s3 offen offset:0 sc1
    buffer_load_dwordx4 a[208:211], v4, s[28:31], s3 offen offset:1024 sc1
    buffer_load_dwordx4 a[224:227], v4, s[28:31], s3 offen offset:2048 sc1
    buffer_load_dwordx4 a[240:243], v4, s[28:31], s3 offen offset:3072 sc1
    s_add_u32 s3, s70, 32768
    buffer_load_dwordx4 a[196:199], v4, s[28:31], s3 offen offset:0 sc1
    buffer_load_dwordx4 a[212:215], v4, s[28:31], s3 offen offset:1024 sc1
    buffer_load_dwordx4 a[228:231], v4, s[28:31], s3 offen offset:2048 sc1
    buffer_load_dwordx4 a[244:247], v4, s[28:31], s3 offen offset:3072 sc1
    s_add_u32 s3, s70, 53248
    buffer_load_dwordx4 a[200:203], v4, s[28:31], s3 offen offset:0 sc1
    buffer_load_dwordx4 a[216:219], v4, s[28:31], s3 offen offset:1024 sc1
    buffer_load_dwordx4 a[232:235], v4, s[28:31], s3 offen offset:2048 sc1
    buffer_load_dwordx4 a[248:251], v4, s[28:31], s3 offen offset:3072 sc1
    s_add_u32 s3, s71, 12288
    buffer_load_dwordx4 a[204:207], v4, s[28:31], s3 offen offset:0 sc1
    buffer_load_dwordx4 a[220:223], v4, s[28:31], s3 offen offset:1024 sc1
    buffer_load_dwordx4 a[236:239], v4, s[28:31], s3 offen offset:2048 sc1
    buffer_load_dwordx4 a[252:255], v4, s[28:31], s3 offen offset:3072 sc1
    s_add_u32 s3, s70, 16384
    buffer_load_dwordx4 v[204:207], v4, s[28:31], s3 offen offset:0 sc1
    buffer_load_dwordx4 v[220:223], v4, s[28:31], s3 offen offset:1024 sc1
    s_add_u32 s3, s70, 36864
    buffer_load_dwordx4 v[208:211], v4, s[28:31], s3 offen offset:0 sc1
    buffer_load_dwordx4 v[224:227], v4, s[28:31], s3 offen offset:1024 sc1
    s_add_u32 s3, s70, 57344
    buffer_load_dwordx4 v[212:215], v4, s[28:31], s3 offen offset:0 sc1
    buffer_load_dwordx4 v[228:231], v4, s[28:31], s3 offen offset:1024 sc1
    s_add_u32 s3, s71, 16384
    buffer_load_dwordx4 v[216:219], v4, s[28:31], s3 offen offset:0 sc1
    buffer_load_dwordx4 v[232:235], v4, s[28:31], s3 offen offset:1024 sc1
L_padz_a1:
    s_branch L_g1
L_side:
    s_sub_u32 s7, s6, 20
    s_lshl_b32 s7, s7, 3
    s_add_u32 s7, s7, s5
    s_waitcnt vmcnt(0)
    v_readfirstlane_b32 s8, v243
    s_mul_i32 s8, s8, 0x9e3779b1
    s_add_u32 s8, s8, 0x7f4a7c15
    s_not_b32 s9, s8
    s_cmp_ge_u32 s7, 72
    s_cbranch_scc1 L_job_none
    s_cmp_ge_u32 s7, 40
    s_cbranch_scc1 L_job_q
    s_add_u32 s71, s7, 10
    s_cmp_lt_u32 s7, 30
    s_cselect_b32 s71, s7, s71
    s_mov_b32 s77, s7
L_job_mod:
    s_mov_b32 s16, s58
    s_and_b32 s17, s59, 0xffff
    s_mov_b32 s18, 4915200
    s_mov_b32 s19, 0x20000
    s_mov_b32 s20, s56
    s_and_b32 s21, s57, 0xffff
    s_mov_b32 s22, 1280
    s_mov_b32 s23, 0x20000
    v_and_b32 v2, 7, v1
    v_lshrrev_b32 v3, 3, v1
    v_mul_u32_u24 v5, 20, v3
    s_mul_i32 s10, s4, 160
    v_add_u32 v5, s10, v5
    v_lshlrev_b32 v6, 1, v5
    v_mul_u32_u24 v5, 7680, v5
    v_lshl_add_u32 v5, v2, 4, v5
    s_nop 0
    buffer_load_dwordx4 v[96:99], v6, s[20:23], 0 offen
    buffer_load_dwordx4 v[100:103], v6, s[20:23], 0 offen offset:16
    buffer_load_dwordx2 v[104:105], v6, s[20:23], 0 offen offset:32
    s_getpc_b64 s[100:101]
L_pc_11:
    s_lshl_b32 s3, s6, 2
    s_add_u32 s3, s3, s4
    s_lshl_b32 s3, s3, 10
    s_cmp_gt_u32 s3, (L_end-L_pc_11)-1024
    s_cselect_b32 s3, 0, s3
    v_add_u32 v252, s3, v4
    global_load_dwordx4 v[252:255], v252, s[100:101]
    s_cmp_lt_u32 s7, 40
    s_cbranch_scc1 L_mod_noearly
    s_lshl_b32 s10, s71, 7
    buffer_load_dwordx4 v[16:19], v5, s[16:19], s10 offen nt
    s_add_u32 s10, s10, 7680
    buffer_load_dwordx4 v[20:23], v5, s[16:19], s10 offen nt
    s_add_u32 s10, s10, 7680
    buffer_load_dwordx4 v[24:27], v5, s[16:19], s10 offen nt
    s_add_u32 s10, s10, 7680
    buffer_load_dwordx4 v[28:31], v5, s[16:19], s10 offen nt
    s_add_u32 s10, s10, 7680
    buffer_load_dwordx4 v[32:35], v5, s[16:19], s10 offen nt
    s_add_u32 s10, s10, 7680
    buffer_load_dwordx4 v[36:39], v5, s[16:19], s10 offen nt
    s_add_u32 s10, s10, 7680
    buffer_load_dwordx4 v[40:43], v5, s[16:19], s10 offen nt
    s_add_u32 s10, s10, 7680
    buffer_load_dwordx4 v[44:47], v5, s[16:19], s10 offen nt
    s_add_u32 s10, s10, 7680
    buffer_load_dwordx4 v[48:51], v5, s[16:19], s10 offen nt
    s_add_u32 s10, s10, 7680
    buffer_load_dwordx4 v[52:55], v5, s[16:19], s10 offen nt
    s_add_u32 s10, s10, 7680
    buffer_load_dwordx4 v[56:59], v5, s[16:19], s10 offen nt
    s_add_u32 s10, s10, 7680
    buffer_load_dwordx4 v[60:63], v5, s[16:19], s10 offen nt
    s_add_u32 s10, s10, 7680
    buffer_load_dwordx4 v[64:67], v5, s[16:19], s10 offen nt
    s_add_u32 s10, s10, 7680
    buffer_load_dwordx4 v[68:71], v5, s[16:19], s10 offen nt
    s_add_u32 s10, s10, 7680
    buffer_load_dwordx4 v[72:75], v5, s[16:19], s10 offen nt
    s_add_u32 s10, s10, 7680
    buffer_load_dwordx4 v[76:79], v5, s[16:19], s10 offen nt
    s_add_u32 s10, s10, 7680
    buffer_load_dwordx4 v[80:83], v5, s[16:19], s10 offen nt
    s_add_u32 s10, s10, 7680
    buffer_load_dwordx4 v[84:87], v5, s[16:19], s10 offen nt
    s_add_u32 s10, s10, 7680
    buffer_load_dwordx4 v[88:91], v5, s[16:19], s10 offen nt
    s_add_u32 s10, s10, 7680
    buffer_load_dwordx4 v[92:95], v5, s[16:19], s10 offen nt
L_mod_noearly:
    s_cmp_lt_u32 s7, 40
    s_cbranch_scc1 L_mod_cw0
    s_waitcnt vmcnt(21)
    s_branch L_mod_cw1
L_mod_cw0:
    s_waitcnt vmcnt(1)
L_mod_cw1:
    v_lshlrev_b32 v108, 16, v96
    v_and_b32 v109, 0xffff0000, v96
    v_lshlrev_b32 v110, 16, v97
    v_and_b32 v111, 0xffff0000, v97
    v_lshlrev_b32 v112, 16, v98
    v_and_b32 v113, 0xffff0000, v98
    v_lshlrev_b32 v114, 16, v99
    v_and_b32 v115, 0xffff0000, v99
    v_lshlrev_b32 v116, 16, v100
    v_and_b32 v117, 0xffff0000, v100
    v_lshlrev_b32 v118, 16, v101
    v_and_b32 v119, 0xffff0000, v101
    v_lshlrev_b32 v120, 16, v102
    v_and_b32 v121, 0xffff0000, v102
    v_lshlrev_b32 v122, 16, v103
    v_and_b32 v123, 0xffff0000, v103
    v_lshlrev_b32 v124, 16, v104
    v_and_b32 v125, 0xffff0000, v104
    v_lshlrev_b32 v126, 16, v105
    v_and_b32 v127, 0xffff0000, v105
    v_mul_f32 v128, 0xbfb8aa3b, v108
    v_mul_f32 v129, 0xbfb8aa3b, v109
    v_mul_f32 v130, 0xbfb8aa3b, v110
    v_mul_f32 v131, 0xbfb8aa3b, v111
    v_mul_f32 v132, 0xbfb8aa3b, v112
    v_mul_f32 v133, 0xbfb8aa3b, v113
    v_mul_f32 v134, 0xbfb8aa3b, v114
    v_mul_f32 v135, 0xbfb8aa3b, v115
    v_mul_f32 v136, 0xbfb8aa3b, v116
    v_mul_f32 v137, 0xbfb8aa3b, v117
    v_mul_f32 v138, 0xbfb8aa3b, v118
    v_mul_f32 v139, 0xbfb8aa3b, v119
    v_mul_f32 v140, 0xbfb8aa3b, v120
    v_mul_f32 v141, 0xbfb8aa3b, v121
    v_mul_f32 v142, 0xbfb8aa3b, v122
    v_mul_f32 v143, 0xbfb8aa3b, v123
    v_mul_f32 v144, 0xbfb8aa3b, v124
    v_mul_f32 v145, 0xbfb8aa3b, v125
    v_mul_f32 v146, 0xbfb8aa3b, v126
    v_mul_f32 v147, 0xbfb8aa3b, v127
    v_exp_f32 v128, v128
    v_exp_f32 v129, v129
    v_exp_f32 v130, v130
    v_exp_f32 v131, v131
    v_exp_f32 v132, v132
    v_exp_f32 v133, v133
    v_exp_f32 v134, v134
    v_exp_f32 v135, v135
    v_exp_f32 v136, v136
    v_exp_f32 v137, v137
    v_exp_f32 v138, v138
    v_exp_f32 v139, v139
    v_exp_f32 v140, v140
    v_exp_f32 v141, v141
    v_exp_f32 v142, v142
    v_exp_f32 v143, v143
    v_exp_f32 v144, v144
    v_exp_f32 v145, v145
    v_exp_f32 v146, v146
    v_exp_f32 v147, v147
    v_add_f32 v128, 1.0, v128
    v_add_f32 v129, 1.0, v129
    v_add_f32 v130, 1.0, v130
    v_add_f32 v131, 1.0, v131
    v_add_f32 v132, 1.0, v132
    v_add_f32 v133, 1.0, v133
    v_add_f32 v134, 1.0, v134
    v_add_f32 v135, 1.0, v135
    v_add_f32 v136, 1.0, v136
    v_add_f32 v137, 1.0, v137
    v_add_f32 v138, 1.0, v138
    v_add_f32 v139, 1.0, v139
    v_add_f32 v140, 1.0, v140
    v_add_f32 v141, 1.0, v141
    v_add_f32 v142, 1.0, v142
    v_add_f32 v143, 1.0, v143
    v_add_f32 v144, 1.0, v144
    v_add_f32 v145, 1.0, v145
    v_add_f32 v146, 1.0, v146
    v_add_f32 v147, 1.0, v147
    v_rcp_f32 v128, v128
    v_rcp_f32 v129, v129
    v_rcp_f32 v130, v130
    v_rcp_f32 v131, v131
    v_rcp_f32 v132, v132
    v_rcp_f32 v133, v133
    v_rcp_f32 v134, v134
    v_rcp_f32 v135, v135
    v_rcp_f32 v136, v136
    v_rcp_f32 v137, v137
    v_rcp_f32 v138, v138
    v_rcp_f32 v139, v139
    v_rcp_f32 v140, v140
    v_rcp_f32 v141, v141
    v_rcp_f32 v142, v142
    v_rcp_f32 v143, v143
    v_rcp_f32 v144, v144
    v_rcp_f32 v145, v145
    v_rcp_f32 v146, v146
    v_rcp_f32 v147, v147
    v_mul_f32 v128, v108, v128
    v_mul_f32 v129, v109, v129
    v_mul_f32 v130, v110, v130
    v_mul_f32 v131, v111, v131
    v_mul_f32 v132, v112, v132
    v_mul_f32 v133, v113, v133
    v_mul_f32 v134, v114, v134
    v_mul_f32 v135, v115, v135
    v_mul_f32 v136, v116, v136
    v_mul_f32 v137, v117, v137
    v_mul_f32 v138, v118, v138
    v_mul_f32 v139, v119, v139
    v_mul_f32 v140, v120, v140
    v_mul_f32 v141, v121, v141
    v_mul_f32 v142, v122, v142
    v_mul_f32 v143, v123, v143
    v_mul_f32 v144, v124, v144
    v_mul_f32 v145, v125, v145
    v_mul_f32 v146, v126, v146
    v_mul_f32 v147, v127, v147
    v_cvt_pk_bf16_f32 v96, v128, v129
    v_cvt_pk_bf16_f32 v97, v130, v131
    v_cvt_pk_bf16_f32 v98, v132, v133
    v_cvt_pk_bf16_f32 v99, v134, v135
    v_cvt_pk_bf16_f32 v100, v136, v137
    v_cvt_pk_bf16_f32 v101, v138, v139
    v_cvt_pk_bf16_f32 v102, v140, v141
    v_cvt_pk_bf16_f32 v103, v142, v143
    v_cvt_pk_bf16_f32 v104, v144, v145
    v_cvt_pk_bf16_f32 v105, v146, v147
    v_lshlrev_b32 v108, 16, v96
    v_and_b32 v109, 0xffff0000, v96
    v_lshlrev_b32 v110, 16, v97
    v_and_b32 v111, 0xffff0000, v97
    v_lshlrev_b32 v112, 16, v98
    v_and_b32 v113, 0xffff0000, v98
    v_lshlrev_b32 v114, 16, v99
    v_and_b32 v115, 0xffff0000, v99
    v_lshlrev_b32 v116, 16, v100
    v_and_b32 v117, 0xffff0000, v100
    v_lshlrev_b32 v118, 16, v101
    v_and_b32 v119, 0xffff0000, v101
    v_lshlrev_b32 v120, 16, v102
    v_and_b32 v121, 0xffff0000, v102
    v_lshlrev_b32 v122, 16, v103
    v_and_b32 v123, 0xffff0000, v103
    v_lshlrev_b32 v124, 16, v104
    v_and_b32 v125, 0xffff0000, v104
    v_lshlrev_b32 v126, 16, v105
    v_and_b32 v127, 0xffff0000, v105
    s_cmp_ge_u32 s7, 40
    s_cbranch_scc1 L_mod_nogate
    s_lshl_b32 s10, s71, 7
    buffer_load_dwordx4 v[16:19], v5, s[16:19], s10 offen nt
    s_add_u32 s10, s10, 7680
    buffer_load_dwordx4 v[20:23], v5, s[16:19], s10 offen nt
    s_add_u32 s10, s10, 7680
    buffer_load_dwordx4 v[24:27], v5, s[16:19], s10 offen nt
    s_add_u32 s10, s10, 7680
    buffer_load_dwordx4 v[28:31], v5, s[16:19], s10 offen nt
    s_add_u32 s10, s10, 7680
    buffer_load_dwordx4 v[32:35], v5, s[16:19], s10 offen nt
    s_add_u32 s10, s10, 7680
    buffer_load_dwordx4 v[36:39], v5, s[16:19], s10 offen nt
    s_add_u32 s10, s10, 7680
    buffer_load_dwordx4 v[40:43], v5, s[16:19], s10 offen nt
    s_add_u32 s10, s10, 7680
    buffer_load_dwordx4 v[44:47], v5, s[16:19], s10 offen nt
    s_add_u32 s10, s10, 7680
    buffer_load_dwordx4 v[48:51], v5, s[16:19], s10 offen nt
    s_add_u32 s10, s10, 7680
    buffer_load_dwordx4 v[52:55], v5, s[16:19], s10 offen nt
    s_add_u32 s10, s10, 7680
    buffer_load_dwordx4 v[56:59], v5, s[16:19], s10 offen nt
    s_add_u32 s10, s10, 7680
    buffer_load_dwordx4 v[60:63], v5, s[16:19], s10 offen nt
    s_add_u32 s10, s10, 7680
    buffer_load_dwordx4 v[64:67], v5, s[16:19], s10 offen nt
    s_add_u32 s10, s10, 7680
    buffer_load_dwordx4 v[68:71], v5, s[16:19], s10 offen nt
    s_add_u32 s10, s10, 7680
    buffer_load_dwordx4 v[72:75], v5, s[16:19], s10 offen nt
    s_add_u32 s10, s10, 7680
    buffer_load_dwordx4 v[76:79], v5, s[16:19], s10 offen nt
    s_add_u32 s10, s10, 7680
    buffer_load_dwordx4 v[80:83], v5, s[16:19], s10 offen nt
    s_add_u32 s10, s10, 7680
    buffer_load_dwordx4 v[84:87], v5, s[16:19], s10 offen nt
    s_add_u32 s10, s10, 7680
    buffer_load_dwordx4 v[88:91], v5, s[16:19], s10 offen nt
    s_add_u32 s10, s10, 7680
    buffer_load_dwordx4 v[92:95], v5, s[16:19], s10 offen nt
L_mod_nogate:
    s_waitcnt vmcnt(19)
    v_lshlrev_b32 v128, 16, v16
    v_and_b32 v129, 0xffff0000, v16
    v_lshlrev_b32 v130, 16, v17
    v_and_b32 v131, 0xffff0000, v17
    v_lshlrev_b32 v132, 16, v18
    v_and_b32 v133, 0xffff0000, v18
    v_lshlrev_b32 v134, 16, v19
    v_and_b32 v135, 0xffff0000, v19
    v_pk_mul_f32 v[144:145], v[128:129], v[108:109] op_sel:[0,0] op_sel_hi:[1,0]
    v_pk_mul_f32 v[146:147], v[130:131], v[108:109] op_sel:[0,0] op_sel_hi:[1,0]
    v_pk_mul_f32 v[148:149], v[132:133], v[108:109] op_sel:[0,0] op_sel_hi:[1,0]
    v_pk_mul_f32 v[150:151], v[134:135], v[108:109] op_sel:[0,0] op_sel_hi:[1,0]
    s_waitcnt vmcnt(18)
    v_lshlrev_b32 v136, 16, v20
    v_and_b32 v137, 0xffff0000, v20
    v_lshlrev_b32 v138, 16, v21
    v_and_b32 v139, 0xffff0000, v21
    v_lshlrev_b32 v140, 16, v22
    v_and_b32 v141, 0xffff0000, v22
    v_lshlrev_b32 v142, 16, v23
    v_and_b32 v143, 0xffff0000, v23
    v_pk_fma_f32 v[144:145], v[136:137], v[108:109], v[144:145] op_sel:[0,1,0] op_sel_hi:[1,1,1]
    v_pk_fma_f32 v[146:147], v[138:139], v[108:109], v[146:147] op_sel:[0,1,0] op_sel_hi:[1,1,1]
    v_pk_fma_f32 v[148:149], v[140:141], v[108:109], v[148:149] op_sel:[0,1,0] op_sel_hi:[1,1,1]
    v_pk_fma_f32 v[150:151], v[142:143], v[108:109], v[150:151] op_sel:[0,1,0] op_sel_hi:[1,1,1]
    s_waitcnt vmcnt(17)
    v_lshlrev_b32 v128, 16, v24
    v_and_b32 v129, 0xffff0000, v24
    v_lshlrev_b32 v130, 16, v25
    v_and_b32 v131, 0xffff0000, v25
    v_lshlrev_b32 v132, 16, v26
    v_and_b32 v133, 0xffff0000, v26
    v_lshlrev_b32 v134, 16, v27
    v_and_b32 v135, 0xffff0000, v27
    v_pk_fma_f32 v[144:145], v[128:129], v[110:111], v[144:145] op_sel:[0,0,0] op_sel_hi:[1,0,1]
    v_pk_fma_f32 v[146:147], v[130:131], v[110:111], v[146:147] op_sel:[0,0,0] op_sel_hi:[1,0,1]
    v_pk_fma_f32 v[148:149], v[132:133], v[110:111], v[148:149] op_sel:[0,0,0] op_sel_hi:[1,0,1]
    v_pk_fma_f32 v[150:151], v[134:135], v[110:111], v[150:151] op_sel:[0,0,0] op_sel_hi:[1,0,1]
    s_waitcnt vmcnt(16)
    v_lshlrev_b32 v136, 16, v28
    v_and_b32 v137, 0xffff0000, v28
    v_lshlrev_b32 v138, 16, v29
    v_and_b32 v139, 0xffff0000, v29
    v_lshlrev_b32 v140, 16, v30
    v_and_b32 v141, 0xffff0000, v30
    v_lshlrev_b32 v142, 16, v31
    v_and_b32 v143, 0xffff0000, v31
    v_pk_fma_f32 v[144:145], v[136:137], v[110:111], v[144:145] op_sel:[0,1,0] op_sel_hi:[1,1,1]
    v_pk_fma_f32 v[146:147], v[138:139], v[110:111], v[146:147] op_sel:[0,1,0] op_sel_hi:[1,1,1]
    v_pk_fma_f32 v[148:149], v[140:141], v[110:111], v[148:149] op_sel:[0,1,0] op_sel_hi:[1,1,1]
    v_pk_fma_f32 v[150:151], v[142:143], v[110:111], v[150:151] op_sel:[0,1,0] op_sel_hi:[1,1,1]
    s_waitcnt vmcnt(15)
    v_lshlrev_b32 v128, 16, v32
    v_and_b32 v129, 0xffff0000, v32
    v_lshlrev_b32 v130, 16, v33
    v_and_b32 v131, 0xffff0000, v33
    v_lshlrev_b32 v132, 16, v34
    v_and_b32 v133, 0xffff0000, v34
    v_lshlrev_b32 v134, 16, v35
    v_and_b32 v135, 0xffff0000, v35
    v_pk_fma_f32 v[144:145], v[128:129], v[112:113], v[144:145] op_sel:[0,0,0] op_sel_hi:[1,0,1]
    v_pk_fma_f32 v[146:147], v[130:131], v[112:113], v[146:147] op_sel:[0,0,0] op_sel_hi:[1,0,1]
    v_pk_fma_f32 v[148:149], v[132:133], v[112:113], v[148:149] op_sel:[0,0,0] op_sel_hi:[1,0,1]
    v_pk_fma_f32 v[150:151], v[134:135], v[112:113], v[150:151] op_sel:[0,0,0] op_sel_hi:[1,0,1]
    s_waitcnt vmcnt(14)
    v_lshlrev_b32 v136, 16, v36
    v_and_b32 v137, 0xffff0000, v36
    v_lshlrev_b32 v138, 16, v37
    v_and_b32 v139, 0xffff0000, v37
    v_lshlrev_b32 v140, 16, v38
    v_and_b32 v141, 0xffff0000, v38
    v_lshlrev_b32 v142, 16, v39
    v_and_b32 v143, 0xffff0000, v39
    v_pk_fma_f32 v[144:145], v[136:137], v[112:113], v[144:145] op_sel:[0,1,0] op_sel_hi:[1,1,1]
    v_pk_fma_f32 v[146:147], v[138:139], v[112:113], v[146:147] op_sel:[0,1,0] op_sel_hi:[1,1,1]
    v_pk_fma_f32 v[148:149], v[140:141], v[112:113], v[148:149] op_sel:[0,1,0] op_sel_hi:[1,1,1]
    v_pk_fma_f32 v[150:151], v[142:143], v[112:113], v[150:151] op_sel:[0,1,0] op_sel_hi:[1,1,1]
    s_waitcnt vmcnt(13)
    v_lshlrev_b32 v128, 16, v40
    v_and_b32 v129, 0xffff0000, v40
    v_lshlrev_b32 v130, 16, v41
    v_and_b32 v131, 0xffff0000, v41
    v_lshlrev_b32 v132, 16, v42
    v_and_b32 v133, 0xffff0000, v42
    v_lshlrev_b32 v134, 16, v43
    v_and_b32 v135, 0xffff0000, v43
    v_pk_fma_f32 v[144:145], v[128:129], v[114:115], v[144:145] op_sel:[0,0,0] op_sel_hi:[1,0,1]
    v_pk_fma_f32 v[146:147], v[130:131], v[114:115], v[146:147] op_sel:[0,0,0] op_sel_hi:[1,0,1]
    v_pk_fma_f32 v[148:149], v[132:133], v[114:115], v[148:149] op_sel:[0,0,0] op_sel_hi:[1,0,1]
    v_pk_fma_f32 v[150:151], v[134:135], v[114:115], v[150:151] op_sel:[0,0,0] op_sel_hi:[1,0,1]
    s_waitcnt vmcnt(12)
    v_lshlrev_b32 v136, 16, v44
    v_and_b32 v137, 0xffff0000, v44
    v_lshlrev_b32 v138, 16, v45
    v_and_b32 v139, 0xffff0000, v45
    v_lshlrev_b32 v140, 16, v46
    v_and_b32 v141, 0xffff0000, v46
    v_lshlrev_b32 v142, 16, v47
    v_and_b32 v143, 0xffff0000, v47
    v_pk_fma_f32 v[144:145], v[136:137], v[114:115], v[144:145] op_sel:[0,1,0] op_sel_hi:[1,1,1]
    v_pk_fma_f32 v[146:147], v[138:139], v[114:115], v[146:147] op_sel:[0,1,0] op_sel_hi:[1,1,1]
    v_pk_fma_f32 v[148:149], v[140:141], v[114:115], v[148:149] op_sel:[0,1,0] op_sel_hi:[1,1,1]
    v_pk_fma_f32 v[150:151], v[142:143], v[114:115], v[150:151] op_sel:[0,1,0] op_sel_hi:[1,1,1]
    s_waitcnt vmcnt(11)
    v_lshlrev_b32 v128, 16, v48
    v_and_b32 v129, 0xffff0000, v48
    v_lshlrev_b32 v130, 16, v49
    v_and_b32 v131, 0xffff0000, v49
    v_lshlrev_b32 v132, 16, v50
    v_and_b32 v133, 0xffff0000, v50
    v_lshlrev_b32 v134, 16, v51
    v_and_b32 v135, 0xffff0000, v51
    v_pk_fma_f32 v[144:145], v[128:129], v[116:117], v[144:145] op_sel:[0,0,0] op_sel_hi:[1,0,1]
    v_pk_fma_f32 v[146:147], v[130:131], v[116:117], v[146:147] op_sel:[0,0,0] op_sel_hi:[1,0,1]
    v_pk_fma_f32 v[148:149], v[132:133], v[116:117], v[148:149] op_sel:[0,0,0] op_sel_hi:[1,0,1]
    v_pk_fma_f32 v[150:151], v[134:135], v[116:117], v[150:151] op_sel:[0,0,0] op_sel_hi:[1,0,1]
    s_waitcnt vmcnt(10)
    v_lshlrev_b32 v136, 16, v52
    v_and_b32 v137, 0xffff0000, v52
    v_lshlrev_b32 v138, 16, v53
    v_and_b32 v139, 0xffff0000, v53
    v_lshlrev_b32 v140, 16, v54
    v_and_b32 v141, 0xffff0000, v54
    v_lshlrev_b32 v142, 16, v55
    v_and_b32 v143, 0xffff0000, v55
    v_pk_fma_f32 v[144:145], v[136:137], v[116:117], v[144:145] op_sel:[0,1,0] op_sel_hi:[1,1,1]
    v_pk_fma_f32 v[146:147], v[138:139], v[116:117], v[146:147] op_sel:[0,1,0] op_sel_hi:[1,1,1]
    v_pk_fma_f32 v[148:149], v[140:141], v[116:117], v[148:149] op_sel:[0,1,0] op_sel_hi:[1,1,1]
    v_pk_fma_f32 v[150:151], v[142:143], v[116:117], v[150:151] op_sel:[0,1,0] op_sel_hi:[1,1,1]
    s_waitcnt vmcnt(9)
    v_lshlrev_b32 v128, 16, v56
    v_and_b32 v129, 0xffff0000, v56
    v_lshlrev_b32 v130, 16, v57
    v_and_b32 v131, 0xffff0000, v57
    v_lshlrev_b32 v132, 16, v58
    v_and_b32 v133, 0xffff0000, v58
    v_lshlrev_b32 v134, 16, v59
    v_and_b32 v135, 0xffff0000, v59
    v_pk_fma_f32 v[144:145], v[128:129], v[118:119], v[144:145] op_sel:[0,0,0] op_sel_hi:[1,0,1]
    v_pk_fma_f32 v[146:147], v[130:131], v[118:119], v[146:147] op_sel:[0,0,0] op_sel_hi:[1,0,1]
    v_pk_fma_f32 v[148:149], v[132:133], v[118:119], v[148:149] op_sel:[0,0,0] op_sel_hi:[1,0,1]
    v_pk_fma_f32 v[150:151], v[134:135], v[118:119], v[150:151] op_sel:[0,0,0] op_sel_hi:[1,0,1]
    s_waitcnt vmcnt(8)
    v_lshlrev_b32 v136, 16, v60
    v_and_b32 v137, 0xffff0000, v60
    v_lshlrev_b32 v138, 16, v61
    v_and_b32 v139, 0xffff0000, v61
    v_lshlrev_b32 v140, 16, v62
    v_and_b32 v141, 0xffff0000, v62
    v_lshlrev_b32 v142, 16, v63
    v_and_b32 v143, 0xffff0000, v63
    v_pk_fma_f32 v[144:145], v[136:137], v[118:119], v[144:145] op_sel:[0,1,0] op_sel_hi:[1,1,1]
    v_pk_fma_f32 v[146:147], v[138:139], v[118:119], v[146:147] op_sel:[0,1,0] op_sel_hi:[1,1,1]
    v_pk_fma_f32 v[148:149], v[140:141], v[118:119], v[148:149] op_sel:[0,1,0] op_sel_hi:[1,1,1]
    v_pk_fma_f32 v[150:151], v[142:143], v[118:119], v[150:151] op_sel:[0,1,0] op_sel_hi:[1,1,1]
    s_waitcnt vmcnt(7)
    v_lshlrev_b32 v128, 16, v64
    v_and_b32 v129, 0xffff0000, v64
    v_lshlrev_b32 v130, 16, v65
    v_and_b32 v131, 0xffff0000, v65
    v_lshlrev_b32 v132, 16, v66
    v_and_b32 v133, 0xffff0000, v66
    v_lshlrev_b32 v134, 16, v67
    v_and_b32 v135, 0xffff0000, v67
    v_pk_fma_f32 v[144:145], v[128:129], v[120:121], v[144:145] op_sel:[0,0,0] op_sel_hi:[1,0,1]
    v_pk_fma_f32 v[146:147], v[130:131], v[120:121], v[146:147] op_sel:[0,0,0] op_sel_hi:[1,0,1]
    v_pk_fma_f32 v[148:149], v[132:133], v[120:121], v[148:149] op_sel:[0,0,0] op_sel_hi:[1,0,1]
    v_pk_fma_f32 v[150:151], v[134:135], v[120:121], v[150:151] op_sel:[0,0,0] op_sel_hi:[1,0,1]
    s_waitcnt vmcnt(6)
    v_lshlrev_b32 v136, 16, v68
    v_and_b32 v137, 0xffff0000, v68
    v_lshlrev_b32 v138, 16, v69
    v_and_b32 v139, 0xffff0000, v69
    v_lshlrev_b32 v140, 16, v70
    v_and_b32 v141, 0xffff0000, v70
    v_lshlrev_b32 v142, 16, v71
    v_and_b32 v143, 0xffff0000, v71
    v_pk_fma_f32 v[144:145], v[136:137], v[120:121], v[144:145] op_sel:[0,1,0] op_sel_hi:[1,1,1]
    v_pk_fma_f32 v[146:147], v[138:139], v[120:121], v[146:147] op_sel:[0,1,0] op_sel_hi:[1,1,1]
    v_pk_fma_f32 v[148:149], v[140:141], v[120:121], v[148:149] op_sel:[0,1,0] op_sel_hi:[1,1,1]
    v_pk_fma_f32 v[150:151], v[142:143], v[120:121], v[150:151] op_sel:[0,1,0] op_sel_hi:[1,1,1]
    s_waitcnt vmcnt(5)
    v_lshlrev_b32 v128, 16, v72
    v_and_b32 v129, 0xffff0000, v72
    v_lshlrev_b32 v130, 16, v73
    v_and_b32 v131, 0xffff0000, v73
    v_lshlrev_b32 v132, 16, v74
    v_and_b32 v133, 0xffff0000, v74
    v_lshlrev_b32 v134, 16, v75
    v_and_b32 v135, 0xffff0000, v75
    v_pk_fma_f32 v[144:145], v[128:129], v[122:123], v[144:145] op_sel:[0,0,0] op_sel_hi:[1,0,1]
    v_pk_fma_f32 v[146:147], v[130:131], v[122:123], v[146:147] op_sel:[0,0,0] op_sel_hi:[1,0,1]
    v_pk_fma_f32 v[148:149], v[132:133], v[122:123], v[148:149] op_sel:[0,0,0] op_sel_hi:[1,0,1]
    v_pk_fma_f32 v[150:151], v[134:135], v[122:123], v[150:151] op_sel:[0,0,0] op_sel_hi:[1,0,1]
    s_waitcnt vmcnt(4)
    v_lshlrev_b32 v136, 16, v76
    v_and_b32 v137, 0xffff0000, v76
    v_lshlrev_b32 v138, 16, v77
    v_and_b32 v139, 0xffff0000, v77
    v_lshlrev_b32 v140, 16, v78
    v_and_b32 v141, 0xffff0000, v78
    v_lshlrev_b32 v142, 16, v79
    v_and_b32 v143, 0xffff0000, v79
    v_pk_fma_f32 v[144:145], v[136:137], v[122:123], v[144:145] op_sel:[0,1,0] op_sel_hi:[1,1,1]
    v_pk_fma_f32 v[146:147], v[138:139], v[122:123], v[146:147] op_sel:[0,1,0] op_sel_hi:[1,1,1]
    v_pk_fma_f32 v[148:149], v[140:141], v[122:123], v[148:149] op_sel:[0,1,0] op_sel_hi:[1,1,1]
    v_pk_fma_f32 v[150:151], v[142:143], v[122:123], v[150:151] op_sel:[0,1,0] op_sel_hi:[1,1,1]
    s_waitcnt vmcnt(3)
    v_lshlrev_b32 v128, 16, v80
    v_and_b32 v129, 0xffff0000, v80
    v_lshlrev_b32 v130, 16, v81
    v_and_b32 v131, 0xffff0000, v81
    v_lshlrev_b32 v132, 16, v82
    v_and_b32 v133, 0xffff0000, v82
    v_lshlrev_b32 v134, 16, v83
    v_and_b32 v135, 0xffff0000, v83
    v_pk_fma_f32 v[144:145], v[128:129], v[124:125], v[144:145] op_sel:[0,0,0] op_sel_hi:[1,0,1]
    v_pk_fma_f32 v[146:147], v[130:131], v[124:125], v[146:147] op_sel:[0,0,0] op_sel_hi:[1,0,1]
    v_pk_fma_f32 v[148:149], v[132:133], v[124:125], v[148:149] op_sel:[0,0,0] op_sel_hi:[1,0,1]
    v_pk_fma_f32 v[150:151], v[134:135], v[124:125], v[150:151] op_sel:[0,0,0] op_sel_hi:[1,0,1]
    s_waitcnt vmcnt(2)
    v_lshlrev_b32 v136, 16, v84
    v_and_b32 v137, 0xffff0000, v84
    v_lshlrev_b32 v138, 16, v85
    v_and_b32 v139, 0xffff0000, v85
    v_lshlrev_b32 v140, 16, v86
    v_and_b32 v141, 0xffff0000, v86
    v_lshlrev_b32 v142, 16, v87
    v_and_b32 v143, 0xffff0000, v87
    v_pk_fma_f32 v[144:145], v[136:137], v[124:125], v[144:145] op_sel:[0,1,0] op_sel_hi:[1,1,1]
    v_pk_fma_f32 v[146:147], v[138:139], v[124:125], v[146:147] op_sel:[0,1,0] op_sel_hi:[1,1,1]
    v_pk_fma_f32 v[148:149], v[140:141], v[124:125], v[148:149] op_sel:[0,1,0] op_sel_hi:[1,1,1]
    v_pk_fma_f32 v[150:151], v[142:143], v[124:125], v[150:151] op_sel:[0,1,0] op_sel_hi:[1,1,1]
    s_waitcnt vmcnt(1)
    v_lshlrev_b32 v128, 16, v88
    v_and_b32 v129, 0xffff0000, v88
    v_lshlrev_b32 v130, 16, v89
    v_and_b32 v131, 0xffff0000, v89
    v_lshlrev_b32 v132, 16, v90
    v_and_b32 v133, 0xffff0000, v90
    v_lshlrev_b32 v134, 16, v91
    v_and_b32 v135, 0xffff0000, v91
    v_pk_fma_f32 v[144:145], v[128:129], v[126:127], v[144:145] op_sel:[0,0,0] op_sel_hi:[1,0,1]
    v_pk_fma_f32 v[146:147], v[130:131], v[126:127], v[146:147] op_sel:[0,0,0] op_sel_hi:[1,0,1]
    v_pk_fma_f32 v[148:149], v[132:133], v[126:127], v[148:149] op_sel:[0,0,0] op_sel_hi:[1,0,1]
    v_pk_fma_f32 v[150:151], v[134:135], v[126:127], v[150:151] op_sel:[0,0,0] op_sel_hi:[1,0,1]
    s_waitcnt vmcnt(0)
    v_lshlrev_b32 v136, 16, v92
    v_and_b32 v137, 0xffff0000, v92
    v_lshlrev_b32 v138, 16, v93
    v_and_b32 v139, 0xffff0000, v93
    v_lshlrev_b32 v140, 16, v94
    v_and_b32 v141, 0xffff0000, v94
    v_lshlrev_b32 v142, 16, v95
    v_and_b32 v143, 0xffff0000, v95
    v_pk_fma_f32 v[144:145], v[136:137], v[126:127], v[144:145] op_sel:[0,1,0] op_sel_hi:[1,1,1]
    v_pk_fma_f32 v[146:147], v[138:139], v[126:127], v[146:147] op_sel:[0,1,0] op_sel_hi:[1,1,1]
    v_pk_fma_f32 v[148:149], v[140:141], v[126:127], v[148:149] op_sel:[0,1,0] op_sel_hi:[1,1,1]
    v_pk_fma_f32 v[150:151], v[142:143], v[126:127], v[150:151] op_sel:[0,1,0] op_sel_hi:[1,1,1]
    s_nop 1
    v_add_f32_dpp v144, v144, v144 row_ror:8 row_mask:0xf bank_mask:0xf
    v_add_f32_dpp v145, v145, v145 row_ror:8 row_mask:0xf bank_mask:0xf
    v_add_f32_dpp v146, v146, v146 row_ror:8 row_mask:0xf bank_mask:0xf
    v_add_f32_dpp v147, v147, v147 row_ror:8 row_mask:0xf bank_mask:0xf
    v_add_f32_dpp v148, v148, v148 row_ror:8 row_mask:0xf bank_mask:0xf
    v_add_f32_dpp v149, v149, v149 row_ror:8 row_mask:0xf bank_mask:0xf
    v_add_f32_dpp v150, v150, v150 row_ror:8 row_mask:0xf bank_mask:0xf
    v_add_f32_dpp v151, v151, v151 row_ror:8 row_mask:0xf bank_mask:0xf
    v_mov_b32 v152, v144
    v_mov_b32 v153, v145
    v_mov_b32 v154, v146
    v_mov_b32 v155, v147
    v_mov_b32 v156, v148
    v_mov_b32 v157, v149
    v_mov_b32 v158, v150
    v_mov_b32 v159, v151
    v_permlane16_swap_b32 v144, v152
    v_permlane16_swap_b32 v145, v153
    v_permlane16_swap_b32 v146, v154
    v_permlane16_swap_b32 v147, v155
    v_permlane16_swap_b32 v148, v156
    v_permlane16_swap_b32 v149, v157
    v_permlane16_swap_b32 v150, v158
    v_permlane16_swap_b32 v151, v159
    v_add_f32 v144, v144, v152
    v_add_f32 v145, v145, v153
    v_add_f32 v146, v146, v154
    v_add_f32 v147, v147, v155
    v_add_f32 v148, v148, v156
    v_add_f32 v149, v149, v157
    v_add_f32 v150, v150, v158
    v_add_f32 v151, v151, v159
    v_mov_b32 v152, v144
    v_mov_b32 v153, v145
    v_mov_b32 v154, v146
    v_mov_b32 v155, v147
    v_mov_b32 v156, v148
    v_mov_b32 v157, v149
    v_mov_b32 v158, v150
    v_mov_b32 v159, v151
    v_permlane32_swap_b32 v144, v152
    v_permlane32_swap_b32 v145, v153
    v_permlane32_swap_b32 v146, v154
    v_permlane32_swap_b32 v147, v155
    v_permlane32_swap_b32 v148, v156
    v_permlane32_swap_b32 v149, v157
    v_permlane32_swap_b32 v150, v158
    v_permlane32_swap_b32 v151, v159
    v_add_f32 v144, v144, v152
    v_add_f32 v145, v145, v153
    v_add_f32 v146, v146, v154
    v_add_f32 v147, v147, v155
    v_add_f32 v148, v148, v156
    v_add_f32 v149, v149, v157
    v_add_f32 v150, v150, v158
    v_add_f32 v151, v151, v159
    s_lshl_b32 s10, s4, 8
    v_lshl_add_u32 v7, v2, 5, s10
    ds_write_b128 v7, v[144:147]
    ds_write_b128 v7, v[148:151] offset:16
    v_lshlrev_b32 v8, 2, v1
    s_waitcnt lgkmcnt(0)
    s_barrier
    ds_read_b32 v152, v8
    ds_read_b32 v153, v8 offset:256
    ds_read_b32 v154, v8 offset:512
    ds_read_b32 v155, v8 offset:768
    s_mul_hi_u32 s73, s71, 429496730
    s_cmp_eq_u32 s73, 1
    s_cselect_b32 s74, 1.0, 0
    s_cmp_eq_u32 s73, 4
    s_cselect_b32 s74, 1.0, s74
    s_lshl_b32 s10, s71, 8
    s_add_u32 s10, s10, 13697024
    s_lshl_b32 s11, s71, 7
    s_add_u32 s11, s11, 13762560
    v_lshlrev_b32 v156, 1, v1
    s_min_u32 s75, s73, 3
    s_lshl_b32 s75, s75, 2
    s_mul_i32 s76, s73, 10
    s_sub_u32 s76, s71, s76
    s_lshl_b32 s76, s76, 10
    s_add_u32 s75, s75, s76
    s_add_u32 s75, s75, 13959168
    s_cmp_eq_u32 s73, 3
    s_cselect_b32 s76, 2146435072, 0
    s_cmp_eq_u32 s73, 5
    s_cselect_b32 s76, 2146435072, s76
    v_add_u32 v157, s76, v4
    s_waitcnt lgkmcnt(0)
    v_add_f32 v152, v152, v153
    v_add_f32 v154, v154, v155
    v_add_f32 v152, v152, v154
    v_cvt_pk_bf16_f32 v152, v152, v152
    v_lshlrev_b32 v152, 16, v152
    v_add_f32 v152, s74, v152
    v_cvt_pk_bf16_f32 v153, v152, v152
    v_lshlrev_b32 v152, 16, v153
    s_cmp_lg_u32 s4, 0
    s_cbranch_scc1 L_mod_nost
    buffer_store_dword v152, v8, s[12:15], s10 offen sc1
    buffer_store_short v153, v156, s[12:15], s11 offen sc1
    buffer_store_dword v152, v157, s[12:15], s75 offen sc1
L_mod_nost:
    s_waitcnt vmcnt(0)
    s_barrier
    s_cmp_lg_u32 s4, 0
    s_cbranch_scc1 L_post_12
    s_lshl_b32 s10, s77, 7
    s_add_u32 s10, s10, 24576
    v_mov_b32 v10, s8
    v_mov_b32 v11, s9
    s_mov_b64 exec, 1
    buffer_store_dwordx2 v[10:11], off, s[12:15], s10 sc1
    s_mov_b64 exec, -1
L_post_12:
    s_branch L_side_tail
L_job_none:
    s_getpc_b64 s[100:101]
L_pc_13:
    s_lshl_b32 s3, s6, 2
    s_add_u32 s3, s3, s4
    s_lshl_b32 s3, s3, 10
    s_cmp_gt_u32 s3, (L_end-L_pc_13)-1024
    s_cselect_b32 s3, 0, s3
    v_add_u32 v252, s3, v4
    global_load_dwordx4 v[252:255], v252, s[100:101]
    s_waitcnt vmcnt(0)
    s_barrier
    s_cmp_lg_u32 s4, 0
    s_cbranch_scc1 L_post_14
    s_lshl_b32 s10, s7, 7
    s_add_u32 s10, s10, 24576
    v_mov_b32 v10, s8
    v_mov_b32 v11, s9
    s_mov_b64 exec, 1
    buffer_store_dwordx2 v[10:11], off, s[12:15], s10 sc1
    s_mov_b64 exec, -1
L_post_14:
    s_cmp_ge_u32 s7, 87
    s_cbranch_scc1 L_job_modr_g
    s_sub_u32 s100, s7, 72
    s_lshl_b32 s100, s100, 2
    s_add_u32 s100, s100, s4
    s_add_u32 s100, s100, 480
    s_mov_b32 s74, 0x05040100
    s_mov_b32 s75, 0x07060302
    v_and_b32 v3, 7, v1
    v_lshrrev_b32 v2, 3, v1
    s_mov_b32 s20, s50
    s_and_b32 s21, s51, 0xffff
    s_mov_b32 s22, 2211840
    s_mov_b32 s23, 0x20000
    s_mov_b32 s24, s52
    s_and_b32 s25, s53, 0xffff
    s_mov_b32 s26, 2211840
    s_mov_b32 s27, 0x20000
    s_mul_hi_u32 s11, s100, 214748365
    s_mul_i32 s101, s11, 20
    s_sub_u32 s101, s100, s101
    s_mul_i32 s3, s101, 110592
    s_lshl_b32 s10, s11, 7
    s_add_u32 s3, s3, s10
    s_mul_i32 s11, s11, 163840
    s_lshl_b32 s101, s101, 10
    s_add_u32 s73, s11, s101
    s_add_u32 s73, s73, 17825792
    v_mul_u32_u24 v28, 13824, v2
    v_lshl_add_u32 v28, v3, 4, v28
    buffer_load_dwordx4 v[164:167], v28, s[20:23], s3 offen nt
    buffer_load_dwordx4 v[180:183], v28, s[24:27], s3 offen nt
    s_add_u32 s3, s3, 3456
    buffer_load_dwordx4 v[168:171], v28, s[20:23], s3 offen nt
    buffer_load_dwordx4 v[184:187], v28, s[24:27], s3 offen nt
    s_add_u32 s3, s3, 3456
    buffer_load_dwordx4 v[172:175], v28, s[20:23], s3 offen nt
    buffer_load_dwordx4 v[188:191], v28, s[24:27], s3 offen nt
    s_add_u32 s3, s3, 3456
    buffer_load_dwordx4 v[176:179], v28, s[20:23], s3 offen nt
    buffer_load_dwordx4 v[192:195], v28, s[24:27], s3 offen nt
    s_mul_i32 s10, s4, 8320
    s_add_u32 s10, s10, 0
    v_mul_u32_u24 v29, 1040, v3
    v_lshrrev_b32 v30, 1, v2
    v_lshl_add_u32 v29, v30, 8, v29
    v_and_b32 v30, 1, v2
    v_lshl_add_u32 v29, v30, 3, v29
    v_add_u32 v29, s10, v29
    v_add_u32 v30, s10, v4
    s_waitcnt vmcnt(0)
    v_perm_b32 v64, v168, v164, s74
    v_perm_b32 v65, v176, v172, s74
    ds_write_b64 v29, v[64:65] offset:0
    v_perm_b32 v66, v168, v164, s75
    v_perm_b32 v67, v176, v172, s75
    ds_write_b64 v29, v[66:67] offset:16
    v_perm_b32 v68, v169, v165, s74
    v_perm_b32 v69, v177, v173, s74
    ds_write_b64 v29, v[68:69] offset:64
    v_perm_b32 v70, v169, v165, s75
    v_perm_b32 v71, v177, v173, s75
    ds_write_b64 v29, v[70:71] offset:80
    v_perm_b32 v72, v170, v166, s74
    v_perm_b32 v73, v178, v174, s74
    ds_write_b64 v29, v[72:73] offset:128
    v_perm_b32 v74, v170, v166, s75
    v_perm_b32 v75, v178, v174, s75
    ds_write_b64 v29, v[74:75] offset:144
    v_perm_b32 v76, v171, v167, s74
    v_perm_b32 v77, v179, v175, s74
    ds_write_b64 v29, v[76:77] offset:192
    v_perm_b32 v78, v171, v167, s75
    v_perm_b32 v79, v179, v175, s75
    ds_write_b64 v29, v[78:79] offset:208
    v_perm_b32 v80, v184, v180, s74
    v_perm_b32 v81, v192, v188, s74
    ds_write_b64 v29, v[80:81] offset:32
    v_perm_b32 v82, v184, v180, s75
    v_perm_b32 v83, v192, v188, s75
    ds_write_b64 v29, v[82:83] offset:48
    v_perm_b32 v84, v185, v181, s74
    v_perm_b32 v85, v193, v189, s74
    ds_write_b64 v29, v[84:85] offset:96
    v_perm_b32 v86, v185, v181, s75
    v_perm_b32 v87, v193, v189, s75
    ds_write_b64 v29, v[86:87] offset:112
    v_perm_b32 v88, v186, v182, s74
    v_perm_b32 v89, v194, v190, s74
    ds_write_b64 v29, v[88:89] offset:160
    v_perm_b32 v90, v186, v182, s75
    v_perm_b32 v91, v194, v190, s75
    ds_write_b64 v29, v[90:91] offset:176
    v_perm_b32 v92, v187, v183, s74
    v_perm_b32 v93, v195, v191, s74
    ds_write_b64 v29, v[92:93] offset:224
    v_perm_b32 v94, v187, v183, s75
    v_perm_b32 v95, v195, v191, s75
    ds_write_b64 v29, v[94:95] offset:240
    ds_read_b128 v[208:211], v30 offset:0
    ds_read_b128 v[212:215], v30 offset:1040
    ds_read_b128 v[216:219], v30 offset:2080
    ds_read_b128 v[220:223], v30 offset:3120
    ds_read_b128 v[224:227], v30 offset:4160
    ds_read_b128 v[228:231], v30 offset:5200
    ds_read_b128 v[232:235], v30 offset:6240
    ds_read_b128 v[236:239], v30 offset:7280
    s_add_u32 s10, s73, 0
    s_waitcnt lgkmcnt(7)
    buffer_store_dwordx4 v[208:211], v4, s[12:15], s10 offen sc1
    s_add_u32 s10, s73, 20480
    s_waitcnt lgkmcnt(6)
    buffer_store_dwordx4 v[212:215], v4, s[12:15], s10 offen sc1
    s_add_u32 s10, s73, 40960
    s_waitcnt lgkmcnt(5)
    buffer_store_dwordx4 v[216:219], v4, s[12:15], s10 offen sc1
    s_add_u32 s10, s73, 61440
    s_waitcnt lgkmcnt(4)
    buffer_store_dwordx4 v[220:223], v4, s[12:15], s10 offen sc1
    s_add_u32 s10, s73, 81920
    s_waitcnt lgkmcnt(3)
    buffer_store_dwordx4 v[224:227], v4, s[12:15], s10 offen sc1
    s_add_u32 s10, s73, 102400
    s_waitcnt lgkmcnt(2)
    buffer_store_dwordx4 v[228:231], v4, s[12:15], s10 offen sc1
    s_add_u32 s10, s73, 122880
    s_waitcnt lgkmcnt(1)
    buffer_store_dwordx4 v[232:235], v4, s[12:15], s10 offen sc1
    s_add_u32 s10, s73, 143360
    s_waitcnt lgkmcnt(0)
    buffer_store_dwordx4 v[236:239], v4, s[12:15], s10 offen sc1
    s_waitcnt vmcnt(0)
    s_lshl_b32 s10, s100, 7
    s_add_u32 s10, s10, 149504
    v_mov_b32 v10, s8
    v_mov_b32 v11, s9
    s_mov_b64 exec, 1
    buffer_store_dwordx2 v[10:11], off, s[12:15], s10 sc1
    s_mov_b64 exec, -1
    s_barrier
    s_branch L_job_modr
L_job_modr_g:
L_job_modr:
    s_sub_u32 s70, s7, 86
    s_cmp_ge_u32 s7, 86
    s_cbranch_scc1 L_job_modr2
    s_bitcmp0_b32 s7, 2
    s_cbranch_scc1 L_side_tail
    s_sub_u32 s70, s7, 66
    s_sub_u32 s10, s7, 70
    s_cmp_lt_u32 s7, 80
    s_cselect_b32 s70, s70, s10
L_job_modr2:
    s_add_u32 s71, s70, 30
    s_add_u32 s10, s70, 40
    s_cmp_lt_u32 s70, 10
    s_cselect_b32 s71, s71, s10
    s_add_u32 s77, s70, 156
    s_branch L_job_mod
L_job_q:
    s_getpc_b64 s[100:101]
L_pc_15:
    s_lshl_b32 s3, s6, 2
    s_add_u32 s3, s3, s4
    s_lshl_b32 s3, s3, 10
    s_cmp_gt_u32 s3, (L_end-L_pc_15)-1024
    s_cselect_b32 s3, 0, s3
    v_add_u32 v252, s3, v4
    global_load_dwordx4 v[252:255], v252, s[100:101]
    s_waitcnt vmcnt(0)
    s_mov_b32 s16, s36
    s_and_b32 s17, s37, 0xffff
    s_mov_b32 s18, 2621440
    s_mov_b32 s19, 0x20000
    s_sub_u32 s70, s7, 40
    v_lshrrev_b32 v2, 4, v1
    v_and_b32 v3, 15, v1
    v_lshlrev_b32 v5, 1, v2
    v_xor_b32 v5, v5, v3
    s_lshr_b32 s73, s4, 1
    v_xor_b32 v5, s73, v5
    v_mul_u32_u24 v6, 1280, v2
    s_lshl_b32 s71, s70, 6
    s_lshl_b32 s10, s4, 4
    s_add_u32 s71, s71, s10
    s_mul_i32 s71, s71, 1280
    s_mul_i32 s72, s4, 20480
    v_xor_b32 v7, 0, v5
    v_lshl_add_u32 v10, v7, 4, v6
    v_xor_b32 v7, 8, v5
    v_lshl_add_u32 v11, v7, 4, v6
    v_xor_b32 v7, 9, v5
    v_lshl_add_u32 v12, v7, 4, v6
    v_xor_b32 v7, 1, v5
    v_lshl_add_u32 v13, v7, 4, v6
    s_add_u32 s10, s71, 0
    s_add_u32 m0, s72, 0
    s_nop 0
    buffer_load_dwordx4 v10, s[16:19], s10 offen offset:0 nt lds
    s_add_u32 m0, s72, 768
    s_nop 0
    buffer_load_dwordx4 v10, s[16:19], s10 offen offset:256 nt lds
    s_add_u32 m0, s72, 1536
    s_nop 0
    buffer_load_dwordx4 v10, s[16:19], s10 offen offset:512 nt lds
    s_add_u32 m0, s72, 2304
    s_nop 0
    buffer_load_dwordx4 v10, s[16:19], s10 offen offset:768 nt lds
    s_add_u32 m0, s72, 3072
    s_nop 0
    buffer_load_dwordx4 v10, s[16:19], s10 offen offset:1024 nt lds
    s_add_u32 s10, s71, 5120
    s_add_u32 m0, s72, 5120
    s_nop 0
    buffer_load_dwordx4 v11, s[16:19], s10 offen offset:0 nt lds
    s_add_u32 m0, s72, 5888
    s_nop 0
    buffer_load_dwordx4 v11, s[16:19], s10 offen offset:256 nt lds
    s_add_u32 m0, s72, 6656
    s_nop 0
    buffer_load_dwordx4 v11, s[16:19], s10 offen offset:512 nt lds
    s_add_u32 m0, s72, 7424
    s_nop 0
    buffer_load_dwordx4 v11, s[16:19], s10 offen offset:768 nt lds
    s_add_u32 m0, s72, 8192
    s_nop 0
    buffer_load_dwordx4 v11, s[16:19], s10 offen offset:1024 nt lds
    s_add_u32 s10, s71, 10240
    s_add_u32 m0, s72, 10240
    s_nop 0
    buffer_load_dwordx4 v12, s[16:19], s10 offen offset:0 nt lds
    s_add_u32 m0, s72, 11008
    s_nop 0
    buffer_load_dwordx4 v12, s[16:19], s10 offen offset:256 nt lds
    s_add_u32 m0, s72, 11776
    s_nop 0
    buffer_load_dwordx4 v12, s[16:19], s10 offen offset:512 nt lds
    s_add_u32 m0, s72, 12544
    s_nop 0
    buffer_load_dwordx4 v12, s[16:19], s10 offen offset:768 nt lds
    s_add_u32 m0, s72, 13312
    s_nop 0
    buffer_load_dwordx4 v12, s[16:19], s10 offen offset:1024 nt lds
    s_add_u32 s10, s71, 15360
    s_add_u32 m0, s72, 15360
    s_nop 0
    buffer_load_dwordx4 v13, s[16:19], s10 offen offset:0 nt lds
    s_add_u32 m0, s72, 16128
    s_nop 0
    buffer_load_dwordx4 v13, s[16:19], s10 offen offset:256 nt lds
    s_add_u32 m0, s72, 16896
    s_nop 0
    buffer_load_dwordx4 v13, s[16:19], s10 offen offset:512 nt lds
    s_add_u32 m0, s72, 17664
    s_nop 0
    buffer_load_dwordx4 v13, s[16:19], s10 offen offset:768 nt lds
    s_add_u32 m0, s72, 18432
    s_nop 0
    buffer_load_dwordx4 v13, s[16:19], s10 offen offset:1024 nt lds
    v_lshrrev_b32 v5, 2, v3
    v_and_b32 v6, 3, v3
    v_lshrrev_b32 v7, 1, v5
    v_and_b32 v8, 1, v5
    v_xor_b32 v8, v8, v7
    v_lshlrev_b32 v8, 3, v8
    v_lshl_or_b32 v8, v6, 1, v8
    v_or_b32 v8, v8, v7
    v_xor_b32 v8, v8, v2
    v_xor_b32 v8, s73, v8
    v_mul_u32_u24 v18, 5120, v5
    v_lshl_add_u32 v18, v6, 8, v18
    v_add_u32 v18, s72, v18
    v_xor_b32 v7, 0, v8
    v_lshl_add_u32 v14, v7, 4, v18
    v_xor_b32 v7, 4, v8
    v_lshl_add_u32 v15, v7, 4, v18
    v_xor_b32 v7, 8, v8
    v_lshl_add_u32 v16, v7, 4, v18
    v_xor_b32 v7, 12, v8
    v_lshl_add_u32 v17, v7, 4, v18
    v_mov_b32 v28, 0x3f803f80
    v_mov_b32 v29, 0x3f803f80
    v_mov_b32 v30, 0x3f803f80
    v_mov_b32 v31, 0x3f803f80
    s_waitcnt vmcnt(0)
    ds_read_b128 v[40:43], v14 offset:0
    ds_read_b128 v[44:47], v15 offset:0
    ds_read_b128 v[48:51], v16 offset:0
    ds_read_b128 v[52:55], v17 offset:0
    ds_read_b128 v[56:59], v14 offset:1024
    ds_read_b128 v[60:63], v15 offset:1024
    ds_read_b128 v[64:67], v16 offset:1024
    ds_read_b128 v[68:71], v17 offset:1024
    ds_read_b128 v[72:75], v14 offset:2048
    ds_read_b128 v[76:79], v15 offset:2048
    ds_read_b128 v[80:83], v16 offset:2048
    ds_read_b128 v[84:87], v17 offset:2048
    ds_read_b128 v[88:91], v14 offset:3072
    ds_read_b128 v[92:95], v15 offset:3072
    ds_read_b128 v[96:99], v16 offset:3072
    ds_read_b128 v[100:103], v17 offset:3072
    ds_read_b128 v[104:107], v14 offset:4096
    ds_read_b128 v[108:111], v15 offset:4096
    ds_read_b128 v[112:115], v16 offset:4096
    ds_read_b128 v[116:119], v17 offset:4096
    s_waitcnt lgkmcnt(15)
    v_mfma_f32_16x16x32_bf16 v[32:35], v[28:31], v[40:43], 0
    v_mfma_f32_16x16x32_bf16 v[36:39], v[40:43], v[40:43], 0
    s_waitcnt lgkmcnt(15)
    v_mfma_f32_16x16x32_bf16 v[32:35], v[28:31], v[44:47], v[32:35]
    v_mfma_f32_16x16x32_bf16 v[36:39], v[44:47], v[44:47], v[36:39]
    s_waitcnt lgkmcnt(15)
    v_mfma_f32_16x16x32_bf16 v[32:35], v[28:31], v[48:51], v[32:35]
    v_mfma_f32_16x16x32_bf16 v[36:39], v[48:51], v[48:51], v[36:39]
    s_waitcnt lgkmcnt(15)
    v_mfma_f32_16x16x32_bf16 v[32:35], v[28:31], v[52:55], v[32:35]
    v_mfma_f32_16x16x32_bf16 v[36:39], v[52:55], v[52:55], v[36:39]
    s_waitcnt lgkmcnt(15)
    v_mfma_f32_16x16x32_bf16 v[32:35], v[28:31], v[56:59], v[32:35]
    v_mfma_f32_16x16x32_bf16 v[36:39], v[56:59], v[56:59], v[36:39]
    s_waitcnt lgkmcnt(14)
    v_mfma_f32_16x16x32_bf16 v[32:35], v[28:31], v[60:63], v[32:35]
    v_mfma_f32_16x16x32_bf16 v[36:39], v[60:63], v[60:63], v[36:39]
    s_waitcnt lgkmcnt(13)
    v_mfma_f32_16x16x32_bf16 v[32:35], v[28:31], v[64:67], v[32:35]
    v_mfma_f32_16x16x32_bf16 v[36:39], v[64:67], v[64:67], v[36:39]
    s_waitcnt lgkmcnt(12)
    v_mfma_f32_16x16x32_bf16 v[32:35], v[28:31], v[68:71], v[32:35]
    v_mfma_f32_16x16x32_bf16 v[36:39], v[68:71], v[68:71], v[36:39]
    s_waitcnt lgkmcnt(11)
    v_mfma_f32_16x16x32_bf16 v[32:35], v[28:31], v[72:75], v[32:35]
    v_mfma_f32_16x16x32_bf16 v[36:39], v[72:75], v[72:75], v[36:39]
    s_waitcnt lgkmcnt(10)
    v_mfma_f32_16x16x32_bf16 v[32:35], v[28:31], v[76:79], v[32:35]
    v_mfma_f32_16x16x32_bf16 v[36:39], v[76:79], v[76:79], v[36:39]
    s_waitcnt lgkmcnt(9)
    v_mfma_f32_16x16x32_bf16 v[32:35], v[28:31], v[80:83], v[32:35]
    v_mfma_f32_16x16x32_bf16 v[36:39], v[80:83], v[80:83], v[36:39]
    s_waitcnt lgkmcnt(8)
    v_mfma_f32_16x16x32_bf16 v[32:35], v[28:31], v[84:87], v[32:35]
    v_mfma_f32_16x16x32_bf16 v[36:39], v[84:87], v[84:87], v[36:39]
    s_waitcnt lgkmcnt(7)
    v_mfma_f32_16x16x32_bf16 v[32:35], v[28:31], v[88:91], v[32:35]
    v_mfma_f32_16x16x32_bf16 v[36:39], v[88:91], v[88:91], v[36:39]
    s_waitcnt lgkmcnt(6)
    v_mfma_f32_16x16x32_bf16 v[32:35], v[28:31], v[92:95], v[32:35]
    v_mfma_f32_16x16x32_bf16 v[36:39], v[92:95], v[92:95], v[36:39]
    s_waitcnt lgkmcnt(5)
    v_mfma_f32_16x16x32_bf16 v[32:35], v[28:31], v[96:99], v[32:35]
    v_mfma_f32_16x16x32_bf16 v[36:39], v[96:99], v[96:99], v[36:39]
    s_waitcnt lgkmcnt(4)
    v_mfma_f32_16x16x32_bf16 v[32:35], v[28:31], v[100:103], v[32:35]
    v_mfma_f32_16x16x32_bf16 v[36:39], v[100:103], v[100:103], v[36:39]
    s_waitcnt lgkmcnt(3)
    v_mfma_f32_16x16x32_bf16 v[32:35], v[28:31], v[104:107], v[32:35]
    v_mfma_f32_16x16x32_bf16 v[36:39], v[104:107], v[104:107], v[36:39]
    s_waitcnt lgkmcnt(2)
    v_mfma_f32_16x16x32_bf16 v[32:35], v[28:31], v[108:111], v[32:35]
    v_mfma_f32_16x16x32_bf16 v[36:39], v[108:111], v[108:111], v[36:39]
    s_waitcnt lgkmcnt(1)
    v_mfma_f32_16x16x32_bf16 v[32:35], v[28:31], v[112:115], v[32:35]
    v_mfma_f32_16x16x32_bf16 v[36:39], v[112:115], v[112:115], v[36:39]
    s_waitcnt lgkmcnt(0)
    v_mfma_f32_16x16x32_bf16 v[32:35], v[28:31], v[116:119], v[32:35]
    v_mfma_f32_16x16x32_bf16 v[36:39], v[116:119], v[116:119], v[36:39]
    s_nop 7
    v_cmp_eq_u32 vcc, 1, v6
    v_cmp_eq_u32 s[10:11], 2, v6
    s_nop 1
    v_cndmask_b32 v36, v36, v37, vcc
    v_cndmask_b32 v36, v36, v38, s[10:11]
    v_cmp_eq_u32 vcc, 3, v6
    v_mul_f32 v32, 0x3acccccd, v32
    v_lshlrev_b32 v25, 2, v3
    v_cndmask_b32 v36, v36, v39, vcc
    v_mul_f32 v33, v32, v32
    v_mov_b32 v34, 0x3acccccd
    v_fma_f32 v36, v36, v34, -v33
    v_max_f32 v36, 0, v36
    v_add_f32 v36, 0x3727c5ac, v36
    v_rsq_f32 v36, v36
    v_cmp_eq_u32 vcc, v5, v2
    v_mov_b32 v34, 2146435072
    v_mul_f32 v32, v32, v36
    v_cndmask_b32 v25, v34, v25, vcc
    s_lshl_b32 s10, s70, 8
    s_lshl_b32 s11, s4, 6
    s_add_u32 s10, s10, s11
    s_add_u32 s10, s10, 13631488
    s_add_u32 s11, s10, 8192
    buffer_store_dword v36, v25, s[12:15], s10 offen sc1
    buffer_store_dword v32, v25, s[12:15], s11 offen sc1
    s_waitcnt vmcnt(0)
    s_barrier
    s_cmp_lg_u32 s4, 0
    s_cbranch_scc1 L_post_16
    s_lshl_b32 s10, s7, 7
    s_add_u32 s10, s10, 24576
    v_mov_b32 v10, s8
    v_mov_b32 v11, s9
    s_mov_b64 exec, 1
    buffer_store_dwordx2 v[10:11], off, s[12:15], s10 sc1
    s_mov_b64 exec, -1
L_post_16:
    s_sub_u32 s70, s7, 40
    s_and_b32 s10, s7, 0x7c
    s_cmp_eq_u32 s10, 56
    s_cbranch_scc1 L_job_modr2
L_side_tail:
    s_mul_i32 s70, s67, 14
    s_lshr_b32 s10, s4, 1
    s_mul_i32 s10, s10, 7
    s_add_u32 s70, s70, s10
    s_add_u32 s71, s70, 6
    s_and_b32 s10, s4, 1
    s_mul_i32 s10, s10, 3
    s_add_u32 s70, s70, s10
    s_mul_i32 s70, s70, 20480
    s_mul_i32 s71, s71, 20480
    s_add_u32 s28, s64, 17825792
    s_addc_u32 s29, s65, 0
    s_and_b32 s29, s29, 0xffff
    s_mov_b32 s30, 4423680
    s_mov_b32 s31, 0x20000
    s_mul_i32 s10, s67, 14
    s_lshr_b32 s11, s4, 1
    s_mul_i32 s11, s11, 7
    s_add_u32 s10, s10, s11
    s_add_u32 s11, s10, 6
    s_lshr_b32 s10, s10, 3
    s_lshr_b32 s11, s11, 3
    s_min_u32 s10, s10, 26
    s_min_u32 s11, s11, 26
    s_mul_i32 s10, s10, 20
    s_mul_i32 s11, s11, 20
    s_add_u32 s11, s11, 19
    v_add_u32 v5, s10, v1
    v_min_u32 v5, s11, v5
    v_lshlrev_b32 v5, 7, v5
    v_add_u32 v5, 149504, v5
    s_cmp_ge_u32 s7, 54
    s_cbranch_scc1 L_nowd
    s_mov_b32 s77, s7
    s_mov_b32 s16, s54
    s_and_b32 s17, s55, 0xffff
    s_mov_b32 s18, 2211840
    s_mov_b32 s19, 0x20000
    s_mul_i32 s72, s77, 40960
    s_mul_i32 s73, s4, 320
    s_add_u32 s73, s73, s72
    s_mul_i32 s74, s4, 10240
    s_mov_b32 s75, 214748365
    v_add_u32 v6, 0, v1
    v_mul_hi_u32 v7, v6, s75
    v_mul_u32_u24 v7, 960, v7
    v_lshl_add_u32 v16, v6, 4, v7
    v_add_u32 v6, 64, v1
    v_mul_hi_u32 v7, v6, s75
    v_mul_u32_u24 v7, 960, v7
    v_lshl_add_u32 v17, v6, 4, v7
    v_add_u32 v6, 128, v1
    v_mul_hi_u32 v7, v6, s75
    v_mul_u32_u24 v7, 960, v7
    v_lshl_add_u32 v18, v6, 4, v7
    v_add_u32 v6, 192, v1
    v_mul_hi_u32 v7, v6, s75
    v_mul_u32_u24 v7, 960, v7
    v_lshl_add_u32 v19, v6, 4, v7
    v_add_u32 v6, 256, v1
    v_mul_hi_u32 v7, v6, s75
    v_mul_u32_u24 v7, 960, v7
    v_lshl_add_u32 v20, v6, 4, v7
    v_add_u32 v6, 320, v1
    v_mul_hi_u32 v7, v6, s75
    v_mul_u32_u24 v7, 960, v7
    v_lshl_add_u32 v21, v6, 4, v7
    v_add_u32 v6, 384, v1
    v_mul_hi_u32 v7, v6, s75
    v_mul_u32_u24 v7, 960, v7
    v_lshl_add_u32 v22, v6, 4, v7
    v_add_u32 v6, 448, v1
    v_mul_hi_u32 v7, v6, s75
    v_mul_u32_u24 v7, 960, v7
    v_lshl_add_u32 v23, v6, 4, v7
    v_add_u32 v6, 512, v1
    v_mul_hi_u32 v7, v6, s75
    v_mul_u32_u24 v7, 960, v7
    v_lshl_add_u32 v24, v6, 4, v7
    v_add_u32 v6, 576, v1
    v_mul_hi_u32 v7, v6, s75
    v_mul_u32_u24 v7, 960, v7
    v_lshl_add_u32 v25, v6, 4, v7
    s_add_u32 m0, s74, 0
    s_nop 0
    buffer_load_dwordx4 v16, s[16:19], s73 offen nt lds
    s_add_u32 m0, s74, 1024
    s_nop 0
    buffer_load_dwordx4 v17, s[16:19], s73 offen nt lds
    s_add_u32 m0, s74, 2048
    s_nop 0
    buffer_load_dwordx4 v18, s[16:19], s73 offen nt lds
    s_add_u32 m0, s74, 3072
    s_nop 0
    buffer_load_dwordx4 v19, s[16:19], s73 offen nt lds
    s_add_u32 m0, s74, 4096
    s_nop 0
    buffer_load_dwordx4 v20, s[16:19], s73 offen nt lds
    s_add_u32 m0, s74, 5120
    s_nop 0
    buffer_load_dwordx4 v21, s[16:19], s73 offen nt lds
    s_add_u32 m0, s74, 6144
    s_nop 0
    buffer_load_dwordx4 v22, s[16:19], s73 offen nt lds
    s_add_u32 m0, s74, 7168
    s_nop 0
    buffer_load_dwordx4 v23, s[16:19], s73 offen nt lds
    s_add_u32 m0, s74, 8192
    s_nop 0
    buffer_load_dwordx4 v24, s[16:19], s73 offen nt lds
    s_add_u32 m0, s74, 9216
    s_nop 0
    buffer_load_dwordx4 v25, s[16:19], s73 offen nt lds
    v_lshrrev_b32 v2, 4, v1
    v_bfe_u32 v3, v1, 2, 2
    v_and_b32 v8, 3, v1
    v_lshl_add_u32 v2, v2, 3, v3
    v_mul_u32_u24 v2, 320, v2
    v_add_u32 v2, s74, v2
    v_lshl_add_u32 v6, v8, 4, v2
    v_lshl_add_u32 v7, v8, 3, v2
    v_add_u32 v7, 128, v7
    s_add_u32 s72, s72, s74
    s_add_u32 s72, s72, 23068672
    s_waitcnt vmcnt(0)
    ds_read_b64_tr_b16 v[16:17], v6 offset:0
    ds_read_b64_tr_b16 v[18:19], v6 offset:1280
    ds_read_b64_tr_b16 v[20:21], v6 offset:8
    ds_read_b64_tr_b16 v[22:23], v6 offset:1288
    ds_read_b64_tr_b16 v[24:25], v6 offset:64
    ds_read_b64_tr_b16 v[26:27], v6 offset:1344
    ds_read_b64_tr_b16 v[28:29], v6 offset:72
    ds_read_b64_tr_b16 v[30:31], v6 offset:1352
    ds_read_b64_tr_b16 v[32:33], v7 offset:0
    ds_read_b64_tr_b16 v[34:35], v7 offset:1280
    ds_read_b64_tr_b16 v[36:37], v6 offset:160
    ds_read_b64_tr_b16 v[38:39], v6 offset:1440
    ds_read_b64_tr_b16 v[40:41], v6 offset:168
    ds_read_b64_tr_b16 v[42:43], v6 offset:1448
    ds_read_b64_tr_b16 v[44:45], v6 offset:224
    ds_read_b64_tr_b16 v[46:47], v6 offset:1504
    ds_read_b64_tr_b16 v[48:49], v6 offset:232
    ds_read_b64_tr_b16 v[50:51], v6 offset:1512
    ds_read_b64_tr_b16 v[52:53], v7 offset:160
    ds_read_b64_tr_b16 v[54:55], v7 offset:1440
    s_waitcnt lgkmcnt(15)
    s_add_u32 s10, s72, 0
    buffer_store_dwordx4 v[16:19], v4, s[12:15], s10 offen offset:0 sc1
    s_waitcnt lgkmcnt(15)
    buffer_store_dwordx4 v[20:23], v4, s[12:15], s10 offen offset:1024 sc1
    s_waitcnt lgkmcnt(14)
    buffer_store_dwordx4 v[24:27], v4, s[12:15], s10 offen offset:2048 sc1
    s_waitcnt lgkmcnt(12)
    buffer_store_dwordx4 v[28:31], v4, s[12:15], s10 offen offset:3072 sc1
    s_waitcnt lgkmcnt(10)
    s_add_u32 s10, s72, 4096
    buffer_store_dwordx4 v[32:35], v4, s[12:15], s10 offen offset:0 sc1
    s_waitcnt lgkmcnt(8)
    buffer_store_dwordx4 v[36:39], v4, s[12:15], s10 offen offset:1024 sc1
    s_waitcnt lgkmcnt(6)
    buffer_store_dwordx4 v[40:43], v4, s[12:15], s10 offen offset:2048 sc1
    s_waitcnt lgkmcnt(4)
    buffer_store_dwordx4 v[44:47], v4, s[12:15], s10 offen offset:3072 sc1
    s_waitcnt lgkmcnt(2)
    s_add_u32 s10, s72, 8192
    buffer_store_dwordx4 v[48:51], v4, s[12:15], s10 offen offset:0 sc1
    s_waitcnt lgkmcnt(0)
    buffer_store_dwordx4 v[52:55], v4, s[12:15], s10 offen offset:1024 sc1
    buffer_load_dwordx2 v[10:11], v5, s[12:15], 0 offen sc1
    s_waitcnt vmcnt(1)
    s_barrier
    s_cmp_lg_u32 s4, 0
    s_cbranch_scc1 L_post_17
    s_lshl_b32 s10, s77, 7
    s_add_u32 s10, s10, 36864
    v_mov_b32 v12, s8
    v_mov_b32 v13, s9
    s_mov_b64 exec, 1
    buffer_store_dwordx2 v[12:13], off, s[12:15], s10 sc1
    s_mov_b64 exec, -1
L_post_17:
    s_waitcnt vmcnt(0)
    v_cmp_eq_u64 vcc, s[8:9], v[10:11]
    s_cmp_eq_u64 vcc, exec
    s_cbranch_scc1 L_pok_18
    s_mov_b32 s10, 0
L_plp_19:
    s_sleep 2
    buffer_load_dwordx2 v[10:11], v5, s[12:15], 0 offen sc1
    s_add_u32 s10, s10, 1
    s_waitcnt vmcnt(0)
    v_cmp_eq_u64 vcc, s[8:9], v[10:11]
    s_cmp_eq_u64 vcc, exec
    s_cbranch_scc1 L_pok_18
    s_cmp_lt_u32 s10, 40000
    s_cbranch_scc1 L_plp_19
L_pok_18:
    s_branch L_plain_w1
L_nowd:
    buffer_load_dwordx2 v[10:11], v5, s[12:15], 0 offen sc1
    s_waitcnt vmcnt(0)
    v_cmp_eq_u64 vcc, s[8:9], v[10:11]
    s_cmp_eq_u64 vcc, exec
    s_cbranch_scc1 L_pok_20
    s_mov_b32 s10, 0
L_plp_21:
    s_sleep 2
    buffer_load_dwordx2 v[10:11], v5, s[12:15], 0 offen sc1
    s_add_u32 s10, s10, 1
    s_waitcnt vmcnt(0)
    v_cmp_eq_u64 vcc, s[8:9], v[10:11]
    s_cmp_eq_u64 vcc, exec
    s_cbranch_scc1 L_pok_20
    s_cmp_lt_u32 s10, 40000
    s_cbranch_scc1 L_plp_21
L_pok_20:
    s_cmp_lt_u32 s6, 28
    s_cbranch_scc1 L_plain_w1
    s_cmp_lt_u32 s5, 4
    s_cbranch_scc1 L_cjob
L_plain_w1:
    s_add_u32 s3, s70, 0
    buffer_load_dwordx4 a[0:3], v4, s[28:31], s3 offen offset:0 sc1
    buffer_load_dwordx4 a[16:19], v4, s[28:31], s3 offen offset:1024 sc1
    buffer_load_dwordx4 a[32:35], v4, s[28:31], s3 offen offset:2048 sc1
    buffer_load_dwordx4 a[48:51], v4, s[28:31], s3 offen offset:3072 sc1
    s_add_u32 s3, s70, 20480
    buffer_load_dwordx4 a[4:7], v4, s[28:31], s3 offen offset:0 sc1
    buffer_load_dwordx4 a[20:23], v4, s[28:31], s3 offen offset:1024 sc1
    buffer_load_dwordx4 a[36:39], v4, s[28:31], s3 offen offset:2048 sc1
    buffer_load_dwordx4 a[52:55], v4, s[28:31], s3 offen offset:3072 sc1
    s_add_u32 s3, s70, 40960
    buffer_load_dwordx4 a[8:11], v4, s[28:31], s3 offen offset:0 sc1
    buffer_load_dwordx4 a[24:27], v4, s[28:31], s3 offen offset:1024 sc1
    buffer_load_dwordx4 a[40:43], v4, s[28:31], s3 offen offset:2048 sc1
    buffer_load_dwordx4 a[56:59], v4, s[28:31], s3 offen offset:3072 sc1
    s_add_u32 s3, s71, 0
    buffer_load_dwordx4 a[12:15], v4, s[28:31], s3 offen offset:0 sc1
    buffer_load_dwordx4 a[28:31], v4, s[28:31], s3 offen offset:1024 sc1
    buffer_load_dwordx4 a[44:47], v4, s[28:31], s3 offen offset:2048 sc1
    buffer_load_dwordx4 a[60:63], v4, s[28:31], s3 offen offset:3072 sc1
    s_add_u32 s3, s70, 4096
    buffer_load_dwordx4 a[64:67], v4, s[28:31], s3 offen offset:0 sc1
    buffer_load_dwordx4 a[80:83], v4, s[28:31], s3 offen offset:1024 sc1
    buffer_load_dwordx4 a[96:99], v4, s[28:31], s3 offen offset:2048 sc1
    buffer_load_dwordx4 a[112:115], v4, s[28:31], s3 offen offset:3072 sc1
    s_add_u32 s3, s70, 24576
    buffer_load_dwordx4 a[68:71], v4, s[28:31], s3 offen offset:0 sc1
    buffer_load_dwordx4 a[84:87], v4, s[28:31], s3 offen offset:1024 sc1
    buffer_load_dwordx4 a[100:103], v4, s[28:31], s3 offen offset:2048 sc1
    buffer_load_dwordx4 a[116:119], v4, s[28:31], s3 offen offset:3072 sc1
    s_add_u32 s3, s70, 45056
    buffer_load_dwordx4 a[72:75], v4, s[28:31], s3 offen offset:0 sc1
    buffer_load_dwordx4 a[88:91], v4, s[28:31], s3 offen offset:1024 sc1
    buffer_load_dwordx4 a[104:107], v4, s[28:31], s3 offen offset:2048 sc1
    buffer_load_dwordx4 a[120:123], v4, s[28:31], s3 offen offset:3072 sc1
    s_add_u32 s3, s71, 4096
    buffer_load_dwordx4 a[76:79], v4, s[28:31], s3 offen offset:0 sc1
    buffer_load_dwordx4 a[92:95], v4, s[28:31], s3 offen offset:1024 sc1
    buffer_load_dwordx4 a[108:111], v4, s[28:31], s3 offen offset:2048 sc1
    buffer_load_dwordx4 a[124:127], v4, s[28:31], s3 offen offset:3072 sc1
    s_add_u32 s3, s70, 8192
    buffer_load_dwordx4 a[128:131], v4, s[28:31], s3 offen offset:0 sc1
    buffer_load_dwordx4 a[144:147], v4, s[28:31], s3 offen offset:1024 sc1
    buffer_load_dwordx4 a[160:163], v4, s[28:31], s3 offen offset:2048 sc1
    buffer_load_dwordx4 a[176:179], v4, s[28:31], s3 offen offset:3072 sc1
    s_add_u32 s3, s70, 28672
    buffer_load_dwordx4 a[132:135], v4, s[28:31], s3 offen offset:0 sc1
    buffer_load_dwordx4 a[148:151], v4, s[28:31], s3 offen offset:1024 sc1
    buffer_load_dwordx4 a[164:167], v4, s[28:31], s3 offen offset:2048 sc1
    buffer_load_dwordx4 a[180:183], v4, s[28:31], s3 offen offset:3072 sc1
    s_add_u32 s3, s70, 49152
    buffer_load_dwordx4 a[136:139], v4, s[28:31], s3 offen offset:0 sc1
    buffer_load_dwordx4 a[152:155], v4, s[28:31], s3 offen offset:1024 sc1
    buffer_load_dwordx4 a[168:171], v4, s[28:31], s3 offen offset:2048 sc1
    buffer_load_dwordx4 a[184:187], v4, s[28:31], s3 offen offset:3072 sc1
    s_add_u32 s3, s71, 8192
    buffer_load_dwordx4 a[140:143], v4, s[28:31], s3 offen offset:0 sc1
    buffer_load_dwordx4 a[156:159], v4, s[28:31], s3 offen offset:1024 sc1
    buffer_load_dwordx4 a[172:175], v4, s[28:31], s3 offen offset:2048 sc1
    buffer_load_dwordx4 a[188:191], v4, s[28:31], s3 offen offset:3072 sc1
    s_add_u32 s3, s70, 12288
    buffer_load_dwordx4 a[192:195], v4, s[28:31], s3 offen offset:0 sc1
    buffer_load_dwordx4 a[208:211], v4, s[28:31], s3 offen offset:1024 sc1
    buffer_load_dwordx4 a[224:227], v4, s[28:31], s3 offen offset:2048 sc1
    buffer_load_dwordx4 a[240:243], v4, s[28:31], s3 offen offset:3072 sc1
    s_add_u32 s3, s70, 32768
    buffer_load_dwordx4 a[196:199], v4, s[28:31], s3 offen offset:0 sc1
    buffer_load_dwordx4 a[212:215], v4, s[28:31], s3 offen offset:1024 sc1
    buffer_load_dwordx4 a[228:231], v4, s[28:31], s3 offen offset:2048 sc1
    buffer_load_dwordx4 a[244:247], v4, s[28:31], s3 offen offset:3072 sc1
    s_add_u32 s3, s70, 53248
    buffer_load_dwordx4 a[200:203], v4, s[28:31], s3 offen offset:0 sc1
    buffer_load_dwordx4 a[216:219], v4, s[28:31], s3 offen offset:1024 sc1
    buffer_load_dwordx4 a[232:235], v4, s[28:31], s3 offen offset:2048 sc1
    buffer_load_dwordx4 a[248:251], v4, s[28:31], s3 offen offset:3072 sc1
    s_add_u32 s3, s71, 12288
    buffer_load_dwordx4 a[204:207], v4, s[28:31], s3 offen offset:0 sc1
    buffer_load_dwordx4 a[220:223], v4, s[28:31], s3 offen offset:1024 sc1
    buffer_load_dwordx4 a[236:239], v4, s[28:31], s3 offen offset:2048 sc1
    buffer_load_dwordx4 a[252:255], v4, s[28:31], s3 offen offset:3072 sc1
    s_add_u32 s3, s70, 16384
    buffer_load_dwordx4 v[204:207], v4, s[28:31], s3 offen offset:0 sc1
    buffer_load_dwordx4 v[220:223], v4, s[28:31], s3 offen offset:1024 sc1
    s_add_u32 s3, s70, 36864
    buffer_load_dwordx4 v[208:211], v4, s[28:31], s3 offen offset:0 sc1
    buffer_load_dwordx4 v[224:227], v4, s[28:31], s3 offen offset:1024 sc1
    s_add_u32 s3, s70, 57344
    buffer_load_dwordx4 v[212:215], v4, s[28:31], s3 offen offset:0 sc1
    buffer_load_dwordx4 v[228:231], v4, s[28:31], s3 offen offset:1024 sc1
    s_add_u32 s3, s71, 16384
    buffer_load_dwordx4 v[216:219], v4, s[28:31], s3 offen offset:0 sc1
    buffer_load_dwordx4 v[232:235], v4, s[28:31], s3 offen offset:1024 sc1
    s_branch L_no_cjob
L_cjob:
    s_add_u32 s3, s70, 0
    buffer_load_dwordx4 a[0:3], v4, s[28:31], s3 offen offset:0 sc1
    buffer_load_dwordx4 a[16:19], v4, s[28:31], s3 offen offset:1024 sc1
    buffer_load_dwordx4 a[32:35], v4, s[28:31], s3 offen offset:2048 sc1
    buffer_load_dwordx4 a[48:51], v4, s[28:31], s3 offen offset:3072 sc1
    s_add_u32 s3, s70, 20480
    buffer_load_dwordx4 a[4:7], v4, s[28:31], s3 offen offset:0 sc1
    buffer_load_dwordx4 a[20:23], v4, s[28:31], s3 offen offset:1024 sc1
    buffer_load_dwordx4 a[36:39], v4, s[28:31], s3 offen offset:2048 sc1
    buffer_load_dwordx4 a[52:55], v4, s[28:31], s3 offen offset:3072 sc1
    s_add_u32 s3, s70, 40960
    buffer_load_dwordx4 a[8:11], v4, s[28:31], s3 offen offset:0 sc1
    buffer_load_dwordx4 a[24:27], v4, s[28:31], s3 offen offset:1024 sc1
    buffer_load_dwordx4 a[40:43], v4, s[28:31], s3 offen offset:2048 sc1
    buffer_load_dwordx4 a[56:59], v4, s[28:31], s3 offen offset:3072 sc1
    s_add_u32 s3, s71, 0
    buffer_load_dwordx4 a[12:15], v4, s[28:31], s3 offen offset:0 sc1
    buffer_load_dwordx4 a[28:31], v4, s[28:31], s3 offen offset:1024 sc1
    buffer_load_dwordx4 a[44:47], v4, s[28:31], s3 offen offset:2048 sc1
    buffer_load_dwordx4 a[60:63], v4, s[28:31], s3 offen offset:3072 sc1
    s_add_u32 s3, s70, 4096
    buffer_load_dwordx4 a[64:67], v4, s[28:31], s3 offen offset:0 sc1
    buffer_load_dwordx4 a[80:83], v4, s[28:31], s3 offen offset:1024 sc1
    buffer_load_dwordx4 a[96:99], v4, s[28:31], s3 offen offset:2048 sc1
    buffer_load_dwordx4 a[112:115], v4, s[28:31], s3 offen offset:3072 sc1
    s_add_u32 s3, s70, 24576
    buffer_load_dwordx4 a[68:71], v4, s[28:31], s3 offen offset:0 sc1
    buffer_load_dwordx4 a[84:87], v4, s[28:31], s3 offen offset:1024 sc1
    buffer_load_dwordx4 a[100:103], v4, s[28:31], s3 offen offset:2048 sc1
    buffer_load_dwordx4 a[116:119], v4, s[28:31], s3 offen offset:3072 sc1
    s_add_u32 s3, s70, 45056
    buffer_load_dwordx4 a[72:75], v4, s[28:31], s3 offen offset:0 sc1
    buffer_load_dwordx4 a[88:91], v4, s[28:31], s3 offen offset:1024 sc1
    buffer_load_dwordx4 a[104:107], v4, s[28:31], s3 offen offset:2048 sc1
    buffer_load_dwordx4 a[120:123], v4, s[28:31], s3 offen offset:3072 sc1
    s_add_u32 s3, s71, 4096
    buffer_load_dwordx4 a[76:79], v4, s[28:31], s3 offen offset:0 sc1
    buffer_load_dwordx4 a[92:95], v4, s[28:31], s3 offen offset:1024 sc1
    buffer_load_dwordx4 a[108:111], v4, s[28:31], s3 offen offset:2048 sc1
    buffer_load_dwordx4 a[124:127], v4, s[28:31], s3 offen offset:3072 sc1
    v_min_u32 v5, 19, v1
    v_add_u32 v6, 190, v5
    v_add_u32 v7, 306, v5
    v_cmp_gt_u32 vcc, 10, v5
    v_and_b32 v2, 15, v1
    v_lshrrev_b32 v3, 4, v1
    v_cndmask_b32 v5, v7, v6, vcc
    v_lshlrev_b32 v5, 7, v5
    v_add_u32 v5, 4096, v5
    v_mul_u32_u24 v6, 1280, v2
    v_sub_u32 v6, 13767680, v6
    v_lshl_add_u32 v6, v3, 4, v6
    v_mov_b32 v7, 2146435072
    v_cmp_gt_u32 vcc, 2, v2
    v_lshlrev_b32 v8, 6, v2
    v_lshl_add_u32 v8, v3, 4, v8
    v_cndmask_b32 v6, v7, v6, vcc
    v_cndmask_b32 v8, v7, v8, vcc
    buffer_load_dwordx2 v[10:11], v5, s[12:15], 0 offen sc1
    s_add_u32 s3, s70, 8192
    buffer_load_dwordx4 a[128:131], v4, s[28:31], s3 offen offset:0 sc1
    buffer_load_dwordx4 a[144:147], v4, s[28:31], s3 offen offset:1024 sc1
    buffer_load_dwordx4 a[160:163], v4, s[28:31], s3 offen offset:2048 sc1
    buffer_load_dwordx4 a[176:179], v4, s[28:31], s3 offen offset:3072 sc1
    s_add_u32 s3, s70, 28672
    buffer_load_dwordx4 a[132:135], v4, s[28:31], s3 offen offset:0 sc1
    buffer_load_dwordx4 a[148:151], v4, s[28:31], s3 offen offset:1024 sc1
    buffer_load_dwordx4 a[164:167], v4, s[28:31], s3 offen offset:2048 sc1
    buffer_load_dwordx4 a[180:183], v4, s[28:31], s3 offen offset:3072 sc1
    s_add_u32 s3, s70, 49152
    buffer_load_dwordx4 a[136:139], v4, s[28:31], s3 offen offset:0 sc1
    buffer_load_dwordx4 a[152:155], v4, s[28:31], s3 offen offset:1024 sc1
    buffer_load_dwordx4 a[168:171], v4, s[28:31], s3 offen offset:2048 sc1
    buffer_load_dwordx4 a[184:187], v4, s[28:31], s3 offen offset:3072 sc1
    s_add_u32 s3, s71, 8192
    buffer_load_dwordx4 a[140:143], v4, s[28:31], s3 offen offset:0 sc1
    buffer_load_dwordx4 a[156:159], v4, s[28:31], s3 offen offset:1024 sc1
    buffer_load_dwordx4 a[172:175], v4, s[28:31], s3 offen offset:2048 sc1
    buffer_load_dwordx4 a[188:191], v4, s[28:31], s3 offen offset:3072 sc1
    s_waitcnt vmcnt(16)
    v_cmp_eq_u64 vcc, s[8:9], v[10:11]
    s_cmp_eq_u64 vcc, exec
    s_cbranch_scc1 L_pok_22
    s_mov_b32 s10, 0
L_plp_23:
    s_sleep 2
    buffer_load_dwordx2 v[10:11], v5, s[12:15], 0 offen sc1
    s_add_u32 s10, s10, 1
    s_waitcnt vmcnt(0)
    v_cmp_eq_u64 vcc, s[8:9], v[10:11]
    s_cmp_eq_u64 vcc, exec
    s_cbranch_scc1 L_pok_22
    s_cmp_lt_u32 s10, 40000
    s_cbranch_scc1 L_plp_23
L_pok_22:
    s_add_u32 s16, s64, 13828096
    s_addc_u32 s17, s65, 0
    s_and_b32 s17, s17, 0xffff
    s_mov_b32 s18, 27648
    s_mov_b32 s19, 0x20000
    buffer_load_dwordx4 v[96:99], v6, s[12:15], 0 offen offset:0 sc1
    buffer_load_dwordx4 v[100:103], v6, s[12:15], 0 offen offset:64 sc1
    buffer_load_dwordx4 v[104:107], v6, s[12:15], 0 offen offset:128 sc1
    buffer_load_dwordx4 v[108:111], v6, s[12:15], 0 offen offset:192 sc1
    buffer_load_dwordx4 v[112:115], v6, s[12:15], 0 offen offset:256 sc1
    buffer_load_dwordx4 v[116:119], v6, s[12:15], 0 offen offset:320 sc1
    buffer_load_dwordx4 v[120:123], v6, s[12:15], 0 offen offset:384 sc1
    buffer_load_dwordx4 v[124:127], v6, s[12:15], 0 offen offset:448 sc1
    buffer_load_dwordx4 v[128:131], v6, s[12:15], 0 offen offset:512 sc1
    buffer_load_dwordx4 v[132:135], v6, s[12:15], 0 offen offset:576 sc1
    buffer_load_dwordx4 v[136:139], v6, s[12:15], 0 offen offset:640 sc1
    buffer_load_dwordx4 v[140:143], v6, s[12:15], 0 offen offset:704 sc1
    buffer_load_dwordx4 v[144:147], v6, s[12:15], 0 offen offset:768 sc1
    buffer_load_dwordx4 v[148:151], v6, s[12:15], 0 offen offset:832 sc1
    buffer_load_dwordx4 v[152:155], v6, s[12:15], 0 offen offset:896 sc1
    buffer_load_dwordx4 v[156:159], v6, s[12:15], 0 offen offset:960 sc1
    buffer_load_dwordx4 v[160:163], v6, s[12:15], 0 offen offset:1024 sc1
    buffer_load_dwordx4 v[164:167], v6, s[12:15], 0 offen offset:1088 sc1
    buffer_load_dwordx4 v[168:171], v6, s[12:15], 0 offen offset:1152 sc1
    buffer_load_dwordx4 v[172:175], v6, s[12:15], 0 offen offset:1216 sc1
    s_add_u32 s3, s70, 12288
    buffer_load_dwordx4 a[192:195], v4, s[28:31], s3 offen offset:0 sc1
    buffer_load_dwordx4 a[208:211], v4, s[28:31], s3 offen offset:1024 sc1
    buffer_load_dwordx4 a[224:227], v4, s[28:31], s3 offen offset:2048 sc1
    buffer_load_dwordx4 a[240:243], v4, s[28:31], s3 offen offset:3072 sc1
    s_add_u32 s3, s70, 32768
    buffer_load_dwordx4 a[196:199], v4, s[28:31], s3 offen offset:0 sc1
    buffer_load_dwordx4 a[212:215], v4, s[28:31], s3 offen offset:1024 sc1
    buffer_load_dwordx4 a[228:231], v4, s[28:31], s3 offen offset:2048 sc1
    buffer_load_dwordx4 a[244:247], v4, s[28:31], s3 offen offset:3072 sc1
    s_add_u32 s3, s70, 53248
    buffer_load_dwordx4 a[200:203], v4, s[28:31], s3 offen offset:0 sc1
    buffer_load_dwordx4 a[216:219], v4, s[28:31], s3 offen offset:1024 sc1
    buffer_load_dwordx4 a[232:235], v4, s[28:31], s3 offen offset:2048 sc1
    buffer_load_dwordx4 a[248:251], v4, s[28:31], s3 offen offset:3072 sc1
    s_add_u32 s3, s71, 12288
    buffer_load_dwordx4 a[204:207], v4, s[28:31], s3 offen offset:0 sc1
    buffer_load_dwordx4 a[220:223], v4, s[28:31], s3 offen offset:1024 sc1
    buffer_load_dwordx4 a[236:239], v4, s[28:31], s3 offen offset:2048 sc1
    buffer_load_dwordx4 a[252:255], v4, s[28:31], s3 offen offset:3072 sc1
    s_add_u32 s3, s70, 16384
    buffer_load_dwordx4 v[204:207], v4, s[28:31], s3 offen offset:0 sc1
    buffer_load_dwordx4 v[220:223], v4, s[28:31], s3 offen offset:1024 sc1
    s_add_u32 s3, s70, 36864
    buffer_load_dwordx4 v[208:211], v4, s[28:31], s3 offen offset:0 sc1
    buffer_load_dwordx4 v[224:227], v4, s[28:31], s3 offen offset:1024 sc1
    s_add_u32 s3, s70, 57344
    buffer_load_dwordx4 v[212:215], v4, s[28:31], s3 offen offset:0 sc1
    buffer_load_dwordx4 v[228:231], v4, s[28:31], s3 offen offset:1024 sc1
    s_add_u32 s3, s71, 16384
    buffer_load_dwordx4 v[216:219], v4, s[28:31], s3 offen offset:0 sc1
    buffer_load_dwordx4 v[232:235], v4, s[28:31], s3 offen offset:1024 sc1
    s_add_u32 s3, s70, 16384
    buffer_load_dwordx4 v[16:19], v4, s[28:31], s3 offen offset:2048 sc1
    buffer_load_dwordx4 v[32:35], v4, s[28:31], s3 offen offset:3072 sc1
    s_add_u32 s3, s70, 36864
    buffer_load_dwordx4 v[20:23], v4, s[28:31], s3 offen offset:2048 sc1
    buffer_load_dwordx4 v[36:39], v4, s[28:31], s3 offen offset:3072 sc1
    s_add_u32 s3, s70, 57344
    buffer_load_dwordx4 v[24:27], v4, s[28:31], s3 offen offset:2048 sc1
    buffer_load_dwordx4 v[40:43], v4, s[28:31], s3 offen offset:3072 sc1
    s_add_u32 s3, s71, 16384
    buffer_load_dwordx4 v[28:31], v4, s[28:31], s3 offen offset:2048 sc1
    buffer_load_dwordx4 v[44:47], v4, s[28:31], s3 offen offset:3072 sc1
    s_waitcnt vmcnt(32)
    v_mfma_f32_16x16x32_bf16 v[176:179], a[0:3], v[96:99], 0
    v_mfma_f32_16x16x32_bf16 v[180:183], a[4:7], v[96:99], 0
    v_mfma_f32_16x16x32_bf16 v[184:187], a[8:11], v[96:99], 0
    v_mfma_f32_16x16x32_bf16 v[188:191], a[12:15], v[96:99], 0
    v_mfma_f32_16x16x32_bf16 v[176:179], a[16:19], v[100:103], v[176:179]
    v_mfma_f32_16x16x32_bf16 v[180:183], a[20:23], v[100:103], v[180:183]
    v_mfma_f32_16x16x32_bf16 v[184:187], a[24:27], v[100:103], v[184:187]
    v_mfma_f32_16x16x32_bf16 v[188:191], a[28:31], v[100:103], v[188:191]
    v_mfma_f32_16x16x32_bf16 v[176:179], a[32:35], v[104:107], v[176:179]
    v_mfma_f32_16x16x32_bf16 v[180:183], a[36:39], v[104:107], v[180:183]
    v_mfma_f32_16x16x32_bf16 v[184:187], a[40:43], v[104:107], v[184:187]
    v_mfma_f32_16x16x32_bf16 v[188:191], a[44:47], v[104:107], v[188:191]
    v_mfma_f32_16x16x32_bf16 v[176:179], a[48:51], v[108:111], v[176:179]
    v_mfma_f32_16x16x32_bf16 v[180:183], a[52:55], v[108:111], v[180:183]
    v_mfma_f32_16x16x32_bf16 v[184:187], a[56:59], v[108:111], v[184:187]
    v_mfma_f32_16x16x32_bf16 v[188:191], a[60:63], v[108:111], v[188:191]
    v_mfma_f32_16x16x32_bf16 v[176:179], a[64:67], v[112:115], v[176:179]
    v_mfma_f32_16x16x32_bf16 v[180:183], a[68:71], v[112:115], v[180:183]
    v_mfma_f32_16x16x32_bf16 v[184:187], a[72:75], v[112:115], v[184:187]
    v_mfma_f32_16x16x32_bf16 v[188:191], a[76:79], v[112:115], v[188:191]
    v_mfma_f32_16x16x32_bf16 v[176:179], a[80:83], v[116:119], v[176:179]
    v_mfma_f32_16x16x32_bf16 v[180:183], a[84:87], v[116:119], v[180:183]
    v_mfma_f32_16x16x32_bf16 v[184:187], a[88:91], v[116:119], v[184:187]
    v_mfma_f32_16x16x32_bf16 v[188:191], a[92:95], v[116:119], v[188:191]
    v_mfma_f32_16x16x32_bf16 v[176:179], a[96:99], v[120:123], v[176:179]
    v_mfma_f32_16x16x32_bf16 v[180:183], a[100:103], v[120:123], v[180:183]
    v_mfma_f32_16x16x32_bf16 v[184:187], a[104:107], v[120:123], v[184:187]
    v_mfma_f32_16x16x32_bf16 v[188:191], a[108:111], v[120:123], v[188:191]
    v_mfma_f32_16x16x32_bf16 v[176:179], a[112:115], v[124:127], v[176:179]
    v_mfma_f32_16x16x32_bf16 v[180:183], a[116:119], v[124:127], v[180:183]
    v_mfma_f32_16x16x32_bf16 v[184:187], a[120:123], v[124:127], v[184:187]
    v_mfma_f32_16x16x32_bf16 v[188:191], a[124:127], v[124:127], v[188:191]
    v_mfma_f32_16x16x32_bf16 v[176:179], a[128:131], v[128:131], v[176:179]
    v_mfma_f32_16x16x32_bf16 v[180:183], a[132:135], v[128:131], v[180:183]
    v_mfma_f32_16x16x32_bf16 v[184:187], a[136:139], v[128:131], v[184:187]
    v_mfma_f32_16x16x32_bf16 v[188:191], a[140:143], v[128:131], v[188:191]
    v_mfma_f32_16x16x32_bf16 v[176:179], a[144:147], v[132:135], v[176:179]
    v_mfma_f32_16x16x32_bf16 v[180:183], a[148:151], v[132:135], v[180:183]
    v_mfma_f32_16x16x32_bf16 v[184:187], a[152:155], v[132:135], v[184:187]
    v_mfma_f32_16x16x32_bf16 v[188:191], a[156:159], v[132:135], v[188:191]
    v_mfma_f32_16x16x32_bf16 v[176:179], a[160:163], v[136:139], v[176:179]
    v_mfma_f32_16x16x32_bf16 v[180:183], a[164:167], v[136:139], v[180:183]
    v_mfma_f32_16x16x32_bf16 v[184:187], a[168:171], v[136:139], v[184:187]
    v_mfma_f32_16x16x32_bf16 v[188:191], a[172:175], v[136:139], v[188:191]
    v_mfma_f32_16x16x32_bf16 v[176:179], a[176:179], v[140:143], v[176:179]
    v_mfma_f32_16x16x32_bf16 v[180:183], a[180:183], v[140:143], v[180:183]
    v_mfma_f32_16x16x32_bf16 v[184:187], a[184:187], v[140:143], v[184:187]
    v_mfma_f32_16x16x32_bf16 v[188:191], a[188:191], v[140:143], v[188:191]
    s_waitcnt vmcnt(16)
    v_mfma_f32_16x16x32_bf16 v[176:179], a[192:195], v[144:147], v[176:179]
    v_mfma_f32_16x16x32_bf16 v[180:183], a[196:199], v[144:147], v[180:183]
    v_mfma_f32_16x16x32_bf16 v[184:187], a[200:203], v[144:147], v[184:187]
    v_mfma_f32_16x16x32_bf16 v[188:191], a[204:207], v[144:147], v[188:191]
    v_mfma_f32_16x16x32_bf16 v[176:179], a[208:211], v[148:151], v[176:179]
    v_mfma_f32_16x16x32_bf16 v[180:183], a[212:215], v[148:151], v[180:183]
    v_mfma_f32_16x16x32_bf16 v[184:187], a[216:219], v[148:151], v[184:187]
    v_mfma_f32_16x16x32_bf16 v[188:191], a[220:223], v[148:151], v[188:191]
    v_mfma_f32_16x16x32_bf16 v[176:179], a[224:227], v[152:155], v[176:179]
    v_mfma_f32_16x16x32_bf16 v[180:183], a[228:231], v[152:155], v[180:183]
    v_mfma_f32_16x16x32_bf16 v[184:187], a[232:235], v[152:155], v[184:187]
    v_mfma_f32_16x16x32_bf16 v[188:191], a[236:239], v[152:155], v[188:191]
    v_mfma_f32_16x16x32_bf16 v[176:179], a[240:243], v[156:159], v[176:179]
    v_mfma_f32_16x16x32_bf16 v[180:183], a[244:247], v[156:159], v[180:183]
    v_mfma_f32_16x16x32_bf16 v[184:187], a[248:251], v[156:159], v[184:187]
    v_mfma_f32_16x16x32_bf16 v[188:191], a[252:255], v[156:159], v[188:191]
    s_waitcnt vmcnt(0)
    v_mfma_f32_16x16x32_bf16 v[176:179], v[204:207], v[160:163], v[176:179]
    v_mfma_f32_16x16x32_bf16 v[180:183], v[208:211], v[160:163], v[180:183]
    v_mfma_f32_16x16x32_bf16 v[184:187], v[212:215], v[160:163], v[184:187]
    v_mfma_f32_16x16x32_bf16 v[188:191], v[216:219], v[160:163], v[188:191]
    v_mfma_f32_16x16x32_bf16 v[176:179], v[220:223], v[164:167], v[176:179]
    v_mfma_f32_16x16x32_bf16 v[180:183], v[224:227], v[164:167], v[180:183]
    v_mfma_f32_16x16x32_bf16 v[184:187], v[228:231], v[164:167], v[184:187]
    v_mfma_f32_16x16x32_bf16 v[188:191], v[232:235], v[164:167], v[188:191]
    v_mfma_f32_16x16x32_bf16 v[176:179], v[16:19], v[168:171], v[176:179]
    v_mfma_f32_16x16x32_bf16 v[180:183], v[20:23], v[168:171], v[180:183]
    v_mfma_f32_16x16x32_bf16 v[184:187], v[24:27], v[168:171], v[184:187]
    v_mfma_f32_16x16x32_bf16 v[188:191], v[28:31], v[168:171], v[188:191]
    v_mfma_f32_16x16x32_bf16 v[176:179], v[32:35], v[172:175], v[176:179]
    v_mfma_f32_16x16x32_bf16 v[180:183], v[36:39], v[172:175], v[180:183]
    v_mfma_f32_16x16x32_bf16 v[184:187], v[40:43], v[172:175], v[184:187]
    v_mfma_f32_16x16x32_bf16 v[188:191], v[44:47], v[172:175], v[188:191]
    s_mul_hi_u32 s72, s70, 209716
    s_mul_hi_u32 s73, s71, 209716
    s_lshl_b32 s72, s72, 7
    s_lshl_b32 s73, s73, 7
    s_nop 3
    buffer_store_dwordx4 v[176:179], v8, s[16:19], s72 offen offset:0 sc1
    buffer_store_dwordx4 v[180:183], v8, s[16:19], s72 offen offset:128 sc1
    buffer_store_dwordx4 v[184:187], v8, s[16:19], s72 offen offset:256 sc1
    buffer_store_dwordx4 v[188:191], v8, s[16:19], s73 offen offset:0 sc1
    s_waitcnt vmcnt(0)
    s_barrier
    s_cmp_lg_u32 s4, 0
    s_cbranch_scc1 L_post_24
    s_lshl_b32 s10, s67, 7
    s_add_u32 s10, s10, 102400
    v_mov_b32 v10, s8
    v_mov_b32 v11, s9
    s_mov_b64 exec, 1
    buffer_store_dwordx2 v[10:11], off, s[12:15], s10 sc1
    s_mov_b64 exec, -1
L_post_24:
L_no_cjob:
    s_cmp_lg_u32 s2, 255
    s_cbranch_scc1 L_not_keeper
    v_add_u32 v5, 160, v1
    v_lshlrev_b32 v5, 7, v5
    v_add_u32 v5, 4096, v5
    buffer_load_dwordx2 v[10:11], v5, s[12:15], 0 offen sc1
    s_waitcnt vmcnt(0)
    v_cmp_eq_u64 vcc, s[8:9], v[10:11]
    s_cmp_eq_u64 vcc, exec
    s_cbranch_scc1 L_pok_25
    s_mov_b32 s10, 0
L_plp_26:
    s_sleep 2
    buffer_load_dwordx2 v[10:11], v5, s[12:15], 0 offen sc1
    s_add_u32 s10, s10, 1
    s_waitcnt vmcnt(0)
    v_cmp_eq_u64 vcc, s[8:9], v[10:11]
    s_cmp_eq_u64 vcc, exec
    s_cbranch_scc1 L_pok_25
    s_cmp_lt_u32 s10, 40000
    s_cbranch_scc1 L_plp_26
L_pok_25:
    v_add_u32 v5, 4096, v5
    buffer_load_dwordx2 v[10:11], v5, s[12:15], 0 offen sc1
    s_waitcnt vmcnt(0)
    v_cmp_eq_u64 vcc, s[8:9], v[10:11]
    s_cmp_eq_u64 vcc, exec
    s_cbranch_scc1 L_pok_27
    s_mov_b32 s10, 0
L_plp_28:
    s_sleep 2
    buffer_load_dwordx2 v[10:11], v5, s[12:15], 0 offen sc1
    s_add_u32 s10, s10, 1
    s_waitcnt vmcnt(0)
    v_cmp_eq_u64 vcc, s[8:9], v[10:11]
    s_cmp_eq_u64 vcc, exec
    s_cbranch_scc1 L_pok_27
    s_cmp_lt_u32 s10, 40000
    s_cbranch_scc1 L_plp_28
L_pok_27:
L_not_keeper:
L_g1:
    s_mul_i32 s10, s4, 40
    v_min_u32 v5, 39, v1
    v_add_u32 v5, s10, v5
    v_lshlrev_b32 v5, 7, v5
    v_add_u32 v5, 49152, v5
    s_getpc_b64 s[100:101]
    s_lshl_b32 s3, s6, 10
    s_cmp_gt_u32 s3, (L_end-L_g1)-1024
    s_cselect_b32 s3, 0, s3
    v_add_u32 v244, s3, v4
    global_load_dwordx4 v[244:247], v244, s[100:101]
    buffer_load_dwordx2 v[248:249], v5, s[12:15], 0 offen sc1
    v_lshrrev_b32 v2, 4, v1
    v_and_b32 v3, 15, v1
    s_and_b32 s74, s4, 1
    s_lshl_b32 s74, s74, 2
    v_lshrrev_b32 v6, 1, v3
    v_xor_b32 v6, v6, v2
    v_and_b32 v7, 1, v3
    v_lshlrev_b32 v7, 4, v7
    v_lshl_add_u32 v7, v2, 8, v7
    s_lshl_b32 s75, s4, 12
    s_mul_i32 s11, s66, 164096
    s_add_u32 s10, s75, s11
    s_add_u32 s10, s10, 7340032
    v_add_u32 v7, s10, v7
    v_lshl_add_u32 v200, v6, 5, v7
    v_xor_b32 v6, 4, v6
    v_lshl_add_u32 v201, v6, 5, v7
    v_add_u32 v202, 4096, v4
    v_lshrrev_b32 v6, 2, v3
    v_and_b32 v7, 3, v3
    v_and_b32 v8, 1, v2
    v_lshl_or_b32 v8, v8, 2, v6
    v_xor_b32 v8, s74, v8
    v_lshl_add_u32 v6, v2, 3, v6
    v_lshlrev_b32 v6, 8, v6
    v_lshl_add_u32 v6, v7, 3, v6
    v_xor_b32 v7, 0, v8
    v_lshl_add_u32 v192, v7, 5, v6
    v_xor_b32 v7, 1, v8
    v_lshl_add_u32 v193, v7, 5, v6
    v_xor_b32 v7, 2, v8
    v_lshl_add_u32 v194, v7, 5, v6
    v_xor_b32 v7, 3, v8
    v_lshl_add_u32 v195, v7, 5, v6
    v_xor_b32 v7, 4, v8
    v_lshl_add_u32 v196, v7, 5, v6
    v_xor_b32 v7, 5, v8
    v_lshl_add_u32 v197, v7, 5, v6
    v_xor_b32 v7, 6, v8
    v_lshl_add_u32 v198, v7, 5, v6
    v_xor_b32 v7, 7, v8
    v_lshl_add_u32 v199, v7, 5, v6
    s_lshl_b32 s10, s66, 3
    s_lshr_b32 s11, s67, 1
    s_add_u32 s10, s10, s11
    s_mul_i32 s10, s10, 20480
    s_and_b32 s11, s67, 1
    s_lshl_b32 s11, s11, 6
    s_add_u32 s10, s10, s11
    s_mul_i32 s11, s4, 5120
    s_add_u32 s10, s10, s11
    s_add_u32 s10, s10, 14680064
    v_lshrrev_b32 v252, 2, v1
    v_lshlrev_b32 v252, 7, v252
    v_and_b32 v13, 3, v1
    v_lshl_add_u32 v252, v13, 4, v252
    v_add_u32 v252, s10, v252
    v_add_u32 v253, 4096, v252
    v_lshlrev_b32 v254, 4, v13
    v_lshl_add_u32 v254, v2, 6, v254
    s_lshl_b32 s10, s4, 2
    s_add_u32 s10, s10, 155648
    v_add_u32 v254, s10, v254
    v_lshrrev_b32 v203, 5, v1
    v_lshlrev_b32 v203, 7, v203
    s_lshl_b32 s10, s4, 4
    s_add_u32 s10, s10, 155648
    v_add_u32 v203, s10, v203
    v_mov_b32 v13, 2146435072
    v_cmp_gt_u32 vcc, 32, v1
    s_add_u32 s72, s70, 16384
    s_add_u32 s73, s71, 16384
    v_cndmask_b32 v253, v13, v253, vcc
    s_lshl_b32 s10, s4, 4
    v_add_u32 v8, s10, v3
    v_add_u32 v14, 256, v8
    v_add_u32 v15, 272, v8
    v_cmp_gt_u32 vcc, 54, v8
    s_lshl_b32 s10, s67, 7
    s_add_u32 s10, s10, 102400
    v_cndmask_b32 v14, v15, v14, vcc
    v_lshlrev_b32 v14, 7, v14
    v_add_u32 v14, 4096, v14
    v_mov_b32 v6, s10
    s_lshl_b32 s10, s66, 7
    s_lshl_b32 s11, s67, 3
    s_add_u32 s10, s10, s11
    s_lshl_b32 s11, s4, 1
    s_add_u32 s10, s10, s11
    s_lshl_b32 s10, s10, 4
    s_add_u32 s10, s10, 13893632
    v_lshrrev_b32 v7, 5, v1
    v_lshl_add_u32 v7, v7, 4, s10
    v_and_b32 v8, 31, v1
    v_cmp_eq_u32 vcc, 0, v8
    s_mul_i32 s77, s4, 573440
    s_mul_i32 s10, s69, 5120
    v_cndmask_b32 v7, v13, v7, vcc
    s_add_u32 s77, s77, s10
    s_mul_i32 s10, s69, 348160
    s_lshl_b32 s11, s68, 7
    s_add_u32 s10, s10, s11
    s_add_u32 s10, s10, 10485760
    v_lshrrev_b32 v9, 3, v1
    v_mul_u32_u24 v9, 4352, v9
    v_and_b32 v8, 7, v1
    v_lshl_add_u32 v9, v8, 4, v9
    v_add_u32 v9, s10, v9
    s_add_u32 s32, s64, 23068672
    s_addc_u32 s33, s65, 0
    s_and_b32 s33, s33, 0xffff
    s_mov_b32 s34, 2211840
    s_mov_b32 s35, 0x20000
    s_add_u32 s16, s64, 13828096
    s_addc_u32 s17, s65, 0
    s_and_b32 s17, s17, 0xffff
    s_mov_b32 s18, 27648
    s_mov_b32 s19, 0x20000
    s_waitcnt vmcnt(0)
    v_cmp_eq_u64 vcc, s[8:9], v[248:249]
    s_cmp_eq_u64 vcc, exec
    s_cbranch_scc1 L_pok_29
    s_mov_b32 s10, 0
L_plp_30:
    s_sleep 1
    buffer_load_dwordx2 v[248:249], v5, s[12:15], 0 offen sc1
    s_add_u32 s10, s10, 1
    s_waitcnt vmcnt(0)
    v_cmp_eq_u64 vcc, s[8:9], v[248:249]
    s_cmp_eq_u64 vcc, exec
    s_cbranch_scc1 L_pok_29
    s_cmp_lt_u32 s10, 40000
    s_cbranch_scc1 L_plp_30
L_pok_29:
    s_barrier
    s_add_u32 m0, s75, 0
    s_mov_b32 s76, 0
    buffer_load_dwordx4 v200, s[12:15], s76 offen sc1 lds
    buffer_load_dwordx4 v200, s[12:15], s76 offen offset:1024 sc1 lds
    buffer_load_dwordx4 v201, s[12:15], s76 offen offset:2048 sc1 lds
    buffer_load_dwordx4 v201, s[12:15], s76 offen offset:3072 sc1 lds
    s_add_u32 m0, s75, 16384
    s_mov_b32 s76, 16384
    buffer_load_dwordx4 v200, s[12:15], s76 offen sc1 lds
    buffer_load_dwordx4 v200, s[12:15], s76 offen offset:1024 sc1 lds
    buffer_load_dwordx4 v201, s[12:15], s76 offen offset:2048 sc1 lds
    buffer_load_dwordx4 v201, s[12:15], s76 offen offset:3072 sc1 lds
    s_add_u32 m0, s75, 32768
    s_mov_b32 s76, 32768
    buffer_load_dwordx4 v200, s[12:15], s76 offen sc1 lds
    buffer_load_dwordx4 v200, s[12:15], s76 offen offset:1024 sc1 lds
    buffer_load_dwordx4 v201, s[12:15], s76 offen offset:2048 sc1 lds
    buffer_load_dwordx4 v201, s[12:15], s76 offen offset:3072 sc1 lds
    s_cmp_lg_u32 s2, 255
    s_cbranch_scc1 L_no_upd
    v_mov_b32 v15, s8
    buffer_store_dword v15, off, s[12:15], 0 sc1
L_no_upd:
    v_mov_b32 v5, v14
    s_lshl_b32 s11, s4, 12
    s_add_u32 s11, s11, 16384
    v_lshl_add_u32 v10, v3, 4, s11
    s_lshl_b32 s10, s74, 8
    v_add_u32 v11, s10, v10
    s_sub_u32 s10, 1024, s10
    v_add_u32 v12, s10, v10
    v_lshl_add_u32 v13, v2, 4, s11
    s_and_b32 s10, s4, 1
    s_mul_i32 s10, s10, 3
    s_sub_u32 s10, 6, s10
    s_lshl_b32 s10, s10, 7
    v_add_u32 v14, s10, v13
    s_waitcnt vmcnt(8)
    s_barrier
    ds_read_b64_tr_b16 v[128:129], v192 offset:0
    ds_read_b64_tr_b16 v[130:131], v192 offset:1024
    ds_read_b64_tr_b16 v[132:133], v193 offset:0
    ds_read_b64_tr_b16 v[134:135], v193 offset:1024
    ds_read_b64_tr_b16 v[136:137], v194 offset:0
    ds_read_b64_tr_b16 v[138:139], v194 offset:1024
    ds_read_b64_tr_b16 v[140:141], v195 offset:0
    ds_read_b64_tr_b16 v[142:143], v195 offset:1024
    ds_read_b64_tr_b16 v[144:145], v196 offset:0
    ds_read_b64_tr_b16 v[146:147], v196 offset:1024
    ds_read_b64_tr_b16 v[148:149], v197 offset:0
    ds_read_b64_tr_b16 v[150:151], v197 offset:1024
    ds_read_b64_tr_b16 v[152:153], v198 offset:0
    ds_read_b64_tr_b16 v[154:155], v198 offset:1024
    ds_read_b64_tr_b16 v[156:157], v199 offset:0
    ds_read_b64_tr_b16 v[158:159], v199 offset:1024
    s_waitcnt vmcnt(4)
    s_barrier
    s_waitcnt lgkmcnt(0)
    v_mfma_f32_16x16x32_bf16 v[16:19], a[0:3], v[128:131], 0
    ds_read_b64_tr_b16 v[160:161], v192 offset:8192
    s_add_u32 m0, s75, 49152
    v_mfma_f32_16x16x32_bf16 v[48:51], a[4:7], v[128:131], 0
    ds_read_b64_tr_b16 v[162:163], v192 offset:9216
    s_mov_b32 s76, 49152
    v_mfma_f32_16x16x32_bf16 v[80:83], a[8:11], v[128:131], 0
    ds_read_b64_tr_b16 v[164:165], v193 offset:8192
    buffer_load_dwordx4 v200, s[12:15], s76 offen sc1 lds
    v_mfma_f32_16x16x32_bf16 v[112:115], a[12:15], v[128:131], 0
    ds_read_b64_tr_b16 v[166:167], v193 offset:9216
    v_mfma_f32_16x16x32_bf16 v[20:23], a[0:3], v[132:135], 0
    ds_read_b64_tr_b16 v[168:169], v194 offset:8192
    v_mfma_f32_16x16x32_bf16 v[52:55], a[4:7], v[132:135], 0
    ds_read_b64_tr_b16 v[170:171], v194 offset:9216
    v_mfma_f32_16x16x32_bf16 v[84:87], a[8:11], v[132:135], 0
    ds_read_b64_tr_b16 v[172:173], v195 offset:8192
    buffer_load_dwordx4 v200, s[12:15], s76 offen offset:1024 sc1 lds
    v_mfma_f32_16x16x32_bf16 v[116:119], a[12:15], v[132:135], 0
    ds_read_b64_tr_b16 v[174:175], v195 offset:9216
    v_mfma_f32_16x16x32_bf16 v[24:27], a[0:3], v[136:139], 0
    ds_read_b64_tr_b16 v[176:177], v196 offset:8192
    v_mfma_f32_16x16x32_bf16 v[56:59], a[4:7], v[136:139], 0
    ds_read_b64_tr_b16 v[178:179], v196 offset:9216
    v_mfma_f32_16x16x32_bf16 v[88:91], a[8:11], v[136:139], 0
    ds_read_b64_tr_b16 v[180:181], v197 offset:8192
    buffer_load_dwordx4 v201, s[12:15], s76 offen offset:2048 sc1 lds
    v_mfma_f32_16x16x32_bf16 v[120:123], a[12:15], v[136:139], 0
    ds_read_b64_tr_b16 v[182:183], v197 offset:9216
    v_mfma_f32_16x16x32_bf16 v[28:31], a[0:3], v[140:143], 0
    ds_read_b64_tr_b16 v[184:185], v198 offset:8192
    v_mfma_f32_16x16x32_bf16 v[60:63], a[4:7], v[140:143], 0
    ds_read_b64_tr_b16 v[186:187], v198 offset:9216
    v_mfma_f32_16x16x32_bf16 v[92:95], a[8:11], v[140:143], 0
    ds_read_b64_tr_b16 v[188:189], v199 offset:8192
    buffer_load_dwordx4 v201, s[12:15], s76 offen offset:3072 sc1 lds
    v_mfma_f32_16x16x32_bf16 v[124:127], a[12:15], v[140:143], 0
    ds_read_b64_tr_b16 v[190:191], v199 offset:9216
    v_mfma_f32_16x16x32_bf16 v[32:35], a[0:3], v[144:147], 0
    v_mfma_f32_16x16x32_bf16 v[64:67], a[4:7], v[144:147], 0
    v_mfma_f32_16x16x32_bf16 v[96:99], a[8:11], v[144:147], 0
    buffer_load_dwordx2 v[250:251], v5, s[12:15], 0 offen sc1
    v_mfma_f32_16x16x32_bf16 v[36:39], a[0:3], v[148:151], 0
    v_mfma_f32_16x16x32_bf16 v[68:71], a[4:7], v[148:151], 0
    v_mfma_f32_16x16x32_bf16 v[100:103], a[8:11], v[148:151], 0
    v_mfma_f32_16x16x32_bf16 v[40:43], a[0:3], v[152:155], 0
    v_mfma_f32_16x16x32_bf16 v[72:75], a[4:7], v[152:155], 0
    v_mfma_f32_16x16x32_bf16 v[104:107], a[8:11], v[152:155], 0
    v_mfma_f32_16x16x32_bf16 v[44:47], a[0:3], v[156:159], 0
    v_mfma_f32_16x16x32_bf16 v[76:79], a[4:7], v[156:159], 0
    v_mfma_f32_16x16x32_bf16 v[108:111], a[8:11], v[156:159], 0
    s_waitcnt lgkmcnt(0)
    v_mfma_f32_16x16x32_bf16 v[16:19], a[16:19], v[160:163], v[16:19]
    ds_read_b64_tr_b16 v[128:129], v192 offset:16384
    s_add_u32 m0, s75, 65536
    v_mfma_f32_16x16x32_bf16 v[48:51], a[20:23], v[160:163], v[48:51]
    ds_read_b64_tr_b16 v[130:131], v192 offset:17408
    s_mov_b32 s76, 65536
    v_mfma_f32_16x16x32_bf16 v[80:83], a[24:27], v[160:163], v[80:83]
    ds_read_b64_tr_b16 v[132:133], v193 offset:16384
    buffer_load_dwordx4 v200, s[12:15], s76 offen sc1 lds
    v_mfma_f32_16x16x32_bf16 v[112:115], a[28:31], v[160:163], v[112:115]
    ds_read_b64_tr_b16 v[134:135], v193 offset:17408
    v_mfma_f32_16x16x32_bf16 v[20:23], a[16:19], v[164:167], v[20:23]
    ds_read_b64_tr_b16 v[136:137], v194 offset:16384
    v_mfma_f32_16x16x32_bf16 v[52:55], a[20:23], v[164:167], v[52:55]
    ds_read_b64_tr_b16 v[138:139], v194 offset:17408
    v_mfma_f32_16x16x32_bf16 v[84:87], a[24:27], v[164:167], v[84:87]
    ds_read_b64_tr_b16 v[140:141], v195 offset:16384
    buffer_load_dwordx4 v200, s[12:15], s76 offen offset:1024 sc1 lds
    v_mfma_f32_16x16x32_bf16 v[116:119], a[28:31], v[164:167], v[116:119]
    ds_read_b64_tr_b16 v[142:143], v195 offset:17408
    v_mfma_f32_16x16x32_bf16 v[24:27], a[16:19], v[168:171], v[24:27]
    ds_read_b64_tr_b16 v[144:145], v196 offset:16384
    v_mfma_f32_16x16x32_bf16 v[56:59], a[20:23], v[168:171], v[56:59]
    ds_read_b64_tr_b16 v[146:147], v196 offset:17408
    v_mfma_f32_16x16x32_bf16 v[88:91], a[24:27], v[168:171], v[88:91]
    ds_read_b64_tr_b16 v[148:149], v197 offset:16384
    buffer_load_dwordx4 v201, s[12:15], s76 offen offset:2048 sc1 lds
    v_mfma_f32_16x16x32_bf16 v[120:123], a[28:31], v[168:171], v[120:123]
    ds_read_b64_tr_b16 v[150:151], v197 offset:17408
    v_mfma_f32_16x16x32_bf16 v[28:31], a[16:19], v[172:175], v[28:31]
    ds_read_b64_tr_b16 v[152:153], v198 offset:16384
    v_mfma_f32_16x16x32_bf16 v[60:63], a[20:23], v[172:175], v[60:63]
    ds_read_b64_tr_b16 v[154:155], v198 offset:17408
    v_mfma_f32_16x16x32_bf16 v[92:95], a[24:27], v[172:175], v[92:95]
    ds_read_b64_tr_b16 v[156:157], v199 offset:16384
    buffer_load_dwordx4 v201, s[12:15], s76 offen offset:3072 sc1 lds
    v_mfma_f32_16x16x32_bf16 v[124:127], a[28:31], v[172:175], v[124:127]
    ds_read_b64_tr_b16 v[158:159], v199 offset:17408
    v_mfma_f32_16x16x32_bf16 v[32:35], a[16:19], v[176:179], v[32:35]
    v_mfma_f32_16x16x32_bf16 v[64:67], a[20:23], v[176:179], v[64:67]
    v_mfma_f32_16x16x32_bf16 v[96:99], a[24:27], v[176:179], v[96:99]
    v_mfma_f32_16x16x32_bf16 v[36:39], a[16:19], v[180:183], v[36:39]
    v_mfma_f32_16x16x32_bf16 v[68:71], a[20:23], v[180:183], v[68:71]
    v_mfma_f32_16x16x32_bf16 v[100:103], a[24:27], v[180:183], v[100:103]
    v_mfma_f32_16x16x32_bf16 v[40:43], a[16:19], v[184:187], v[40:43]
    v_mfma_f32_16x16x32_bf16 v[72:75], a[20:23], v[184:187], v[72:75]
    v_mfma_f32_16x16x32_bf16 v[104:107], a[24:27], v[184:187], v[104:107]
    v_mfma_f32_16x16x32_bf16 v[44:47], a[16:19], v[188:191], v[44:47]
    v_mfma_f32_16x16x32_bf16 v[76:79], a[20:23], v[188:191], v[76:79]
    v_mfma_f32_16x16x32_bf16 v[108:111], a[24:27], v[188:191], v[108:111]
    s_waitcnt vmcnt(9)
    s_waitcnt lgkmcnt(0)
    s_barrier
    v_mfma_f32_16x16x32_bf16 v[16:19], a[32:35], v[128:131], v[16:19]
    ds_read_b64_tr_b16 v[160:161], v192 offset:24576
    s_add_u32 m0, s75, 81920
    v_mfma_f32_16x16x32_bf16 v[48:51], a[36:39], v[128:131], v[48:51]
    ds_read_b64_tr_b16 v[162:163], v192 offset:25600
    s_mov_b32 s76, 81920
    v_mfma_f32_16x16x32_bf16 v[80:83], a[40:43], v[128:131], v[80:83]
    ds_read_b64_tr_b16 v[164:165], v193 offset:24576
    buffer_load_dwordx4 v200, s[12:15], s76 offen sc1 lds
    v_mfma_f32_16x16x32_bf16 v[112:115], a[44:47], v[128:131], v[112:115]
    ds_read_b64_tr_b16 v[166:167], v193 offset:25600
    v_mfma_f32_16x16x32_bf16 v[20:23], a[32:35], v[132:135], v[20:23]
    ds_read_b64_tr_b16 v[168:169], v194 offset:24576
    v_mfma_f32_16x16x32_bf16 v[52:55], a[36:39], v[132:135], v[52:55]
    ds_read_b64_tr_b16 v[170:171], v194 offset:25600
    v_mfma_f32_16x16x32_bf16 v[84:87], a[40:43], v[132:135], v[84:87]
    ds_read_b64_tr_b16 v[172:173], v195 offset:24576
    buffer_load_dwordx4 v200, s[12:15], s76 offen offset:1024 sc1 lds
    v_mfma_f32_16x16x32_bf16 v[116:119], a[44:47], v[132:135], v[116:119]
    ds_read_b64_tr_b16 v[174:175], v195 offset:25600
    s_add_u32 s3, s72, 0
    v_mfma_f32_16x16x32_bf16 v[24:27], a[32:35], v[136:139], v[24:27]
    ds_read_b64_tr_b16 v[176:177], v196 offset:24576
    v_mfma_f32_16x16x32_bf16 v[56:59], a[36:39], v[136:139], v[56:59]
    ds_read_b64_tr_b16 v[178:179], v196 offset:25600
    v_mfma_f32_16x16x32_bf16 v[88:91], a[40:43], v[136:139], v[88:91]
    ds_read_b64_tr_b16 v[180:181], v197 offset:24576
    buffer_load_dwordx4 a[0:3], v4, s[28:31], s3 offen offset:2048 sc1
    v_mfma_f32_16x16x32_bf16 v[120:123], a[44:47], v[136:139], v[120:123]
    ds_read_b64_tr_b16 v[182:183], v197 offset:25600
    s_add_u32 s3, s72, 20480
    v_mfma_f32_16x16x32_bf16 v[28:31], a[32:35], v[140:143], v[28:31]
    ds_read_b64_tr_b16 v[184:185], v198 offset:24576
    v_mfma_f32_16x16x32_bf16 v[60:63], a[36:39], v[140:143], v[60:63]
    ds_read_b64_tr_b16 v[186:187], v198 offset:25600
    v_mfma_f32_16x16x32_bf16 v[92:95], a[40:43], v[140:143], v[92:95]
    ds_read_b64_tr_b16 v[188:189], v199 offset:24576
    buffer_load_dwordx4 a[4:7], v4, s[28:31], s3 offen offset:2048 sc1
    v_mfma_f32_16x16x32_bf16 v[124:127], a[44:47], v[140:143], v[124:127]
    ds_read_b64_tr_b16 v[190:191], v199 offset:25600
    s_add_u32 s3, s72, 40960
    v_mfma_f32_16x16x32_bf16 v[32:35], a[32:35], v[144:147], v[32:35]
    v_mfma_f32_16x16x32_bf16 v[64:67], a[36:39], v[144:147], v[64:67]
    v_mfma_f32_16x16x32_bf16 v[96:99], a[40:43], v[144:147], v[96:99]
    buffer_load_dwordx4 a[8:11], v4, s[28:31], s3 offen offset:2048 sc1
    v_mfma_f32_16x16x32_bf16 v[36:39], a[32:35], v[148:151], v[36:39]
    v_mfma_f32_16x16x32_bf16 v[68:71], a[36:39], v[148:151], v[68:71]
    v_mfma_f32_16x16x32_bf16 v[100:103], a[40:43], v[148:151], v[100:103]
    v_mfma_f32_16x16x32_bf16 v[40:43], a[32:35], v[152:155], v[40:43]
    buffer_load_dwordx4 a[12:15], v4, s[28:31], s73 offen offset:2048 sc1
    v_mfma_f32_16x16x32_bf16 v[72:75], a[36:39], v[152:155], v[72:75]
    v_mfma_f32_16x16x32_bf16 v[104:107], a[40:43], v[152:155], v[104:107]
    v_mfma_f32_16x16x32_bf16 v[44:47], a[32:35], v[156:159], v[44:47]
    v_mfma_f32_16x16x32_bf16 v[76:79], a[36:39], v[156:159], v[76:79]
    v_mfma_f32_16x16x32_bf16 v[108:111], a[40:43], v[156:159], v[108:111]
    s_waitcnt lgkmcnt(0)
    v_mfma_f32_16x16x32_bf16 v[16:19], a[48:51], v[160:163], v[16:19]
    ds_read_b64_tr_b16 v[128:129], v192 offset:32768
    buffer_load_dwordx4 v201, s[12:15], s76 offen offset:2048 sc1 lds
    v_mfma_f32_16x16x32_bf16 v[48:51], a[52:55], v[160:163], v[48:51]
    ds_read_b64_tr_b16 v[130:131], v192 offset:33792
    v_mfma_f32_16x16x32_bf16 v[80:83], a[56:59], v[160:163], v[80:83]
    ds_read_b64_tr_b16 v[132:133], v193 offset:32768
    v_mfma_f32_16x16x32_bf16 v[112:115], a[60:63], v[160:163], v[112:115]
    ds_read_b64_tr_b16 v[134:135], v193 offset:33792
    v_mfma_f32_16x16x32_bf16 v[20:23], a[48:51], v[164:167], v[20:23]
    ds_read_b64_tr_b16 v[136:137], v194 offset:32768
    buffer_load_dwordx4 v201, s[12:15], s76 offen offset:3072 sc1 lds
    v_mfma_f32_16x16x32_bf16 v[52:55], a[52:55], v[164:167], v[52:55]
    ds_read_b64_tr_b16 v[138:139], v194 offset:33792
    s_add_u32 s3, s72, 0
    v_mfma_f32_16x16x32_bf16 v[84:87], a[56:59], v[164:167], v[84:87]
    ds_read_b64_tr_b16 v[140:141], v195 offset:32768
    v_mfma_f32_16x16x32_bf16 v[116:119], a[60:63], v[164:167], v[116:119]
    ds_read_b64_tr_b16 v[142:143], v195 offset:33792
    v_mfma_f32_16x16x32_bf16 v[24:27], a[48:51], v[168:171], v[24:27]
    ds_read_b64_tr_b16 v[144:145], v196 offset:32768
    buffer_load_dwordx4 a[16:19], v4, s[28:31], s3 offen offset:3072 sc1
    v_mfma_f32_16x16x32_bf16 v[56:59], a[52:55], v[168:171], v[56:59]
    ds_read_b64_tr_b16 v[146:147], v196 offset:33792
    s_add_u32 s3, s72, 20480
    v_mfma_f32_16x16x32_bf16 v[88:91], a[56:59], v[168:171], v[88:91]
    ds_read_b64_tr_b16 v[148:149], v197 offset:32768
    v_mfma_f32_16x16x32_bf16 v[120:123], a[60:63], v[168:171], v[120:123]
    ds_read_b64_tr_b16 v[150:151], v197 offset:33792
    v_mfma_f32_16x16x32_bf16 v[28:31], a[48:51], v[172:175], v[28:31]
    ds_read_b64_tr_b16 v[152:153], v198 offset:32768
    buffer_load_dwordx4 a[20:23], v4, s[28:31], s3 offen offset:3072 sc1
    v_mfma_f32_16x16x32_bf16 v[60:63], a[52:55], v[172:175], v[60:63]
    ds_read_b64_tr_b16 v[154:155], v198 offset:33792
    s_add_u32 s3, s72, 40960
    v_mfma_f32_16x16x32_bf16 v[92:95], a[56:59], v[172:175], v[92:95]
    ds_read_b64_tr_b16 v[156:157], v199 offset:32768
    v_mfma_f32_16x16x32_bf16 v[124:127], a[60:63], v[172:175], v[124:127]
    ds_read_b64_tr_b16 v[158:159], v199 offset:33792
    v_mfma_f32_16x16x32_bf16 v[32:35], a[48:51], v[176:179], v[32:35]
    buffer_load_dwordx4 a[24:27], v4, s[28:31], s3 offen offset:3072 sc1
    v_mfma_f32_16x16x32_bf16 v[64:67], a[52:55], v[176:179], v[64:67]
    v_mfma_f32_16x16x32_bf16 v[96:99], a[56:59], v[176:179], v[96:99]
    v_mfma_f32_16x16x32_bf16 v[36:39], a[48:51], v[180:183], v[36:39]
    v_mfma_f32_16x16x32_bf16 v[68:71], a[52:55], v[180:183], v[68:71]
    buffer_load_dwordx4 a[28:31], v4, s[28:31], s73 offen offset:3072 sc1
    v_mfma_f32_16x16x32_bf16 v[100:103], a[56:59], v[180:183], v[100:103]
    v_mfma_f32_16x16x32_bf16 v[40:43], a[48:51], v[184:187], v[40:43]
    v_mfma_f32_16x16x32_bf16 v[72:75], a[52:55], v[184:187], v[72:75]
    v_mfma_f32_16x16x32_bf16 v[104:107], a[56:59], v[184:187], v[104:107]
    v_mfma_f32_16x16x32_bf16 v[44:47], a[48:51], v[188:191], v[44:47]
    v_mfma_f32_16x16x32_bf16 v[76:79], a[52:55], v[188:191], v[76:79]
    v_mfma_f32_16x16x32_bf16 v[108:111], a[56:59], v[188:191], v[108:111]
    s_waitcnt vmcnt(16)
    v_cmp_eq_u64 vcc, s[8:9], v[250:251]
    s_cmp_eq_u64 vcc, exec
    s_cbranch_scc1 L_pok_31
    s_mov_b32 s10, 0
L_plp_32:
    s_sleep 1
    buffer_load_dwordx2 v[250:251], v5, s[12:15], 0 offen sc1
    s_add_u32 s10, s10, 1
    s_waitcnt vmcnt(0)
    v_cmp_eq_u64 vcc, s[8:9], v[250:251]
    s_cmp_eq_u64 vcc, exec
    s_cbranch_scc1 L_pok_31
    s_cmp_lt_u32 s10, 40000
    s_cbranch_scc1 L_plp_32
L_pok_31:
    s_waitcnt vmcnt(12)
    s_waitcnt lgkmcnt(0)
    s_barrier
    v_mfma_f32_16x16x32_bf16 v[16:19], a[64:67], v[128:131], v[16:19]
    ds_read_b64_tr_b16 v[160:161], v192 offset:40960
    s_add_u32 m0, s75, 98304
    v_mfma_f32_16x16x32_bf16 v[48:51], a[68:71], v[128:131], v[48:51]
    ds_read_b64_tr_b16 v[162:163], v192 offset:41984
    s_mov_b32 s76, 98304
    v_mfma_f32_16x16x32_bf16 v[80:83], a[72:75], v[128:131], v[80:83]
    ds_read_b64_tr_b16 v[164:165], v193 offset:40960
    buffer_load_dwordx4 v200, s[12:15], s76 offen sc1 lds
    v_mfma_f32_16x16x32_bf16 v[112:115], a[76:79], v[128:131], v[112:115]
    ds_read_b64_tr_b16 v[166:167], v193 offset:41984
    v_mfma_f32_16x16x32_bf16 v[20:23], a[64:67], v[132:135], v[20:23]
    ds_read_b64_tr_b16 v[168:169], v194 offset:40960
    v_mfma_f32_16x16x32_bf16 v[52:55], a[68:71], v[132:135], v[52:55]
    ds_read_b64_tr_b16 v[170:171], v194 offset:41984
    v_mfma_f32_16x16x32_bf16 v[84:87], a[72:75], v[132:135], v[84:87]
    ds_read_b64_tr_b16 v[172:173], v195 offset:40960
    buffer_load_dwordx4 v200, s[12:15], s76 offen offset:1024 sc1 lds
    v_mfma_f32_16x16x32_bf16 v[116:119], a[76:79], v[132:135], v[116:119]
    ds_read_b64_tr_b16 v[174:175], v195 offset:41984
    v_mfma_f32_16x16x32_bf16 v[24:27], a[64:67], v[136:139], v[24:27]
    ds_read_b64_tr_b16 v[176:177], v196 offset:40960
    v_mfma_f32_16x16x32_bf16 v[56:59], a[68:71], v[136:139], v[56:59]
    ds_read_b64_tr_b16 v[178:179], v196 offset:41984
    v_mfma_f32_16x16x32_bf16 v[88:91], a[72:75], v[136:139], v[88:91]
    ds_read_b64_tr_b16 v[180:181], v197 offset:40960
    buffer_load_dwordx4 v[236:239], v252, s[12:15], 0 offen offset:0 sc1
    v_mfma_f32_16x16x32_bf16 v[120:123], a[76:79], v[136:139], v[120:123]
    ds_read_b64_tr_b16 v[182:183], v197 offset:41984
    v_mfma_f32_16x16x32_bf16 v[28:31], a[64:67], v[140:143], v[28:31]
    ds_read_b64_tr_b16 v[184:185], v198 offset:40960
    v_mfma_f32_16x16x32_bf16 v[60:63], a[68:71], v[140:143], v[60:63]
    ds_read_b64_tr_b16 v[186:187], v198 offset:41984
    v_mfma_f32_16x16x32_bf16 v[92:95], a[72:75], v[140:143], v[92:95]
    ds_read_b64_tr_b16 v[188:189], v199 offset:40960
    buffer_load_dwordx4 v[240:243], v252, s[12:15], 0 offen offset:2048 sc1
    v_mfma_f32_16x16x32_bf16 v[124:127], a[76:79], v[140:143], v[124:127]
    ds_read_b64_tr_b16 v[190:191], v199 offset:41984
    v_mfma_f32_16x16x32_bf16 v[32:35], a[64:67], v[144:147], v[32:35]
    v_mfma_f32_16x16x32_bf16 v[64:67], a[68:71], v[144:147], v[64:67]
    v_mfma_f32_16x16x32_bf16 v[96:99], a[72:75], v[144:147], v[96:99]
    buffer_load_dwordx4 v[244:247], v253, s[12:15], 0 offen offset:0 sc1
    s_add_u32 s79, s77, 0
    v_mfma_f32_16x16x32_bf16 v[36:39], a[64:67], v[148:151], v[36:39]
    v_mfma_f32_16x16x32_bf16 v[68:71], a[68:71], v[148:151], v[68:71]
    v_mfma_f32_16x16x32_bf16 v[100:103], a[72:75], v[148:151], v[100:103]
    v_mfma_f32_16x16x32_bf16 v[40:43], a[64:67], v[152:155], v[40:43]
    buffer_load_dwordx4 a[32:35], v4, s[32:35], s79 offen offset:0 sc1
    v_mfma_f32_16x16x32_bf16 v[72:75], a[68:71], v[152:155], v[72:75]
    v_mfma_f32_16x16x32_bf16 v[104:107], a[72:75], v[152:155], v[104:107]
    v_mfma_f32_16x16x32_bf16 v[44:47], a[64:67], v[156:159], v[44:47]
    v_mfma_f32_16x16x32_bf16 v[76:79], a[68:71], v[156:159], v[76:79]
    v_mfma_f32_16x16x32_bf16 v[108:111], a[72:75], v[156:159], v[108:111]
    s_waitcnt lgkmcnt(0)
    v_mfma_f32_16x16x32_bf16 v[16:19], a[80:83], v[160:163], v[16:19]
    ds_read_b64_tr_b16 v[128:129], v192 offset:49152
    buffer_load_dwordx4 v201, s[12:15], s76 offen offset:2048 sc1 lds
    v_mfma_f32_16x16x32_bf16 v[48:51], a[84:87], v[160:163], v[48:51]
    ds_read_b64_tr_b16 v[130:131], v192 offset:50176
    v_mfma_f32_16x16x32_bf16 v[80:83], a[88:91], v[160:163], v[80:83]
    ds_read_b64_tr_b16 v[132:133], v193 offset:49152
    v_mfma_f32_16x16x32_bf16 v[112:115], a[92:95], v[160:163], v[112:115]
    ds_read_b64_tr_b16 v[134:135], v193 offset:50176
    v_mfma_f32_16x16x32_bf16 v[20:23], a[80:83], v[164:167], v[20:23]
    ds_read_b64_tr_b16 v[136:137], v194 offset:49152
    buffer_load_dwordx4 v201, s[12:15], s76 offen offset:3072 sc1 lds
    v_mfma_f32_16x16x32_bf16 v[52:55], a[84:87], v[164:167], v[52:55]
    ds_read_b64_tr_b16 v[138:139], v194 offset:50176
    v_mfma_f32_16x16x32_bf16 v[84:87], a[88:91], v[164:167], v[84:87]
    ds_read_b64_tr_b16 v[140:141], v195 offset:49152
    v_mfma_f32_16x16x32_bf16 v[116:119], a[92:95], v[164:167], v[116:119]
    ds_read_b64_tr_b16 v[142:143], v195 offset:50176
    v_mfma_f32_16x16x32_bf16 v[24:27], a[80:83], v[168:171], v[24:27]
    ds_read_b64_tr_b16 v[144:145], v196 offset:49152
    buffer_load_dwordx4 a[36:39], v4, s[32:35], s79 offen offset:1024 sc1
    v_mfma_f32_16x16x32_bf16 v[56:59], a[84:87], v[168:171], v[56:59]
    ds_read_b64_tr_b16 v[146:147], v196 offset:50176
    v_mfma_f32_16x16x32_bf16 v[88:91], a[88:91], v[168:171], v[88:91]
    ds_read_b64_tr_b16 v[148:149], v197 offset:49152
    v_mfma_f32_16x16x32_bf16 v[120:123], a[92:95], v[168:171], v[120:123]
    ds_read_b64_tr_b16 v[150:151], v197 offset:50176
    v_mfma_f32_16x16x32_bf16 v[28:31], a[80:83], v[172:175], v[28:31]
    ds_read_b64_tr_b16 v[152:153], v198 offset:49152
    buffer_load_dwordx4 a[40:43], v4, s[32:35], s79 offen offset:2048 sc1
    v_mfma_f32_16x16x32_bf16 v[60:63], a[84:87], v[172:175], v[60:63]
    ds_read_b64_tr_b16 v[154:155], v198 offset:50176
    v_mfma_f32_16x16x32_bf16 v[92:95], a[88:91], v[172:175], v[92:95]
    ds_read_b64_tr_b16 v[156:157], v199 offset:49152
    v_mfma_f32_16x16x32_bf16 v[124:127], a[92:95], v[172:175], v[124:127]
    ds_read_b64_tr_b16 v[158:159], v199 offset:50176
    v_mfma_f32_16x16x32_bf16 v[32:35], a[80:83], v[176:179], v[32:35]
    buffer_load_dwordx4 a[44:47], v4, s[32:35], s79 offen offset:3072 sc1
    v_mfma_f32_16x16x32_bf16 v[64:67], a[84:87], v[176:179], v[64:67]
    v_mfma_f32_16x16x32_bf16 v[96:99], a[88:91], v[176:179], v[96:99]
    v_mfma_f32_16x16x32_bf16 v[36:39], a[80:83], v[180:183], v[36:39]
    v_mfma_f32_16x16x32_bf16 v[68:71], a[84:87], v[180:183], v[68:71]
    buffer_load_dwordx4 a[48:51], v202, s[32:35], s79 offen offset:0 sc1
    v_mfma_f32_16x16x32_bf16 v[100:103], a[88:91], v[180:183], v[100:103]
    v_mfma_f32_16x16x32_bf16 v[40:43], a[80:83], v[184:187], v[40:43]
    v_mfma_f32_16x16x32_bf16 v[72:75], a[84:87], v[184:187], v[72:75]
    v_mfma_f32_16x16x32_bf16 v[104:107], a[88:91], v[184:187], v[104:107]
    v_mfma_f32_16x16x32_bf16 v[44:47], a[80:83], v[188:191], v[44:47]
    v_mfma_f32_16x16x32_bf16 v[76:79], a[84:87], v[188:191], v[76:79]
    v_mfma_f32_16x16x32_bf16 v[108:111], a[88:91], v[188:191], v[108:111]
    s_waitcnt lgkmcnt(0)
    s_waitcnt vmcnt(7)
    v_pk_add_f32 v[236:237], v[236:237], v[240:241]
    v_pk_add_f32 v[238:239], v[238:239], v[242:243]
    v_pk_add_f32 v[236:237], v[236:237], v[244:245]
    v_pk_add_f32 v[238:239], v[238:239], v[246:247]
    v_mfma_f32_16x16x32_bf16 v[16:19], a[96:99], v[128:131], v[16:19]
    ds_read_b64_tr_b16 v[160:161], v192 offset:57344
    s_add_u32 m0, s75, 114688
    v_mfma_f32_16x16x32_bf16 v[48:51], a[100:103], v[128:131], v[48:51]
    ds_read_b64_tr_b16 v[162:163], v192 offset:58368
    s_mov_b32 s76, 114688
    v_mfma_f32_16x16x32_bf16 v[80:83], a[104:107], v[128:131], v[80:83]
    ds_read_b64_tr_b16 v[164:165], v193 offset:57344
    buffer_load_dwordx4 v200, s[12:15], s76 offen sc1 lds
    v_mfma_f32_16x16x32_bf16 v[112:115], a[108:111], v[128:131], v[112:115]
    ds_read_b64_tr_b16 v[166:167], v193 offset:58368
    v_mfma_f32_16x16x32_bf16 v[20:23], a[96:99], v[132:135], v[20:23]
    ds_read_b64_tr_b16 v[168:169], v194 offset:57344
    v_mfma_f32_16x16x32_bf16 v[52:55], a[100:103], v[132:135], v[52:55]
    ds_read_b64_tr_b16 v[170:171], v194 offset:58368
    v_mfma_f32_16x16x32_bf16 v[84:87], a[104:107], v[132:135], v[84:87]
    ds_read_b64_tr_b16 v[172:173], v195 offset:57344
    buffer_load_dwordx4 v200, s[12:15], s76 offen offset:1024 sc1 lds
    v_mfma_f32_16x16x32_bf16 v[116:119], a[108:111], v[132:135], v[116:119]
    ds_read_b64_tr_b16 v[174:175], v195 offset:58368
    s_add_u32 s79, s77, 40960
    v_mfma_f32_16x16x32_bf16 v[24:27], a[96:99], v[136:139], v[24:27]
    ds_read_b64_tr_b16 v[176:177], v196 offset:57344
    v_mfma_f32_16x16x32_bf16 v[56:59], a[100:103], v[136:139], v[56:59]
    ds_read_b64_tr_b16 v[178:179], v196 offset:58368
    v_mfma_f32_16x16x32_bf16 v[88:91], a[104:107], v[136:139], v[88:91]
    ds_read_b64_tr_b16 v[180:181], v197 offset:57344
    buffer_load_dwordx4 a[52:55], v4, s[32:35], s79 offen offset:0 sc1
    v_mfma_f32_16x16x32_bf16 v[120:123], a[108:111], v[136:139], v[120:123]
    ds_read_b64_tr_b16 v[182:183], v197 offset:58368
    v_mfma_f32_16x16x32_bf16 v[28:31], a[96:99], v[140:143], v[28:31]
    ds_read_b64_tr_b16 v[184:185], v198 offset:57344
    v_mfma_f32_16x16x32_bf16 v[60:63], a[100:103], v[140:143], v[60:63]
    ds_read_b64_tr_b16 v[186:187], v198 offset:58368
    v_mfma_f32_16x16x32_bf16 v[92:95], a[104:107], v[140:143], v[92:95]
    ds_read_b64_tr_b16 v[188:189], v199 offset:57344
    buffer_load_dwordx4 a[56:59], v4, s[32:35], s79 offen offset:1024 sc1
    v_mfma_f32_16x16x32_bf16 v[124:127], a[108:111], v[140:143], v[124:127]
    ds_read_b64_tr_b16 v[190:191], v199 offset:58368
    v_mfma_f32_16x16x32_bf16 v[32:35], a[96:99], v[144:147], v[32:35]
    v_add_u32 v192, 0x10000, v192
    v_add_u32 v193, 0x10000, v193
    v_mfma_f32_16x16x32_bf16 v[64:67], a[100:103], v[144:147], v[64:67]
    v_add_u32 v194, 0x10000, v194
    v_add_u32 v195, 0x10000, v195
    v_mfma_f32_16x16x32_bf16 v[96:99], a[104:107], v[144:147], v[96:99]
    v_add_u32 v196, 0x10000, v196
    buffer_load_dwordx4 a[60:63], v4, s[32:35], s79 offen offset:2048 sc1
    v_mfma_f32_16x16x32_bf16 v[36:39], a[96:99], v[148:151], v[36:39]
    v_add_u32 v197, 0x10000, v197
    v_add_u32 v198, 0x10000, v198
    v_mfma_f32_16x16x32_bf16 v[68:71], a[100:103], v[148:151], v[68:71]
    v_add_u32 v199, 0x10000, v199
    s_nop 0
    v_mfma_f32_16x16x32_bf16 v[100:103], a[104:107], v[148:151], v[100:103]
    v_add_f32_dpp v236, v236, v236 row_ror:4 row_mask:0xf bank_mask:0xf
    v_add_f32_dpp v237, v237, v237 row_ror:4 row_mask:0xf bank_mask:0xf
    v_mfma_f32_16x16x32_bf16 v[40:43], a[96:99], v[152:155], v[40:43]
    v_add_f32_dpp v238, v238, v238 row_ror:4 row_mask:0xf bank_mask:0xf
    buffer_load_dwordx4 a[64:67], v4, s[32:35], s79 offen offset:3072 sc1
    v_mfma_f32_16x16x32_bf16 v[72:75], a[100:103], v[152:155], v[72:75]
    v_add_f32_dpp v239, v239, v239 row_ror:4 row_mask:0xf bank_mask:0xf
    v_add_f32_dpp v236, v236, v236 row_ror:8 row_mask:0xf bank_mask:0xf
    v_mfma_f32_16x16x32_bf16 v[104:107], a[104:107], v[152:155], v[104:107]
    v_add_f32_dpp v237, v237, v237 row_ror:8 row_mask:0xf bank_mask:0xf
    v_add_f32_dpp v238, v238, v238 row_ror:8 row_mask:0xf bank_mask:0xf
    v_mfma_f32_16x16x32_bf16 v[44:47], a[96:99], v[156:159], v[44:47]
    v_add_f32_dpp v239, v239, v239 row_ror:8 row_mask:0xf bank_mask:0xf
    s_nop 0
    v_mfma_f32_16x16x32_bf16 v[76:79], a[100:103], v[156:159], v[76:79]
    v_mfma_f32_16x16x32_bf16 v[108:111], a[104:107], v[156:159], v[108:111]
    s_waitcnt lgkmcnt(0)
    v_mfma_f32_16x16x32_bf16 v[16:19], a[112:115], v[160:163], v[16:19]
    ds_read_b64_tr_b16 v[128:129], v192 offset:0
    buffer_load_dwordx4 v201, s[12:15], s76 offen offset:2048 sc1 lds
    v_mfma_f32_16x16x32_bf16 v[48:51], a[116:119], v[160:163], v[48:51]
    ds_read_b64_tr_b16 v[130:131], v192 offset:1024
    v_mfma_f32_16x16x32_bf16 v[80:83], a[120:123], v[160:163], v[80:83]
    ds_read_b64_tr_b16 v[132:133], v193 offset:0
    v_mfma_f32_16x16x32_bf16 v[112:115], a[124:127], v[160:163], v[112:115]
    ds_read_b64_tr_b16 v[134:135], v193 offset:1024
    v_mfma_f32_16x16x32_bf16 v[20:23], a[112:115], v[164:167], v[20:23]
    ds_read_b64_tr_b16 v[136:137], v194 offset:0
    buffer_load_dwordx4 v201, s[12:15], s76 offen offset:3072 sc1 lds
    v_mfma_f32_16x16x32_bf16 v[52:55], a[116:119], v[164:167], v[52:55]
    ds_read_b64_tr_b16 v[138:139], v194 offset:1024
    v_mfma_f32_16x16x32_bf16 v[84:87], a[120:123], v[164:167], v[84:87]
    ds_read_b64_tr_b16 v[140:141], v195 offset:0
    v_mfma_f32_16x16x32_bf16 v[116:119], a[124:127], v[164:167], v[116:119]
    ds_read_b64_tr_b16 v[142:143], v195 offset:1024
    v_mfma_f32_16x16x32_bf16 v[24:27], a[112:115], v[168:171], v[24:27]
    ds_read_b64_tr_b16 v[144:145], v196 offset:0
    buffer_load_dwordx4 a[68:71], v202, s[32:35], s79 offen offset:0 sc1
    v_mfma_f32_16x16x32_bf16 v[56:59], a[116:119], v[168:171], v[56:59]
    ds_read_b64_tr_b16 v[146:147], v196 offset:1024
    s_add_u32 s79, s77, 81920
    v_mfma_f32_16x16x32_bf16 v[88:91], a[120:123], v[168:171], v[88:91]
    ds_read_b64_tr_b16 v[148:149], v197 offset:0
    v_mfma_f32_16x16x32_bf16 v[120:123], a[124:127], v[168:171], v[120:123]
    ds_read_b64_tr_b16 v[150:151], v197 offset:1024
    v_mfma_f32_16x16x32_bf16 v[28:31], a[112:115], v[172:175], v[28:31]
    ds_read_b64_tr_b16 v[152:153], v198 offset:0
    buffer_load_dwordx4 a[72:75], v4, s[32:35], s79 offen offset:0 sc1
    v_mfma_f32_16x16x32_bf16 v[60:63], a[116:119], v[172:175], v[60:63]
    ds_read_b64_tr_b16 v[154:155], v198 offset:1024
    v_mfma_f32_16x16x32_bf16 v[92:95], a[120:123], v[172:175], v[92:95]
    ds_read_b64_tr_b16 v[156:157], v199 offset:0
    v_mfma_f32_16x16x32_bf16 v[124:127], a[124:127], v[172:175], v[124:127]
    ds_read_b64_tr_b16 v[158:159], v199 offset:1024
    v_mfma_f32_16x16x32_bf16 v[32:35], a[112:115], v[176:179], v[32:35]
    v_permlane32_swap_b32 v236, v237
    buffer_load_dwordx4 a[76:79], v4, s[32:35], s79 offen offset:1024 sc1
    v_mfma_f32_16x16x32_bf16 v[64:67], a[116:119], v[176:179], v[64:67]
    v_permlane32_swap_b32 v238, v239
    v_add_f32 v236, v236, v237
    v_mfma_f32_16x16x32_bf16 v[96:99], a[120:123], v[176:179], v[96:99]
    v_add_f32 v238, v238, v239
    s_nop 0
    v_mfma_f32_16x16x32_bf16 v[36:39], a[112:115], v[180:183], v[36:39]
    v_permlane16_swap_b32 v236, v238
    v_add_f32 v236, v236, v238
    v_mfma_f32_16x16x32_bf16 v[68:71], a[116:119], v[180:183], v[68:71]
    ds_write_b32 v254, v236
    buffer_load_dwordx4 a[80:83], v4, s[32:35], s79 offen offset:2048 sc1
    v_mfma_f32_16x16x32_bf16 v[100:103], a[120:123], v[180:183], v[100:103]
    v_mfma_f32_16x16x32_bf16 v[40:43], a[112:115], v[184:187], v[40:43]
    v_mfma_f32_16x16x32_bf16 v[72:75], a[116:119], v[184:187], v[72:75]
    v_mfma_f32_16x16x32_bf16 v[104:107], a[120:123], v[184:187], v[104:107]
    v_mfma_f32_16x16x32_bf16 v[44:47], a[112:115], v[188:191], v[44:47]
    v_mfma_f32_16x16x32_bf16 v[76:79], a[116:119], v[188:191], v[76:79]
    v_mfma_f32_16x16x32_bf16 v[108:111], a[120:123], v[188:191], v[108:111]
    s_waitcnt vmcnt(16)
    s_waitcnt lgkmcnt(0)
    s_barrier
    v_mfma_f32_16x16x32_bf16 v[16:19], a[128:131], v[128:131], v[16:19]
    ds_read_b64_tr_b16 v[160:161], v192 offset:8192
    s_add_u32 m0, s75, 131072
    v_mfma_f32_16x16x32_bf16 v[48:51], a[132:135], v[128:131], v[48:51]
    ds_read_b64_tr_b16 v[162:163], v192 offset:9216
    s_mov_b32 s76, 131072
    v_mfma_f32_16x16x32_bf16 v[80:83], a[136:139], v[128:131], v[80:83]
    ds_read_b64_tr_b16 v[164:165], v193 offset:8192
    buffer_load_dwordx4 v200, s[12:15], s76 offen sc1 lds
    v_mfma_f32_16x16x32_bf16 v[112:115], a[140:143], v[128:131], v[112:115]
    ds_read_b64_tr_b16 v[166:167], v193 offset:9216
    v_mfma_f32_16x16x32_bf16 v[20:23], a[128:131], v[132:135], v[20:23]
    ds_read_b64_tr_b16 v[168:169], v194 offset:8192
    v_mfma_f32_16x16x32_bf16 v[52:55], a[132:135], v[132:135], v[52:55]
    ds_read_b64_tr_b16 v[170:171], v194 offset:9216
    v_mfma_f32_16x16x32_bf16 v[84:87], a[136:139], v[132:135], v[84:87]
    ds_read_b64_tr_b16 v[172:173], v195 offset:8192
    buffer_load_dwordx4 v200, s[12:15], s76 offen offset:1024 sc1 lds
    v_mfma_f32_16x16x32_bf16 v[116:119], a[140:143], v[132:135], v[116:119]
    ds_read_b64_tr_b16 v[174:175], v195 offset:9216
    v_mfma_f32_16x16x32_bf16 v[24:27], a[128:131], v[136:139], v[24:27]
    ds_read_b64_tr_b16 v[176:177], v196 offset:8192
    v_mfma_f32_16x16x32_bf16 v[56:59], a[132:135], v[136:139], v[56:59]
    ds_read_b64_tr_b16 v[178:179], v196 offset:9216
    v_mfma_f32_16x16x32_bf16 v[88:91], a[136:139], v[136:139], v[88:91]
    ds_read_b64_tr_b16 v[180:181], v197 offset:8192
    buffer_load_dwordx4 a[84:87], v4, s[32:35], s79 offen offset:3072 sc1
    v_mfma_f32_16x16x32_bf16 v[120:123], a[140:143], v[136:139], v[120:123]
    ds_read_b64_tr_b16 v[182:183], v197 offset:9216
    v_mfma_f32_16x16x32_bf16 v[28:31], a[128:131], v[140:143], v[28:31]
    ds_read_b64_tr_b16 v[184:185], v198 offset:8192
    v_mfma_f32_16x16x32_bf16 v[60:63], a[132:135], v[140:143], v[60:63]
    ds_read_b64_tr_b16 v[186:187], v198 offset:9216
    v_mfma_f32_16x16x32_bf16 v[92:95], a[136:139], v[140:143], v[92:95]
    ds_read_b64_tr_b16 v[188:189], v199 offset:8192
    buffer_load_dwordx4 a[88:91], v202, s[32:35], s79 offen offset:0 sc1
    v_mfma_f32_16x16x32_bf16 v[124:127], a[140:143], v[140:143], v[124:127]
    ds_read_b64_tr_b16 v[190:191], v199 offset:9216
    s_add_u32 s79, s77, 122880
    v_mfma_f32_16x16x32_bf16 v[32:35], a[128:131], v[144:147], v[32:35]
    ds_read_b128 v[236:239], v203
    ds_read_b128 v[240:243], v203 offset:64
    v_mfma_f32_16x16x32_bf16 v[64:67], a[132:135], v[144:147], v[64:67]
    v_mfma_f32_16x16x32_bf16 v[96:99], a[136:139], v[144:147], v[96:99]
    buffer_load_dwordx4 a[92:95], v4, s[32:35], s79 offen offset:0 sc1
    v_mfma_f32_16x16x32_bf16 v[36:39], a[128:131], v[148:151], v[36:39]
    v_mfma_f32_16x16x32_bf16 v[68:71], a[132:135], v[148:151], v[68:71]
    v_mfma_f32_16x16x32_bf16 v[100:103], a[136:139], v[148:151], v[100:103]
    v_mfma_f32_16x16x32_bf16 v[40:43], a[128:131], v[152:155], v[40:43]
    buffer_load_dwordx4 a[96:99], v4, s[32:35], s79 offen offset:1024 sc1
    v_mfma_f32_16x16x32_bf16 v[72:75], a[132:135], v[152:155], v[72:75]
    v_mfma_f32_16x16x32_bf16 v[104:107], a[136:139], v[152:155], v[104:107]
    v_mfma_f32_16x16x32_bf16 v[44:47], a[128:131], v[156:159], v[44:47]
    v_mfma_f32_16x16x32_bf16 v[76:79], a[132:135], v[156:159], v[76:79]
    v_mfma_f32_16x16x32_bf16 v[108:111], a[136:139], v[156:159], v[108:111]
    s_waitcnt lgkmcnt(0)
    v_mfma_f32_16x16x32_bf16 v[16:19], a[144:147], v[160:163], v[16:19]
    ds_read_b64_tr_b16 v[128:129], v192 offset:16384
    buffer_load_dwordx4 v201, s[12:15], s76 offen offset:2048 sc1 lds
    v_mfma_f32_16x16x32_bf16 v[48:51], a[148:151], v[160:163], v[48:51]
    ds_read_b64_tr_b16 v[130:131], v192 offset:17408
    v_mfma_f32_16x16x32_bf16 v[80:83], a[152:155], v[160:163], v[80:83]
    ds_read_b64_tr_b16 v[132:133], v193 offset:16384
    v_mfma_f32_16x16x32_bf16 v[112:115], a[156:159], v[160:163], v[112:115]
    ds_read_b64_tr_b16 v[134:135], v193 offset:17408
    v_mfma_f32_16x16x32_bf16 v[20:23], a[144:147], v[164:167], v[20:23]
    ds_read_b64_tr_b16 v[136:137], v194 offset:16384
    buffer_load_dwordx4 v201, s[12:15], s76 offen offset:3072 sc1 lds
    v_mfma_f32_16x16x32_bf16 v[52:55], a[148:151], v[164:167], v[52:55]
    ds_read_b64_tr_b16 v[138:139], v194 offset:17408
    v_mfma_f32_16x16x32_bf16 v[84:87], a[152:155], v[164:167], v[84:87]
    ds_read_b64_tr_b16 v[140:141], v195 offset:16384
    v_mfma_f32_16x16x32_bf16 v[116:119], a[156:159], v[164:167], v[116:119]
    ds_read_b64_tr_b16 v[142:143], v195 offset:17408
    v_mfma_f32_16x16x32_bf16 v[24:27], a[144:147], v[168:171], v[24:27]
    ds_read_b64_tr_b16 v[144:145], v196 offset:16384
    buffer_load_dwordx4 a[100:103], v4, s[32:35], s79 offen offset:2048 sc1
    v_mfma_f32_16x16x32_bf16 v[56:59], a[148:151], v[168:171], v[56:59]
    ds_read_b64_tr_b16 v[146:147], v196 offset:17408
    v_mfma_f32_16x16x32_bf16 v[88:91], a[152:155], v[168:171], v[88:91]
    ds_read_b64_tr_b16 v[148:149], v197 offset:16384
    v_mfma_f32_16x16x32_bf16 v[120:123], a[156:159], v[168:171], v[120:123]
    ds_read_b64_tr_b16 v[150:151], v197 offset:17408
    v_mfma_f32_16x16x32_bf16 v[28:31], a[144:147], v[172:175], v[28:31]
    ds_read_b64_tr_b16 v[152:153], v198 offset:16384
    buffer_load_dwordx4 a[104:107], v4, s[32:35], s79 offen offset:3072 sc1
    v_mfma_f32_16x16x32_bf16 v[60:63], a[148:151], v[172:175], v[60:63]
    ds_read_b64_tr_b16 v[154:155], v198 offset:17408
    v_mfma_f32_16x16x32_bf16 v[92:95], a[152:155], v[172:175], v[92:95]
    ds_read_b64_tr_b16 v[156:157], v199 offset:16384
    v_mfma_f32_16x16x32_bf16 v[124:127], a[156:159], v[172:175], v[124:127]
    ds_read_b64_tr_b16 v[158:159], v199 offset:17408
    v_mfma_f32_16x16x32_bf16 v[32:35], a[144:147], v[176:179], v[32:35]
    v_add_f32 v236, v236, v237
    buffer_load_dwordx4 a[108:111], v202, s[32:35], s79 offen offset:0 sc1
    v_mfma_f32_16x16x32_bf16 v[64:67], a[148:151], v[176:179], v[64:67]
    v_add_f32 v238, v238, v239
    s_add_u32 s79, s77, 163840
    v_mfma_f32_16x16x32_bf16 v[96:99], a[152:155], v[176:179], v[96:99]
    v_add_f32 v240, v240, v241
    v_add_f32 v242, v242, v243
    v_mfma_f32_16x16x32_bf16 v[36:39], a[144:147], v[180:183], v[36:39]
    v_add_f32 v236, v236, v238
    v_add_f32 v238, v240, v242
    v_mfma_f32_16x16x32_bf16 v[68:71], a[148:151], v[180:183], v[68:71]
    v_mov_b32 v244, 0x3acccccd
    buffer_load_dwordx4 a[112:115], v4, s[32:35], s79 offen offset:0 sc1
    v_mfma_f32_16x16x32_bf16 v[100:103], a[152:155], v[180:183], v[100:103]
    v_mov_b32 v241, s8
    v_mov_b32 v243, s9
    v_mfma_f32_16x16x32_bf16 v[40:43], a[144:147], v[184:187], v[40:43]
    v_mul_f32 v236, v236, v244
    v_mul_f32 v237, v236, v236
    v_mfma_f32_16x16x32_bf16 v[72:75], a[148:151], v[184:187], v[72:75]
    v_fma_f32 v238, v238, v244, -v237
    v_max_f32 v238, 0, v238
    v_mfma_f32_16x16x32_bf16 v[104:107], a[152:155], v[184:187], v[104:107]
    v_add_f32 v238, 0x3727c5ac, v238
    v_rsq_f32 v240, v238
    v_mfma_f32_16x16x32_bf16 v[44:47], a[144:147], v[188:191], v[44:47]
    s_nop 0
    v_mul_f32 v242, v236, v240
    v_mfma_f32_16x16x32_bf16 v[76:79], a[148:151], v[188:191], v[76:79]
    v_mfma_f32_16x16x32_bf16 v[108:111], a[152:155], v[188:191], v[108:111]
    s_waitcnt lgkmcnt(0)
    v_mfma_f32_16x16x32_bf16 v[16:19], a[160:163], v[128:131], v[16:19]
    ds_read_b64_tr_b16 v[160:161], v192 offset:24576
    buffer_store_dwordx4 v[240:243], v7, s[12:15], 0 offen sc1
    v_mfma_f32_16x16x32_bf16 v[48:51], a[164:167], v[128:131], v[48:51]
    ds_read_b64_tr_b16 v[162:163], v192 offset:25600
    v_mfma_f32_16x16x32_bf16 v[80:83], a[168:171], v[128:131], v[80:83]
    ds_read_b64_tr_b16 v[164:165], v193 offset:24576
    v_mfma_f32_16x16x32_bf16 v[112:115], a[172:175], v[128:131], v[112:115]
    ds_read_b64_tr_b16 v[166:167], v193 offset:25600
    v_mfma_f32_16x16x32_bf16 v[20:23], a[160:163], v[132:135], v[20:23]
    ds_read_b64_tr_b16 v[168:169], v194 offset:24576
    buffer_load_dwordx4 a[116:119], v4, s[32:35], s79 offen offset:1024 sc1
    v_mfma_f32_16x16x32_bf16 v[52:55], a[164:167], v[132:135], v[52:55]
    ds_read_b64_tr_b16 v[170:171], v194 offset:25600
    v_mfma_f32_16x16x32_bf16 v[84:87], a[168:171], v[132:135], v[84:87]
    ds_read_b64_tr_b16 v[172:173], v195 offset:24576
    v_mfma_f32_16x16x32_bf16 v[116:119], a[172:175], v[132:135], v[116:119]
    ds_read_b64_tr_b16 v[174:175], v195 offset:25600
    v_mfma_f32_16x16x32_bf16 v[24:27], a[160:163], v[136:139], v[24:27]
    ds_read_b64_tr_b16 v[176:177], v196 offset:24576
    buffer_load_dwordx4 a[120:123], v4, s[32:35], s79 offen offset:2048 sc1
    v_mfma_f32_16x16x32_bf16 v[56:59], a[164:167], v[136:139], v[56:59]
    ds_read_b64_tr_b16 v[178:179], v196 offset:25600
    v_mfma_f32_16x16x32_bf16 v[88:91], a[168:171], v[136:139], v[88:91]
    ds_read_b64_tr_b16 v[180:181], v197 offset:24576
    v_mfma_f32_16x16x32_bf16 v[120:123], a[172:175], v[136:139], v[120:123]
    ds_read_b64_tr_b16 v[182:183], v197 offset:25600
    v_mfma_f32_16x16x32_bf16 v[28:31], a[160:163], v[140:143], v[28:31]
    ds_read_b64_tr_b16 v[184:185], v198 offset:24576
    buffer_load_dwordx4 a[124:127], v4, s[32:35], s79 offen offset:3072 sc1
    v_mfma_f32_16x16x32_bf16 v[60:63], a[164:167], v[140:143], v[60:63]
    ds_read_b64_tr_b16 v[186:187], v198 offset:25600
    v_mfma_f32_16x16x32_bf16 v[92:95], a[168:171], v[140:143], v[92:95]
    ds_read_b64_tr_b16 v[188:189], v199 offset:24576
    v_mfma_f32_16x16x32_bf16 v[124:127], a[172:175], v[140:143], v[124:127]
    ds_read_b64_tr_b16 v[190:191], v199 offset:25600
    v_mfma_f32_16x16x32_bf16 v[32:35], a[160:163], v[144:147], v[32:35]
    buffer_load_dwordx4 a[128:131], v202, s[32:35], s79 offen offset:0 sc1
    s_add_u32 s79, s77, 204800
    v_mfma_f32_16x16x32_bf16 v[64:67], a[164:167], v[144:147], v[64:67]
    v_mfma_f32_16x16x32_bf16 v[96:99], a[168:171], v[144:147], v[96:99]
    v_mfma_f32_16x16x32_bf16 v[36:39], a[160:163], v[148:151], v[36:39]
    v_mfma_f32_16x16x32_bf16 v[68:71], a[164:167], v[148:151], v[68:71]
    buffer_load_dwordx4 a[132:135], v4, s[32:35], s79 offen offset:0 sc1
    v_mfma_f32_16x16x32_bf16 v[100:103], a[168:171], v[148:151], v[100:103]
    v_mfma_f32_16x16x32_bf16 v[40:43], a[160:163], v[152:155], v[40:43]
    v_mfma_f32_16x16x32_bf16 v[72:75], a[164:167], v[152:155], v[72:75]
    v_mfma_f32_16x16x32_bf16 v[104:107], a[168:171], v[152:155], v[104:107]
    v_mfma_f32_16x16x32_bf16 v[44:47], a[160:163], v[156:159], v[44:47]
    v_mfma_f32_16x16x32_bf16 v[76:79], a[164:167], v[156:159], v[76:79]
    v_mfma_f32_16x16x32_bf16 v[108:111], a[168:171], v[156:159], v[108:111]
    s_waitcnt lgkmcnt(0)
    v_mfma_f32_16x16x32_bf16 v[16:19], a[176:179], v[160:163], v[16:19]
    ds_read_b64_tr_b16 v[128:129], v192 offset:32768
    buffer_load_dwordx2 v[250:251], v6, s[12:15], 0 offen sc1
    v_mfma_f32_16x16x32_bf16 v[48:51], a[180:183], v[160:163], v[48:51]
    ds_read_b64_tr_b16 v[130:131], v192 offset:33792
    v_mfma_f32_16x16x32_bf16 v[80:83], a[184:187], v[160:163], v[80:83]
    ds_read_b64_tr_b16 v[132:133], v193 offset:32768
    v_mfma_f32_16x16x32_bf16 v[112:115], a[188:191], v[160:163], v[112:115]
    ds_read_b64_tr_b16 v[134:135], v193 offset:33792
    v_mfma_f32_16x16x32_bf16 v[20:23], a[176:179], v[164:167], v[20:23]
    ds_read_b64_tr_b16 v[136:137], v194 offset:32768
    buffer_load_dwordx4 a[136:139], v4, s[32:35], s79 offen offset:1024 sc1
    v_mfma_f32_16x16x32_bf16 v[52:55], a[180:183], v[164:167], v[52:55]
    ds_read_b64_tr_b16 v[138:139], v194 offset:33792
    v_mfma_f32_16x16x32_bf16 v[84:87], a[184:187], v[164:167], v[84:87]
    ds_read_b64_tr_b16 v[140:141], v195 offset:32768
    v_mfma_f32_16x16x32_bf16 v[116:119], a[188:191], v[164:167], v[116:119]
    ds_read_b64_tr_b16 v[142:143], v195 offset:33792
    v_mfma_f32_16x16x32_bf16 v[24:27], a[176:179], v[168:171], v[24:27]
    ds_read_b64_tr_b16 v[144:145], v196 offset:32768
    buffer_load_dwordx4 a[140:143], v4, s[32:35], s79 offen offset:2048 sc1
    v_mfma_f32_16x16x32_bf16 v[56:59], a[180:183], v[168:171], v[56:59]
    ds_read_b64_tr_b16 v[146:147], v196 offset:33792
    v_mfma_f32_16x16x32_bf16 v[88:91], a[184:187], v[168:171], v[88:91]
    ds_read_b64_tr_b16 v[148:149], v197 offset:32768
    v_mfma_f32_16x16x32_bf16 v[120:123], a[188:191], v[168:171], v[120:123]
    ds_read_b64_tr_b16 v[150:151], v197 offset:33792
    v_mfma_f32_16x16x32_bf16 v[28:31], a[176:179], v[172:175], v[28:31]
    ds_read_b64_tr_b16 v[152:153], v198 offset:32768
    buffer_load_dwordx4 a[144:147], v4, s[32:35], s79 offen offset:3072 sc1
    v_mfma_f32_16x16x32_bf16 v[60:63], a[180:183], v[172:175], v[60:63]
    ds_read_b64_tr_b16 v[154:155], v198 offset:33792
    v_mfma_f32_16x16x32_bf16 v[92:95], a[184:187], v[172:175], v[92:95]
    ds_read_b64_tr_b16 v[156:157], v199 offset:32768
    v_mfma_f32_16x16x32_bf16 v[124:127], a[188:191], v[172:175], v[124:127]
    ds_read_b64_tr_b16 v[158:159], v199 offset:33792
    v_mfma_f32_16x16x32_bf16 v[32:35], a[176:179], v[176:179], v[32:35]
    buffer_load_dwordx4 a[148:151], v202, s[32:35], s79 offen offset:0 sc1
    s_add_u32 s79, s77, 245760
    v_mfma_f32_16x16x32_bf16 v[64:67], a[180:183], v[176:179], v[64:67]
    v_mfma_f32_16x16x32_bf16 v[96:99], a[184:187], v[176:179], v[96:99]
    v_mfma_f32_16x16x32_bf16 v[36:39], a[176:179], v[180:183], v[36:39]
    v_mfma_f32_16x16x32_bf16 v[68:71], a[180:183], v[180:183], v[68:71]
    buffer_load_dwordx4 a[152:155], v4, s[32:35], s79 offen offset:0 sc1
    v_mfma_f32_16x16x32_bf16 v[100:103], a[184:187], v[180:183], v[100:103]
    v_mfma_f32_16x16x32_bf16 v[40:43], a[176:179], v[184:187], v[40:43]
    v_mfma_f32_16x16x32_bf16 v[72:75], a[180:183], v[184:187], v[72:75]
    v_mfma_f32_16x16x32_bf16 v[104:107], a[184:187], v[184:187], v[104:107]
    v_mfma_f32_16x16x32_bf16 v[44:47], a[176:179], v[188:191], v[44:47]
    v_mfma_f32_16x16x32_bf16 v[76:79], a[180:183], v[188:191], v[76:79]
    v_mfma_f32_16x16x32_bf16 v[108:111], a[184:187], v[188:191], v[108:111]
    s_waitcnt vmcnt(16)
    s_waitcnt lgkmcnt(0)
    s_barrier
    v_mfma_f32_16x16x32_bf16 v[16:19], a[192:195], v[128:131], v[16:19]
    ds_read_b64_tr_b16 v[160:161], v192 offset:40960
    s_add_u32 m0, s75, 147456
    v_mfma_f32_16x16x32_bf16 v[48:51], a[196:199], v[128:131], v[48:51]
    ds_read_b64_tr_b16 v[162:163], v192 offset:41984
    s_mov_b32 s76, 147456
    v_mfma_f32_16x16x32_bf16 v[80:83], a[200:203], v[128:131], v[80:83]
    ds_read_b64_tr_b16 v[164:165], v193 offset:40960
    buffer_load_dwordx4 v200, s[12:15], s76 offen sc1 lds
    v_mfma_f32_16x16x32_bf16 v[112:115], a[204:207], v[128:131], v[112:115]
    ds_read_b64_tr_b16 v[166:167], v193 offset:41984
    v_mfma_f32_16x16x32_bf16 v[20:23], a[192:195], v[132:135], v[20:23]
    ds_read_b64_tr_b16 v[168:169], v194 offset:40960
    v_mfma_f32_16x16x32_bf16 v[52:55], a[196:199], v[132:135], v[52:55]
    ds_read_b64_tr_b16 v[170:171], v194 offset:41984
    v_mfma_f32_16x16x32_bf16 v[84:87], a[200:203], v[132:135], v[84:87]
    ds_read_b64_tr_b16 v[172:173], v195 offset:40960
    buffer_load_dwordx4 v200, s[12:15], s76 offen offset:1024 sc1 lds
    v_mfma_f32_16x16x32_bf16 v[116:119], a[204:207], v[132:135], v[116:119]
    ds_read_b64_tr_b16 v[174:175], v195 offset:41984
    v_mfma_f32_16x16x32_bf16 v[24:27], a[192:195], v[136:139], v[24:27]
    ds_read_b64_tr_b16 v[176:177], v196 offset:40960
    v_mfma_f32_16x16x32_bf16 v[56:59], a[196:199], v[136:139], v[56:59]
    ds_read_b64_tr_b16 v[178:179], v196 offset:41984
    v_mfma_f32_16x16x32_bf16 v[88:91], a[200:203], v[136:139], v[88:91]
    ds_read_b64_tr_b16 v[180:181], v197 offset:40960
    buffer_load_dwordx4 a[156:159], v4, s[32:35], s79 offen offset:1024 sc1
    v_mfma_f32_16x16x32_bf16 v[120:123], a[204:207], v[136:139], v[120:123]
    ds_read_b64_tr_b16 v[182:183], v197 offset:41984
    v_mfma_f32_16x16x32_bf16 v[28:31], a[192:195], v[140:143], v[28:31]
    ds_read_b64_tr_b16 v[184:185], v198 offset:40960
    v_mfma_f32_16x16x32_bf16 v[60:63], a[196:199], v[140:143], v[60:63]
    ds_read_b64_tr_b16 v[186:187], v198 offset:41984
    v_mfma_f32_16x16x32_bf16 v[92:95], a[200:203], v[140:143], v[92:95]
    ds_read_b64_tr_b16 v[188:189], v199 offset:40960
    buffer_load_dwordx4 a[160:163], v4, s[32:35], s79 offen offset:2048 sc1
    v_mfma_f32_16x16x32_bf16 v[124:127], a[204:207], v[140:143], v[124:127]
    ds_read_b64_tr_b16 v[190:191], v199 offset:41984
    v_mfma_f32_16x16x32_bf16 v[32:35], a[192:195], v[144:147], v[32:35]
    v_mfma_f32_16x16x32_bf16 v[64:67], a[196:199], v[144:147], v[64:67]
    v_mfma_f32_16x16x32_bf16 v[96:99], a[200:203], v[144:147], v[96:99]
    buffer_load_dwordx4 a[164:167], v4, s[32:35], s79 offen offset:3072 sc1
    v_mfma_f32_16x16x32_bf16 v[36:39], a[192:195], v[148:151], v[36:39]
    v_mfma_f32_16x16x32_bf16 v[68:71], a[196:199], v[148:151], v[68:71]
    v_mfma_f32_16x16x32_bf16 v[100:103], a[200:203], v[148:151], v[100:103]
    v_mfma_f32_16x16x32_bf16 v[40:43], a[192:195], v[152:155], v[40:43]
    buffer_load_dwordx4 a[168:171], v202, s[32:35], s79 offen offset:0 sc1
    v_mfma_f32_16x16x32_bf16 v[72:75], a[196:199], v[152:155], v[72:75]
    v_mfma_f32_16x16x32_bf16 v[104:107], a[200:203], v[152:155], v[104:107]
    v_mfma_f32_16x16x32_bf16 v[44:47], a[192:195], v[156:159], v[44:47]
    v_mfma_f32_16x16x32_bf16 v[76:79], a[196:199], v[156:159], v[76:79]
    v_mfma_f32_16x16x32_bf16 v[108:111], a[200:203], v[156:159], v[108:111]
    s_waitcnt lgkmcnt(0)
    v_mfma_f32_16x16x32_bf16 v[16:19], a[208:211], v[160:163], v[16:19]
    ds_read_b64_tr_b16 v[128:129], v192 offset:49152
    buffer_load_dwordx4 v201, s[12:15], s76 offen offset:2048 sc1 lds
    v_mfma_f32_16x16x32_bf16 v[48:51], a[212:215], v[160:163], v[48:51]
    ds_read_b64_tr_b16 v[130:131], v192 offset:50176
    v_mfma_f32_16x16x32_bf16 v[80:83], a[216:219], v[160:163], v[80:83]
    ds_read_b64_tr_b16 v[132:133], v193 offset:49152
    v_mfma_f32_16x16x32_bf16 v[112:115], a[220:223], v[160:163], v[112:115]
    ds_read_b64_tr_b16 v[134:135], v193 offset:50176
    v_mfma_f32_16x16x32_bf16 v[20:23], a[208:211], v[164:167], v[20:23]
    ds_read_b64_tr_b16 v[136:137], v194 offset:49152
    buffer_load_dwordx4 v201, s[12:15], s76 offen offset:3072 sc1 lds
    v_mfma_f32_16x16x32_bf16 v[52:55], a[212:215], v[164:167], v[52:55]
    ds_read_b64_tr_b16 v[138:139], v194 offset:50176
    s_add_u32 s79, s77, 286720
    v_mfma_f32_16x16x32_bf16 v[84:87], a[216:219], v[164:167], v[84:87]
    ds_read_b64_tr_b16 v[140:141], v195 offset:49152
    v_mfma_f32_16x16x32_bf16 v[116:119], a[220:223], v[164:167], v[116:119]
    ds_read_b64_tr_b16 v[142:143], v195 offset:50176
    v_mfma_f32_16x16x32_bf16 v[24:27], a[208:211], v[168:171], v[24:27]
    ds_read_b64_tr_b16 v[144:145], v196 offset:49152
    buffer_load_dwordx4 a[172:175], v4, s[32:35], s79 offen offset:0 sc1
    v_mfma_f32_16x16x32_bf16 v[56:59], a[212:215], v[168:171], v[56:59]
    ds_read_b64_tr_b16 v[146:147], v196 offset:50176
    v_mfma_f32_16x16x32_bf16 v[88:91], a[216:219], v[168:171], v[88:91]
    ds_read_b64_tr_b16 v[148:149], v197 offset:49152
    v_mfma_f32_16x16x32_bf16 v[120:123], a[220:223], v[168:171], v[120:123]
    ds_read_b64_tr_b16 v[150:151], v197 offset:50176
    v_mfma_f32_16x16x32_bf16 v[28:31], a[208:211], v[172:175], v[28:31]
    ds_read_b64_tr_b16 v[152:153], v198 offset:49152
    buffer_load_dwordx4 a[176:179], v4, s[32:35], s79 offen offset:1024 sc1
    v_mfma_f32_16x16x32_bf16 v[60:63], a[212:215], v[172:175], v[60:63]
    ds_read_b64_tr_b16 v[154:155], v198 offset:50176
    v_mfma_f32_16x16x32_bf16 v[92:95], a[216:219], v[172:175], v[92:95]
    ds_read_b64_tr_b16 v[156:157], v199 offset:49152
    v_mfma_f32_16x16x32_bf16 v[124:127], a[220:223], v[172:175], v[124:127]
    ds_read_b64_tr_b16 v[158:159], v199 offset:50176
    v_mfma_f32_16x16x32_bf16 v[32:35], a[208:211], v[176:179], v[32:35]
    buffer_load_dwordx4 a[180:183], v4, s[32:35], s79 offen offset:2048 sc1
    v_mfma_f32_16x16x32_bf16 v[64:67], a[212:215], v[176:179], v[64:67]
    v_mfma_f32_16x16x32_bf16 v[96:99], a[216:219], v[176:179], v[96:99]
    v_mfma_f32_16x16x32_bf16 v[36:39], a[208:211], v[180:183], v[36:39]
    v_mfma_f32_16x16x32_bf16 v[68:71], a[212:215], v[180:183], v[68:71]
    buffer_load_dwordx4 a[184:187], v4, s[32:35], s79 offen offset:3072 sc1
    v_mfma_f32_16x16x32_bf16 v[100:103], a[216:219], v[180:183], v[100:103]
    v_mfma_f32_16x16x32_bf16 v[40:43], a[208:211], v[184:187], v[40:43]
    v_mfma_f32_16x16x32_bf16 v[72:75], a[212:215], v[184:187], v[72:75]
    v_mfma_f32_16x16x32_bf16 v[104:107], a[216:219], v[184:187], v[104:107]
    v_mfma_f32_16x16x32_bf16 v[44:47], a[208:211], v[188:191], v[44:47]
    v_mfma_f32_16x16x32_bf16 v[76:79], a[212:215], v[188:191], v[76:79]
    v_mfma_f32_16x16x32_bf16 v[108:111], a[216:219], v[188:191], v[108:111]
    s_waitcnt lgkmcnt(0)
    s_waitcnt vmcnt(17)
    v_cmp_eq_u64 vcc, s[8:9], v[250:251]
    s_cmp_eq_u64 vcc, exec
    s_cbranch_scc1 L_pok_33
    s_mov_b32 s10, 0
L_plp_34:
    s_sleep 1
    buffer_load_dwordx2 v[250:251], v6, s[12:15], 0 offen sc1
    s_add_u32 s10, s10, 1
    s_waitcnt vmcnt(0)
    v_cmp_eq_u64 vcc, s[8:9], v[250:251]
    s_cmp_eq_u64 vcc, exec
    s_cbranch_scc1 L_pok_33
    s_cmp_lt_u32 s10, 40000
    s_cbranch_scc1 L_plp_34
L_pok_33:
    v_mfma_f32_16x16x32_bf16 v[16:19], a[224:227], v[128:131], v[16:19]
    ds_read_b64_tr_b16 v[160:161], v192 offset:57344
    buffer_load_dwordx4 a[188:191], v202, s[32:35], s79 offen offset:0 sc1
    v_mfma_f32_16x16x32_bf16 v[48:51], a[228:231], v[128:131], v[48:51]
    ds_read_b64_tr_b16 v[162:163], v192 offset:58368
    s_add_u32 s79, s77, 327680
    v_mfma_f32_16x16x32_bf16 v[80:83], a[232:235], v[128:131], v[80:83]
    ds_read_b64_tr_b16 v[164:165], v193 offset:57344
    v_mfma_f32_16x16x32_bf16 v[112:115], a[236:239], v[128:131], v[112:115]
    ds_read_b64_tr_b16 v[166:167], v193 offset:58368
    v_mfma_f32_16x16x32_bf16 v[20:23], a[224:227], v[132:135], v[20:23]
    ds_read_b64_tr_b16 v[168:169], v194 offset:57344
    buffer_load_dwordx4 a[192:195], v4, s[32:35], s79 offen offset:0 sc1
    v_mfma_f32_16x16x32_bf16 v[52:55], a[228:231], v[132:135], v[52:55]
    ds_read_b64_tr_b16 v[170:171], v194 offset:58368
    v_mfma_f32_16x16x32_bf16 v[84:87], a[232:235], v[132:135], v[84:87]
    ds_read_b64_tr_b16 v[172:173], v195 offset:57344
    v_mfma_f32_16x16x32_bf16 v[116:119], a[236:239], v[132:135], v[116:119]
    ds_read_b64_tr_b16 v[174:175], v195 offset:58368
    v_mfma_f32_16x16x32_bf16 v[24:27], a[224:227], v[136:139], v[24:27]
    ds_read_b64_tr_b16 v[176:177], v196 offset:57344
    buffer_load_dwordx4 a[196:199], v4, s[32:35], s79 offen offset:1024 sc1
    v_mfma_f32_16x16x32_bf16 v[56:59], a[228:231], v[136:139], v[56:59]
    ds_read_b64_tr_b16 v[178:179], v196 offset:58368
    v_mfma_f32_16x16x32_bf16 v[88:91], a[232:235], v[136:139], v[88:91]
    ds_read_b64_tr_b16 v[180:181], v197 offset:57344
    v_mfma_f32_16x16x32_bf16 v[120:123], a[236:239], v[136:139], v[120:123]
    ds_read_b64_tr_b16 v[182:183], v197 offset:58368
    v_mfma_f32_16x16x32_bf16 v[28:31], a[224:227], v[140:143], v[28:31]
    ds_read_b64_tr_b16 v[184:185], v198 offset:57344
    buffer_load_dwordx4 a[200:203], v4, s[32:35], s79 offen offset:2048 sc1
    v_mfma_f32_16x16x32_bf16 v[60:63], a[228:231], v[140:143], v[60:63]
    ds_read_b64_tr_b16 v[186:187], v198 offset:58368
    v_mfma_f32_16x16x32_bf16 v[92:95], a[232:235], v[140:143], v[92:95]
    ds_read_b64_tr_b16 v[188:189], v199 offset:57344
    v_mfma_f32_16x16x32_bf16 v[124:127], a[236:239], v[140:143], v[124:127]
    ds_read_b64_tr_b16 v[190:191], v199 offset:58368
    v_mfma_f32_16x16x32_bf16 v[32:35], a[224:227], v[144:147], v[32:35]
    v_add_u32 v192, 0x10000, v192
    buffer_load_dwordx4 a[204:207], v4, s[32:35], s79 offen offset:3072 sc1
    v_mfma_f32_16x16x32_bf16 v[64:67], a[228:231], v[144:147], v[64:67]
    v_add_u32 v193, 0x10000, v193
    v_add_u32 v194, 0x10000, v194
    v_mfma_f32_16x16x32_bf16 v[96:99], a[232:235], v[144:147], v[96:99]
    v_add_u32 v195, 0x10000, v195
    v_add_u32 v196, 0x10000, v196
    v_mfma_f32_16x16x32_bf16 v[36:39], a[224:227], v[148:151], v[36:39]
    v_add_u32 v197, 0x10000, v197
    v_add_u32 v198, 0x10000, v198
    v_mfma_f32_16x16x32_bf16 v[68:71], a[228:231], v[148:151], v[68:71]
    v_add_u32 v199, 0x10000, v199
    v_mfma_f32_16x16x32_bf16 v[100:103], a[232:235], v[148:151], v[100:103]
    v_mfma_f32_16x16x32_bf16 v[40:43], a[224:227], v[152:155], v[40:43]
    v_mfma_f32_16x16x32_bf16 v[72:75], a[228:231], v[152:155], v[72:75]
    v_mfma_f32_16x16x32_bf16 v[104:107], a[232:235], v[152:155], v[104:107]
    v_mfma_f32_16x16x32_bf16 v[44:47], a[224:227], v[156:159], v[44:47]
    v_mfma_f32_16x16x32_bf16 v[76:79], a[228:231], v[156:159], v[76:79]
    v_mfma_f32_16x16x32_bf16 v[108:111], a[232:235], v[156:159], v[108:111]
    s_waitcnt lgkmcnt(0)
    v_mfma_f32_16x16x32_bf16 v[16:19], a[240:243], v[160:163], v[16:19]
    ds_read_b64_tr_b16 v[128:129], v192 offset:0
    s_add_u32 s11, s4, 0
    v_mfma_f32_16x16x32_bf16 v[48:51], a[244:247], v[160:163], v[48:51]
    ds_read_b64_tr_b16 v[130:131], v192 offset:1024
    s_lshl_b32 s3, s11, 10
    v_mfma_f32_16x16x32_bf16 v[80:83], a[248:251], v[160:163], v[80:83]
    ds_read_b64_tr_b16 v[132:133], v193 offset:0
    s_add_u32 m0, s3, 0
    v_mfma_f32_16x16x32_bf16 v[112:115], a[252:255], v[160:163], v[112:115]
    ds_read_b64_tr_b16 v[134:135], v193 offset:1024
    s_mul_i32 s3, s11, 34816
    v_mfma_f32_16x16x32_bf16 v[20:23], a[240:243], v[164:167], v[20:23]
    ds_read_b64_tr_b16 v[136:137], v194 offset:0
    buffer_load_dwordx4 v9, s[12:15], s3 offen sc1 lds
    v_mfma_f32_16x16x32_bf16 v[52:55], a[244:247], v[164:167], v[52:55]
    ds_read_b64_tr_b16 v[138:139], v194 offset:1024
    s_add_u32 s11, s4, 4
    v_mfma_f32_16x16x32_bf16 v[84:87], a[248:251], v[164:167], v[84:87]
    ds_read_b64_tr_b16 v[140:141], v195 offset:0
    s_lshl_b32 s3, s11, 10
    v_mfma_f32_16x16x32_bf16 v[116:119], a[252:255], v[164:167], v[116:119]
    ds_read_b64_tr_b16 v[142:143], v195 offset:1024
    s_add_u32 m0, s3, 0
    v_mfma_f32_16x16x32_bf16 v[24:27], a[240:243], v[168:171], v[24:27]
    ds_read_b64_tr_b16 v[144:145], v196 offset:0
    s_mul_i32 s3, s11, 34816
    v_mfma_f32_16x16x32_bf16 v[56:59], a[244:247], v[168:171], v[56:59]
    ds_read_b64_tr_b16 v[146:147], v196 offset:1024
    buffer_load_dwordx4 v9, s[12:15], s3 offen sc1 lds
    v_mfma_f32_16x16x32_bf16 v[88:91], a[248:251], v[168:171], v[88:91]
    ds_read_b64_tr_b16 v[148:149], v197 offset:0
    s_add_u32 s11, s4, 8
    v_mfma_f32_16x16x32_bf16 v[120:123], a[252:255], v[168:171], v[120:123]
    ds_read_b64_tr_b16 v[150:151], v197 offset:1024
    s_lshl_b32 s3, s11, 10
    v_mfma_f32_16x16x32_bf16 v[28:31], a[240:243], v[172:175], v[28:31]
    ds_read_b64_tr_b16 v[152:153], v198 offset:0
    s_add_u32 m0, s3, 0
    v_mfma_f32_16x16x32_bf16 v[60:63], a[244:247], v[172:175], v[60:63]
    ds_read_b64_tr_b16 v[154:155], v198 offset:1024
    s_mul_i32 s3, s11, 34816
    v_mfma_f32_16x16x32_bf16 v[92:95], a[248:251], v[172:175], v[92:95]
    ds_read_b64_tr_b16 v[156:157], v199 offset:0
    buffer_load_dwordx4 v9, s[12:15], s3 offen sc1 lds
    v_mfma_f32_16x16x32_bf16 v[124:127], a[252:255], v[172:175], v[124:127]
    ds_read_b64_tr_b16 v[158:159], v199 offset:1024
    v_mfma_f32_16x16x32_bf16 v[32:35], a[240:243], v[176:179], v[32:35]
    v_mfma_f32_16x16x32_bf16 v[64:67], a[244:247], v[176:179], v[64:67]
    v_mfma_f32_16x16x32_bf16 v[96:99], a[248:251], v[176:179], v[96:99]
    buffer_load_dwordx4 a[208:211], v202, s[32:35], s79 offen offset:0 sc1
    s_add_u32 s79, s77, 368640
    v_mfma_f32_16x16x32_bf16 v[36:39], a[240:243], v[180:183], v[36:39]
    v_mfma_f32_16x16x32_bf16 v[68:71], a[244:247], v[180:183], v[68:71]
    v_mfma_f32_16x16x32_bf16 v[100:103], a[248:251], v[180:183], v[100:103]
    v_mfma_f32_16x16x32_bf16 v[40:43], a[240:243], v[184:187], v[40:43]
    buffer_load_dwordx4 a[212:215], v4, s[32:35], s79 offen offset:0 sc1
    v_mfma_f32_16x16x32_bf16 v[72:75], a[244:247], v[184:187], v[72:75]
    v_mfma_f32_16x16x32_bf16 v[104:107], a[248:251], v[184:187], v[104:107]
    v_mfma_f32_16x16x32_bf16 v[44:47], a[240:243], v[188:191], v[44:47]
    v_mfma_f32_16x16x32_bf16 v[76:79], a[244:247], v[188:191], v[76:79]
    buffer_load_dwordx4 a[216:219], v4, s[32:35], s79 offen offset:1024 sc1
    v_mfma_f32_16x16x32_bf16 v[108:111], a[248:251], v[188:191], v[108:111]
    s_waitcnt vmcnt(15)
    s_waitcnt lgkmcnt(0)
    s_barrier
    v_mfma_f32_16x16x32_bf16 v[16:19], v[204:207], v[128:131], v[16:19]
    ds_read_b64_tr_b16 v[160:161], v192 offset:8192
    s_lshl_b32 s11, s4, 12
    v_mfma_f32_16x16x32_bf16 v[48:51], v[208:211], v[128:131], v[48:51]
    ds_read_b64_tr_b16 v[162:163], v192 offset:9216
    s_add_u32 m0, s11, 16384
    v_mfma_f32_16x16x32_bf16 v[80:83], v[212:215], v[128:131], v[80:83]
    ds_read_b64_tr_b16 v[164:165], v193 offset:8192
    s_lshl_b32 s3, s66, 11
    v_mfma_f32_16x16x32_bf16 v[112:115], v[216:219], v[128:131], v[112:115]
    ds_read_b64_tr_b16 v[166:167], v193 offset:9216
    s_add_u32 s3, s3, 13893632
    v_mfma_f32_16x16x32_bf16 v[20:23], v[204:207], v[132:135], v[20:23]
    ds_read_b64_tr_b16 v[168:169], v194 offset:8192
    buffer_load_dwordx4 v4, s[12:15], s3 offen sc1 lds
    v_mfma_f32_16x16x32_bf16 v[52:55], v[208:211], v[132:135], v[52:55]
    ds_read_b64_tr_b16 v[170:171], v194 offset:9216
    v_mfma_f32_16x16x32_bf16 v[84:87], v[212:215], v[132:135], v[84:87]
    ds_read_b64_tr_b16 v[172:173], v195 offset:8192
    v_mfma_f32_16x16x32_bf16 v[116:119], v[216:219], v[132:135], v[116:119]
    ds_read_b64_tr_b16 v[174:175], v195 offset:9216
    v_mfma_f32_16x16x32_bf16 v[24:27], v[204:207], v[136:139], v[24:27]
    ds_read_b64_tr_b16 v[176:177], v196 offset:8192
    buffer_load_dwordx4 v4, s[12:15], s3 offen offset:1024 sc1 lds
    v_mfma_f32_16x16x32_bf16 v[56:59], v[208:211], v[136:139], v[56:59]
    ds_read_b64_tr_b16 v[178:179], v196 offset:9216
    s_add_u32 m0, s11, 18432
    v_mfma_f32_16x16x32_bf16 v[88:91], v[212:215], v[136:139], v[88:91]
    ds_read_b64_tr_b16 v[180:181], v197 offset:8192
    s_mul_hi_u32 s3, s70, 209716
    v_mfma_f32_16x16x32_bf16 v[120:123], v[216:219], v[136:139], v[120:123]
    ds_read_b64_tr_b16 v[182:183], v197 offset:9216
    s_lshl_b32 s3, s3, 7
    v_mfma_f32_16x16x32_bf16 v[28:31], v[204:207], v[140:143], v[28:31]
    ds_read_b64_tr_b16 v[184:185], v198 offset:8192
    buffer_load_dwordx4 v4, s[16:19], s3 offen sc1 lds
    v_mfma_f32_16x16x32_bf16 v[60:63], v[208:211], v[140:143], v[60:63]
    ds_read_b64_tr_b16 v[186:187], v198 offset:9216
    v_mfma_f32_16x16x32_bf16 v[92:95], v[212:215], v[140:143], v[92:95]
    ds_read_b64_tr_b16 v[188:189], v199 offset:8192
    v_mfma_f32_16x16x32_bf16 v[124:127], v[216:219], v[140:143], v[124:127]
    ds_read_b64_tr_b16 v[190:191], v199 offset:9216
    v_mfma_f32_16x16x32_bf16 v[32:35], v[204:207], v[144:147], v[32:35]
    buffer_load_dwordx4 a[220:223], v4, s[32:35], s79 offen offset:2048 sc1
    v_mfma_f32_16x16x32_bf16 v[64:67], v[208:211], v[144:147], v[64:67]
    v_mfma_f32_16x16x32_bf16 v[96:99], v[212:215], v[144:147], v[96:99]
    v_mfma_f32_16x16x32_bf16 v[36:39], v[204:207], v[148:151], v[36:39]
    v_mfma_f32_16x16x32_bf16 v[68:71], v[208:211], v[148:151], v[68:71]
    buffer_load_dwordx4 a[224:227], v4, s[32:35], s79 offen offset:3072 sc1
    v_mfma_f32_16x16x32_bf16 v[100:103], v[212:215], v[148:151], v[100:103]
    v_mfma_f32_16x16x32_bf16 v[40:43], v[204:207], v[152:155], v[40:43]
    v_mfma_f32_16x16x32_bf16 v[72:75], v[208:211], v[152:155], v[72:75]
    v_mfma_f32_16x16x32_bf16 v[104:107], v[212:215], v[152:155], v[104:107]
    buffer_load_dwordx4 a[228:231], v202, s[32:35], s79 offen offset:0 sc1
    v_mfma_f32_16x16x32_bf16 v[44:47], v[204:207], v[156:159], v[44:47]
    v_mfma_f32_16x16x32_bf16 v[76:79], v[208:211], v[156:159], v[76:79]
    v_mfma_f32_16x16x32_bf16 v[108:111], v[212:215], v[156:159], v[108:111]
    s_waitcnt lgkmcnt(0)
    v_mfma_f32_16x16x32_bf16 v[16:19], v[220:223], v[160:163], v[16:19]
    ds_read_b64_tr_b16 v[128:129], v192 offset:16384
    s_add_u32 s79, s77, 409600
    v_mfma_f32_16x16x32_bf16 v[48:51], v[224:227], v[160:163], v[48:51]
    ds_read_b64_tr_b16 v[130:131], v192 offset:17408
    buffer_load_dwordx4 a[232:235], v4, s[32:35], s79 offen offset:0 sc1
    v_mfma_f32_16x16x32_bf16 v[80:83], v[228:231], v[160:163], v[80:83]
    ds_read_b64_tr_b16 v[132:133], v193 offset:16384
    v_mfma_f32_16x16x32_bf16 v[112:115], v[232:235], v[160:163], v[112:115]
    ds_read_b64_tr_b16 v[134:135], v193 offset:17408
    v_mfma_f32_16x16x32_bf16 v[20:23], v[220:223], v[164:167], v[20:23]
    ds_read_b64_tr_b16 v[136:137], v194 offset:16384
    v_mfma_f32_16x16x32_bf16 v[52:55], v[224:227], v[164:167], v[52:55]
    ds_read_b64_tr_b16 v[138:139], v194 offset:17408
    buffer_load_dwordx4 a[236:239], v4, s[32:35], s79 offen offset:1024 sc1
    v_mfma_f32_16x16x32_bf16 v[84:87], v[228:231], v[164:167], v[84:87]
    ds_read_b64_tr_b16 v[140:141], v195 offset:16384
    v_mfma_f32_16x16x32_bf16 v[116:119], v[232:235], v[164:167], v[116:119]
    ds_read_b64_tr_b16 v[142:143], v195 offset:17408
    v_mfma_f32_16x16x32_bf16 v[24:27], v[220:223], v[168:171], v[24:27]
    ds_read_b64_tr_b16 v[144:145], v196 offset:16384
    v_mfma_f32_16x16x32_bf16 v[56:59], v[224:227], v[168:171], v[56:59]
    ds_read_b64_tr_b16 v[146:147], v196 offset:17408
    buffer_load_dwordx4 a[240:243], v4, s[32:35], s79 offen offset:2048 sc1
    v_mfma_f32_16x16x32_bf16 v[88:91], v[228:231], v[168:171], v[88:91]
    ds_read_b64_tr_b16 v[148:149], v197 offset:16384
    v_mfma_f32_16x16x32_bf16 v[120:123], v[232:235], v[168:171], v[120:123]
    ds_read_b64_tr_b16 v[150:151], v197 offset:17408
    v_mfma_f32_16x16x32_bf16 v[28:31], v[220:223], v[172:175], v[28:31]
    ds_read_b64_tr_b16 v[152:153], v198 offset:16384
    v_mfma_f32_16x16x32_bf16 v[60:63], v[224:227], v[172:175], v[60:63]
    ds_read_b64_tr_b16 v[154:155], v198 offset:17408
    v_mfma_f32_16x16x32_bf16 v[92:95], v[228:231], v[172:175], v[92:95]
    ds_read_b64_tr_b16 v[156:157], v199 offset:16384
    v_mfma_f32_16x16x32_bf16 v[124:127], v[232:235], v[172:175], v[124:127]
    ds_read_b64_tr_b16 v[158:159], v199 offset:17408
    v_mfma_f32_16x16x32_bf16 v[32:35], v[220:223], v[176:179], v[32:35]
    v_mfma_f32_16x16x32_bf16 v[64:67], v[224:227], v[176:179], v[64:67]
    v_mfma_f32_16x16x32_bf16 v[96:99], v[228:231], v[176:179], v[96:99]
    v_mfma_f32_16x16x32_bf16 v[36:39], v[220:223], v[180:183], v[36:39]
    v_mfma_f32_16x16x32_bf16 v[68:71], v[224:227], v[180:183], v[68:71]
    v_mfma_f32_16x16x32_bf16 v[100:103], v[228:231], v[180:183], v[100:103]
    v_mfma_f32_16x16x32_bf16 v[40:43], v[220:223], v[184:187], v[40:43]
    v_mfma_f32_16x16x32_bf16 v[72:75], v[224:227], v[184:187], v[72:75]
    v_mfma_f32_16x16x32_bf16 v[104:107], v[228:231], v[184:187], v[104:107]
    v_mfma_f32_16x16x32_bf16 v[44:47], v[220:223], v[188:191], v[44:47]
    v_mfma_f32_16x16x32_bf16 v[76:79], v[224:227], v[188:191], v[76:79]
    v_mfma_f32_16x16x32_bf16 v[108:111], v[228:231], v[188:191], v[108:111]
    s_waitcnt lgkmcnt(0)
    v_mfma_f32_16x16x32_bf16 v[16:19], a[0:3], v[128:131], v[16:19]
    ds_read_b64_tr_b16 v[160:161], v192 offset:24576
    buffer_load_dwordx4 a[244:247], v4, s[32:35], s79 offen offset:3072 sc1
    v_mfma_f32_16x16x32_bf16 v[48:51], a[4:7], v[128:131], v[48:51]
    ds_read_b64_tr_b16 v[162:163], v192 offset:25600
    v_mfma_f32_16x16x32_bf16 v[80:83], a[8:11], v[128:131], v[80:83]
    ds_read_b64_tr_b16 v[164:165], v193 offset:24576
    v_mfma_f32_16x16x32_bf16 v[112:115], a[12:15], v[128:131], v[112:115]
    ds_read_b64_tr_b16 v[166:167], v193 offset:25600
    v_mfma_f32_16x16x32_bf16 v[20:23], a[0:3], v[132:135], v[20:23]
    ds_read_b64_tr_b16 v[168:169], v194 offset:24576
    buffer_load_dwordx4 a[248:251], v202, s[32:35], s79 offen offset:0 sc1
    v_mfma_f32_16x16x32_bf16 v[52:55], a[4:7], v[132:135], v[52:55]
    ds_read_b64_tr_b16 v[170:171], v194 offset:25600
    s_add_u32 s79, s77, 450560
    v_mfma_f32_16x16x32_bf16 v[84:87], a[8:11], v[132:135], v[84:87]
    ds_read_b64_tr_b16 v[172:173], v195 offset:24576
    v_mfma_f32_16x16x32_bf16 v[116:119], a[12:15], v[132:135], v[116:119]
    ds_read_b64_tr_b16 v[174:175], v195 offset:25600
    v_mfma_f32_16x16x32_bf16 v[24:27], a[0:3], v[136:139], v[24:27]
    ds_read_b64_tr_b16 v[176:177], v196 offset:24576
    buffer_load_dwordx4 a[252:255], v4, s[32:35], s79 offen offset:0 sc1
    v_mfma_f32_16x16x32_bf16 v[56:59], a[4:7], v[136:139], v[56:59]
    ds_read_b64_tr_b16 v[178:179], v196 offset:25600
    v_mfma_f32_16x16x32_bf16 v[88:91], a[8:11], v[136:139], v[88:91]
    ds_read_b64_tr_b16 v[180:181], v197 offset:24576
    v_mfma_f32_16x16x32_bf16 v[120:123], a[12:15], v[136:139], v[120:123]
    ds_read_b64_tr_b16 v[182:183], v197 offset:25600
    v_mfma_f32_16x16x32_bf16 v[28:31], a[0:3], v[140:143], v[28:31]
    ds_read_b64_tr_b16 v[184:185], v198 offset:24576
    v_mfma_f32_16x16x32_bf16 v[60:63], a[4:7], v[140:143], v[60:63]
    ds_read_b64_tr_b16 v[186:187], v198 offset:25600
    v_mfma_f32_16x16x32_bf16 v[92:95], a[8:11], v[140:143], v[92:95]
    ds_read_b64_tr_b16 v[188:189], v199 offset:24576
    v_mfma_f32_16x16x32_bf16 v[124:127], a[12:15], v[140:143], v[124:127]
    ds_read_b64_tr_b16 v[190:191], v199 offset:25600
    v_mfma_f32_16x16x32_bf16 v[32:35], a[0:3], v[144:147], v[32:35]
    s_lshl_b32 s10, s66, 3
    s_add_u32 s11, s10, s74
    v_mfma_f32_16x16x32_bf16 v[64:67], a[4:7], v[144:147], v[64:67]
    v_add_u32 v5, s11, v2
    s_xor_b32 s11, s74, 4
    v_mfma_f32_16x16x32_bf16 v[96:99], a[8:11], v[144:147], v[96:99]
    s_add_u32 s11, s10, s11
    v_add_u32 v6, s11, v2
    v_mfma_f32_16x16x32_bf16 v[36:39], a[0:3], v[148:151], v[36:39]
    v_mul_u32_u24 v5, 57344, v5
    v_mul_u32_u24 v6, 57344, v6
    v_mfma_f32_16x16x32_bf16 v[68:71], a[4:7], v[148:151], v[68:71]
    v_lshl_add_u32 v5, v3, 4, v5
    v_lshl_add_u32 v6, v3, 4, v6
    v_mfma_f32_16x16x32_bf16 v[100:103], a[8:11], v[148:151], v[100:103]
    s_mul_hi_u32 s72, s70, 209716
    s_mul_hi_u32 s73, s71, 209716
    v_mfma_f32_16x16x32_bf16 v[40:43], a[0:3], v[152:155], v[40:43]
    s_lshl_b32 s72, s72, 8
    s_lshl_b32 s73, s73, 8
    v_mfma_f32_16x16x32_bf16 v[72:75], a[4:7], v[152:155], v[72:75]
    s_add_u32 s72, s72, 26214400
    s_add_u32 s73, s73, 26214400
    v_mfma_f32_16x16x32_bf16 v[104:107], a[8:11], v[152:155], v[104:107]
    v_mfma_f32_16x16x32_bf16 v[44:47], a[0:3], v[156:159], v[44:47]
    v_mfma_f32_16x16x32_bf16 v[76:79], a[4:7], v[156:159], v[76:79]
    v_mfma_f32_16x16x32_bf16 v[108:111], a[8:11], v[156:159], v[108:111]
    s_waitcnt lgkmcnt(0)
    s_waitcnt vmcnt(9)
    v_mfma_f32_16x16x32_bf16 v[16:19], a[16:19], v[160:163], v[16:19]
    ds_read_b128 v[128:131], v11 offset:0
    buffer_load_dwordx4 a[0:3], v4, s[32:35], s79 offen offset:1024 sc1
    v_mfma_f32_16x16x32_bf16 v[48:51], a[20:23], v[160:163], v[48:51]
    ds_read_b128 v[132:135], v11 offset:256
    v_mfma_f32_16x16x32_bf16 v[80:83], a[24:27], v[160:163], v[80:83]
    ds_read_b128 v[136:139], v11 offset:512
    v_mfma_f32_16x16x32_bf16 v[112:115], a[28:31], v[160:163], v[112:115]
    ds_read_b128 v[140:143], v11 offset:768
    v_mfma_f32_16x16x32_bf16 v[20:23], a[16:19], v[164:167], v[20:23]
    ds_read_b128 v[144:147], v12 offset:0
    buffer_load_dwordx4 a[4:7], v4, s[32:35], s79 offen offset:2048 sc1
    v_mfma_f32_16x16x32_bf16 v[52:55], a[20:23], v[164:167], v[52:55]
    ds_read_b128 v[148:151], v12 offset:256
    ds_read_b128 v[152:155], v12 offset:512
    v_mfma_f32_16x16x32_bf16 v[84:87], a[24:27], v[164:167], v[84:87]
    ds_read_b128 v[156:159], v12 offset:768
    ds_read_b128 v[204:207], v13 offset:2048
    v_mfma_f32_16x16x32_bf16 v[116:119], a[28:31], v[164:167], v[116:119]
    ds_read_b128 v[208:211], v13 offset:2112
    ds_read_b128 v[212:215], v13 offset:2176
    v_mfma_f32_16x16x32_bf16 v[24:27], a[16:19], v[168:171], v[24:27]
    ds_read_b128 v[216:219], v13 offset:2240
    buffer_load_dwordx4 a[8:11], v4, s[32:35], s79 offen offset:3072 sc1
    v_mfma_f32_16x16x32_bf16 v[56:59], a[20:23], v[168:171], v[56:59]
    ds_read_b128 v[220:223], v13 offset:2304
    ds_read_b128 v[224:227], v13 offset:2368
    v_mfma_f32_16x16x32_bf16 v[88:91], a[24:27], v[168:171], v[88:91]
    ds_read_b128 v[228:231], v14 offset:2048
    ds_read_b128 v[232:235], v14 offset:2112
    v_mfma_f32_16x16x32_bf16 v[120:123], a[28:31], v[168:171], v[120:123]
    v_mfma_f32_16x16x32_bf16 v[28:31], a[16:19], v[172:175], v[28:31]
    s_mov_b64 s[98:99], -1
    buffer_load_dwordx4 a[12:15], v202, s[32:35], s79 offen offset:0 sc1
    v_mfma_f32_16x16x32_bf16 v[60:63], a[20:23], v[172:175], v[60:63]
    s_waitcnt lgkmcnt(8)
    v_cmp_eq_u32 vcc, s8, v129
    v_mfma_f32_16x16x32_bf16 v[92:95], a[24:27], v[172:175], v[92:95]
    s_and_b64 s[98:99], s[98:99], vcc
    v_cmp_eq_u32 vcc, s9, v131
    v_mfma_f32_16x16x32_bf16 v[124:127], a[28:31], v[172:175], v[124:127]
    s_and_b64 s[98:99], s[98:99], vcc
    v_cmp_eq_u32 vcc, s8, v133
    v_mfma_f32_16x16x32_bf16 v[32:35], a[16:19], v[176:179], v[32:35]
    s_and_b64 s[98:99], s[98:99], vcc
    v_cmp_eq_u32 vcc, s9, v135
    v_mfma_f32_16x16x32_bf16 v[64:67], a[20:23], v[176:179], v[64:67]
    s_and_b64 s[98:99], s[98:99], vcc
    v_cmp_eq_u32 vcc, s8, v137
    v_mfma_f32_16x16x32_bf16 v[96:99], a[24:27], v[176:179], v[96:99]
    s_and_b64 s[98:99], s[98:99], vcc
    v_cmp_eq_u32 vcc, s9, v139
    v_mfma_f32_16x16x32_bf16 v[36:39], a[16:19], v[180:183], v[36:39]
    s_and_b64 s[98:99], s[98:99], vcc
    v_cmp_eq_u32 vcc, s8, v141
    v_mfma_f32_16x16x32_bf16 v[68:71], a[20:23], v[180:183], v[68:71]
    s_and_b64 s[98:99], s[98:99], vcc
    v_cmp_eq_u32 vcc, s9, v143
    v_mfma_f32_16x16x32_bf16 v[100:103], a[24:27], v[180:183], v[100:103]
    s_and_b64 s[98:99], s[98:99], vcc
    v_cmp_eq_u32 vcc, s8, v145
    v_mfma_f32_16x16x32_bf16 v[40:43], a[16:19], v[184:187], v[40:43]
    s_and_b64 s[98:99], s[98:99], vcc
    v_cmp_eq_u32 vcc, s9, v147
    v_mfma_f32_16x16x32_bf16 v[72:75], a[20:23], v[184:187], v[72:75]
    s_and_b64 s[98:99], s[98:99], vcc
    v_cmp_eq_u32 vcc, s8, v149
    v_mfma_f32_16x16x32_bf16 v[104:107], a[24:27], v[184:187], v[104:107]
    s_and_b64 s[98:99], s[98:99], vcc
    v_cmp_eq_u32 vcc, s9, v151
    v_mfma_f32_16x16x32_bf16 v[44:47], a[16:19], v[188:191], v[44:47]
    s_and_b64 s[98:99], s[98:99], vcc
    v_cmp_eq_u32 vcc, s8, v153
    v_mfma_f32_16x16x32_bf16 v[76:79], a[20:23], v[188:191], v[76:79]
    s_and_b64 s[98:99], s[98:99], vcc
    v_cmp_eq_u32 vcc, s9, v155
    v_mfma_f32_16x16x32_bf16 v[108:111], a[24:27], v[188:191], v[108:111]
    s_and_b64 s[98:99], s[98:99], vcc
    v_cmp_eq_u32 vcc, s8, v157
    s_and_b64 s[98:99], s[98:99], vcc
    v_cmp_eq_u32 vcc, s9, v159
    s_and_b64 s[98:99], s[98:99], vcc
    s_mov_b32 s78, 0
    s_waitcnt lgkmcnt(0)
    s_cmp_eq_u64 s[98:99], exec
    s_cbranch_scc1 L_gok_35
L_glp_36:
    s_waitcnt lgkmcnt(0)
    s_mov_b64 s[10:11], -1
    v_cmp_eq_u32 vcc, s8, v129
    s_and_b64 s[10:11], s[10:11], vcc
    v_cmp_eq_u32 vcc, s9, v131
    s_and_b64 s[10:11], s[10:11], vcc
    v_cmp_eq_u32 vcc, s8, v133
    s_and_b64 s[10:11], s[10:11], vcc
    v_cmp_eq_u32 vcc, s9, v135
    s_and_b64 s[10:11], s[10:11], vcc
    v_cmp_eq_u32 vcc, s8, v137
    s_and_b64 s[10:11], s[10:11], vcc
    v_cmp_eq_u32 vcc, s9, v139
    s_and_b64 s[10:11], s[10:11], vcc
    v_cmp_eq_u32 vcc, s8, v141
    s_and_b64 s[10:11], s[10:11], vcc
    v_cmp_eq_u32 vcc, s9, v143
    s_and_b64 s[10:11], s[10:11], vcc
    v_cmp_eq_u32 vcc, s8, v145
    s_and_b64 s[10:11], s[10:11], vcc
    v_cmp_eq_u32 vcc, s9, v147
    s_and_b64 s[10:11], s[10:11], vcc
    v_cmp_eq_u32 vcc, s8, v149
    s_and_b64 s[10:11], s[10:11], vcc
    v_cmp_eq_u32 vcc, s9, v151
    s_and_b64 s[10:11], s[10:11], vcc
    v_cmp_eq_u32 vcc, s8, v153
    s_and_b64 s[10:11], s[10:11], vcc
    v_cmp_eq_u32 vcc, s9, v155
    s_and_b64 s[10:11], s[10:11], vcc
    v_cmp_eq_u32 vcc, s8, v157
    s_and_b64 s[10:11], s[10:11], vcc
    v_cmp_eq_u32 vcc, s9, v159
    s_and_b64 s[10:11], s[10:11], vcc
    s_cmp_eq_u64 s[10:11], exec
    s_cbranch_scc1 L_gok_35
    s_add_u32 s78, s78, 1
    s_cmp_ge_u32 s78, 40000
    s_cbranch_scc1 L_gok_35
    s_lshl_b32 s11, s4, 12
    s_add_u32 m0, s11, 16384
    s_lshl_b32 s3, s66, 11
    s_add_u32 s3, s3, 13893632
    buffer_load_dwordx4 v4, s[12:15], s3 offen sc1 lds
    buffer_load_dwordx4 v4, s[12:15], s3 offen offset:1024 sc1 lds
    s_waitcnt vmcnt(0)
    ds_read_b128 v[128:131], v11 offset:0
    ds_read_b128 v[132:135], v11 offset:256
    ds_read_b128 v[136:139], v11 offset:512
    ds_read_b128 v[140:143], v11 offset:768
    ds_read_b128 v[144:147], v12 offset:0
    ds_read_b128 v[148:151], v12 offset:256
    ds_read_b128 v[152:155], v12 offset:512
    ds_read_b128 v[156:159], v12 offset:768
    s_branch L_glp_36
L_gok_35:
    v_pk_fma_f32 v[236:237], v[130:131], v[204:205], v[208:209] op_sel:[0,0,0] op_sel_hi:[0,1,1] neg_lo:[1,0,0] neg_hi:[1,0,0]
    v_pk_fma_f32 v[238:239], v[130:131], v[206:207], v[210:211] op_sel:[0,0,0] op_sel_hi:[0,1,1] neg_lo:[1,0,0] neg_hi:[1,0,0]
    v_pk_fma_f32 v[236:237], v[128:129], v[16:17], v[236:237] op_sel:[0,0,0] op_sel_hi:[0,1,1]
    v_pk_fma_f32 v[238:239], v[128:129], v[18:19], v[238:239] op_sel:[0,0,0] op_sel_hi:[0,1,1]
    v_pk_mul_f32 v[236:237], v[236:237], v[238:239]
    v_cvt_pk_bf16_f32 v244, v236, v237
    v_pk_fma_f32 v[240:241], v[134:135], v[204:205], v[208:209] op_sel:[0,0,0] op_sel_hi:[0,1,1] neg_lo:[1,0,0] neg_hi:[1,0,0]
    v_pk_fma_f32 v[242:243], v[134:135], v[206:207], v[210:211] op_sel:[0,0,0] op_sel_hi:[0,1,1] neg_lo:[1,0,0] neg_hi:[1,0,0]
    v_pk_fma_f32 v[240:241], v[132:133], v[20:21], v[240:241] op_sel:[0,0,0] op_sel_hi:[0,1,1]
    v_pk_fma_f32 v[242:243], v[132:133], v[22:23], v[242:243] op_sel:[0,0,0] op_sel_hi:[0,1,1]
    v_pk_mul_f32 v[240:241], v[240:241], v[242:243]
    v_cvt_pk_bf16_f32 v245, v240, v241
    v_pk_fma_f32 v[236:237], v[138:139], v[204:205], v[208:209] op_sel:[0,0,0] op_sel_hi:[0,1,1] neg_lo:[1,0,0] neg_hi:[1,0,0]
    v_pk_fma_f32 v[238:239], v[138:139], v[206:207], v[210:211] op_sel:[0,0,0] op_sel_hi:[0,1,1] neg_lo:[1,0,0] neg_hi:[1,0,0]
    v_pk_fma_f32 v[236:237], v[136:137], v[24:25], v[236:237] op_sel:[0,0,0] op_sel_hi:[0,1,1]
    v_pk_fma_f32 v[238:239], v[136:137], v[26:27], v[238:239] op_sel:[0,0,0] op_sel_hi:[0,1,1]
    v_pk_mul_f32 v[236:237], v[236:237], v[238:239]
    v_cvt_pk_bf16_f32 v246, v236, v237
    v_pk_fma_f32 v[240:241], v[142:143], v[204:205], v[208:209] op_sel:[0,0,0] op_sel_hi:[0,1,1] neg_lo:[1,0,0] neg_hi:[1,0,0]
    v_pk_fma_f32 v[242:243], v[142:143], v[206:207], v[210:211] op_sel:[0,0,0] op_sel_hi:[0,1,1] neg_lo:[1,0,0] neg_hi:[1,0,0]
    v_pk_fma_f32 v[240:241], v[140:141], v[28:29], v[240:241] op_sel:[0,0,0] op_sel_hi:[0,1,1]
    v_pk_fma_f32 v[242:243], v[140:141], v[30:31], v[242:243] op_sel:[0,0,0] op_sel_hi:[0,1,1]
    v_pk_mul_f32 v[240:241], v[240:241], v[242:243]
    v_cvt_pk_bf16_f32 v247, v240, v241
    v_pk_fma_f32 v[236:237], v[146:147], v[204:205], v[208:209] op_sel:[0,0,0] op_sel_hi:[0,1,1] neg_lo:[1,0,0] neg_hi:[1,0,0]
    v_pk_fma_f32 v[238:239], v[146:147], v[206:207], v[210:211] op_sel:[0,0,0] op_sel_hi:[0,1,1] neg_lo:[1,0,0] neg_hi:[1,0,0]
    v_permlane32_swap_b32 v244, v246
    v_permlane32_swap_b32 v245, v247
    v_pk_fma_f32 v[236:237], v[144:145], v[32:33], v[236:237] op_sel:[0,0,0] op_sel_hi:[0,1,1]
    v_pk_fma_f32 v[238:239], v[144:145], v[34:35], v[238:239] op_sel:[0,0,0] op_sel_hi:[0,1,1]
    v_permlane16_swap_b32 v244, v245
    v_permlane16_swap_b32 v246, v247
    buffer_store_dwordx4 v[244:247], v5, s[12:15], s72 offen offset:0 sc1
    v_pk_mul_f32 v[236:237], v[236:237], v[238:239]
    v_cvt_pk_bf16_f32 v248, v236, v237
    v_pk_fma_f32 v[240:241], v[150:151], v[204:205], v[208:209] op_sel:[0,0,0] op_sel_hi:[0,1,1] neg_lo:[1,0,0] neg_hi:[1,0,0]
    v_pk_fma_f32 v[242:243], v[150:151], v[206:207], v[210:211] op_sel:[0,0,0] op_sel_hi:[0,1,1] neg_lo:[1,0,0] neg_hi:[1,0,0]
    v_pk_fma_f32 v[240:241], v[148:149], v[36:37], v[240:241] op_sel:[0,0,0] op_sel_hi:[0,1,1]
    v_pk_fma_f32 v[242:243], v[148:149], v[38:39], v[242:243] op_sel:[0,0,0] op_sel_hi:[0,1,1]
    v_pk_mul_f32 v[240:241], v[240:241], v[242:243]
    v_cvt_pk_bf16_f32 v249, v240, v241
    v_pk_fma_f32 v[236:237], v[154:155], v[204:205], v[208:209] op_sel:[0,0,0] op_sel_hi:[0,1,1] neg_lo:[1,0,0] neg_hi:[1,0,0]
    v_pk_fma_f32 v[238:239], v[154:155], v[206:207], v[210:211] op_sel:[0,0,0] op_sel_hi:[0,1,1] neg_lo:[1,0,0] neg_hi:[1,0,0]
    v_pk_fma_f32 v[236:237], v[152:153], v[40:41], v[236:237] op_sel:[0,0,0] op_sel_hi:[0,1,1]
    v_pk_fma_f32 v[238:239], v[152:153], v[42:43], v[238:239] op_sel:[0,0,0] op_sel_hi:[0,1,1]
    v_pk_mul_f32 v[236:237], v[236:237], v[238:239]
    v_cvt_pk_bf16_f32 v250, v236, v237
    v_pk_fma_f32 v[240:241], v[158:159], v[204:205], v[208:209] op_sel:[0,0,0] op_sel_hi:[0,1,1] neg_lo:[1,0,0] neg_hi:[1,0,0]
    v_pk_fma_f32 v[242:243], v[158:159], v[206:207], v[210:211] op_sel:[0,0,0] op_sel_hi:[0,1,1] neg_lo:[1,0,0] neg_hi:[1,0,0]
    v_pk_fma_f32 v[240:241], v[156:157], v[44:45], v[240:241] op_sel:[0,0,0] op_sel_hi:[0,1,1]
    v_pk_fma_f32 v[242:243], v[156:157], v[46:47], v[242:243] op_sel:[0,0,0] op_sel_hi:[0,1,1]
    v_pk_mul_f32 v[240:241], v[240:241], v[242:243]
    v_cvt_pk_bf16_f32 v251, v240, v241
    v_pk_fma_f32 v[236:237], v[130:131], v[212:213], v[216:217] op_sel:[0,0,0] op_sel_hi:[0,1,1] neg_lo:[1,0,0] neg_hi:[1,0,0]
    v_pk_fma_f32 v[238:239], v[130:131], v[214:215], v[218:219] op_sel:[0,0,0] op_sel_hi:[0,1,1] neg_lo:[1,0,0] neg_hi:[1,0,0]
    v_permlane32_swap_b32 v248, v250
    v_permlane32_swap_b32 v249, v251
    v_pk_fma_f32 v[236:237], v[128:129], v[48:49], v[236:237] op_sel:[0,0,0] op_sel_hi:[0,1,1]
    v_pk_fma_f32 v[238:239], v[128:129], v[50:51], v[238:239] op_sel:[0,0,0] op_sel_hi:[0,1,1]
    v_permlane16_swap_b32 v248, v249
    v_permlane16_swap_b32 v250, v251
    buffer_store_dwordx4 v[248:251], v6, s[12:15], s72 offen offset:0 sc1
    v_pk_mul_f32 v[236:237], v[236:237], v[238:239]
    v_cvt_pk_bf16_f32 v244, v236, v237
    v_pk_fma_f32 v[240:241], v[134:135], v[212:213], v[216:217] op_sel:[0,0,0] op_sel_hi:[0,1,1] neg_lo:[1,0,0] neg_hi:[1,0,0]
    v_pk_fma_f32 v[242:243], v[134:135], v[214:215], v[218:219] op_sel:[0,0,0] op_sel_hi:[0,1,1] neg_lo:[1,0,0] neg_hi:[1,0,0]
    v_pk_fma_f32 v[240:241], v[132:133], v[52:53], v[240:241] op_sel:[0,0,0] op_sel_hi:[0,1,1]
    v_pk_fma_f32 v[242:243], v[132:133], v[54:55], v[242:243] op_sel:[0,0,0] op_sel_hi:[0,1,1]
    v_pk_mul_f32 v[240:241], v[240:241], v[242:243]
    v_cvt_pk_bf16_f32 v245, v240, v241
    v_pk_fma_f32 v[236:237], v[138:139], v[212:213], v[216:217] op_sel:[0,0,0] op_sel_hi:[0,1,1] neg_lo:[1,0,0] neg_hi:[1,0,0]
    v_pk_fma_f32 v[238:239], v[138:139], v[214:215], v[218:219] op_sel:[0,0,0] op_sel_hi:[0,1,1] neg_lo:[1,0,0] neg_hi:[1,0,0]
    v_pk_fma_f32 v[236:237], v[136:137], v[56:57], v[236:237] op_sel:[0,0,0] op_sel_hi:[0,1,1]
    v_pk_fma_f32 v[238:239], v[136:137], v[58:59], v[238:239] op_sel:[0,0,0] op_sel_hi:[0,1,1]
    v_pk_mul_f32 v[236:237], v[236:237], v[238:239]
    v_cvt_pk_bf16_f32 v246, v236, v237
    v_pk_fma_f32 v[240:241], v[142:143], v[212:213], v[216:217] op_sel:[0,0,0] op_sel_hi:[0,1,1] neg_lo:[1,0,0] neg_hi:[1,0,0]
    v_pk_fma_f32 v[242:243], v[142:143], v[214:215], v[218:219] op_sel:[0,0,0] op_sel_hi:[0,1,1] neg_lo:[1,0,0] neg_hi:[1,0,0]
    v_pk_fma_f32 v[240:241], v[140:141], v[60:61], v[240:241] op_sel:[0,0,0] op_sel_hi:[0,1,1]
    v_pk_fma_f32 v[242:243], v[140:141], v[62:63], v[242:243] op_sel:[0,0,0] op_sel_hi:[0,1,1]
    v_pk_mul_f32 v[240:241], v[240:241], v[242:243]
    v_cvt_pk_bf16_f32 v247, v240, v241
    v_pk_fma_f32 v[236:237], v[146:147], v[212:213], v[216:217] op_sel:[0,0,0] op_sel_hi:[0,1,1] neg_lo:[1,0,0] neg_hi:[1,0,0]
    v_pk_fma_f32 v[238:239], v[146:147], v[214:215], v[218:219] op_sel:[0,0,0] op_sel_hi:[0,1,1] neg_lo:[1,0,0] neg_hi:[1,0,0]
    v_permlane32_swap_b32 v244, v246
    v_permlane32_swap_b32 v245, v247
    v_pk_fma_f32 v[236:237], v[144:145], v[64:65], v[236:237] op_sel:[0,0,0] op_sel_hi:[0,1,1]
    v_pk_fma_f32 v[238:239], v[144:145], v[66:67], v[238:239] op_sel:[0,0,0] op_sel_hi:[0,1,1]
    v_permlane16_swap_b32 v244, v245
    v_permlane16_swap_b32 v246, v247
    buffer_store_dwordx4 v[244:247], v5, s[12:15], s72 offen offset:256 sc1
    v_pk_mul_f32 v[236:237], v[236:237], v[238:239]
    v_cvt_pk_bf16_f32 v248, v236, v237
    v_pk_fma_f32 v[240:241], v[150:151], v[212:213], v[216:217] op_sel:[0,0,0] op_sel_hi:[0,1,1] neg_lo:[1,0,0] neg_hi:[1,0,0]
    v_pk_fma_f32 v[242:243], v[150:151], v[214:215], v[218:219] op_sel:[0,0,0] op_sel_hi:[0,1,1] neg_lo:[1,0,0] neg_hi:[1,0,0]
    v_pk_fma_f32 v[240:241], v[148:149], v[68:69], v[240:241] op_sel:[0,0,0] op_sel_hi:[0,1,1]
    v_pk_fma_f32 v[242:243], v[148:149], v[70:71], v[242:243] op_sel:[0,0,0] op_sel_hi:[0,1,1]
    v_pk_mul_f32 v[240:241], v[240:241], v[242:243]
    v_cvt_pk_bf16_f32 v249, v240, v241
    v_pk_fma_f32 v[236:237], v[154:155], v[212:213], v[216:217] op_sel:[0,0,0] op_sel_hi:[0,1,1] neg_lo:[1,0,0] neg_hi:[1,0,0]
    v_pk_fma_f32 v[238:239], v[154:155], v[214:215], v[218:219] op_sel:[0,0,0] op_sel_hi:[0,1,1] neg_lo:[1,0,0] neg_hi:[1,0,0]
    v_pk_fma_f32 v[236:237], v[152:153], v[72:73], v[236:237] op_sel:[0,0,0] op_sel_hi:[0,1,1]
    v_pk_fma_f32 v[238:239], v[152:153], v[74:75], v[238:239] op_sel:[0,0,0] op_sel_hi:[0,1,1]
    v_pk_mul_f32 v[236:237], v[236:237], v[238:239]
    v_cvt_pk_bf16_f32 v250, v236, v237
    v_pk_fma_f32 v[240:241], v[158:159], v[212:213], v[216:217] op_sel:[0,0,0] op_sel_hi:[0,1,1] neg_lo:[1,0,0] neg_hi:[1,0,0]
    v_pk_fma_f32 v[242:243], v[158:159], v[214:215], v[218:219] op_sel:[0,0,0] op_sel_hi:[0,1,1] neg_lo:[1,0,0] neg_hi:[1,0,0]
    v_pk_fma_f32 v[240:241], v[156:157], v[76:77], v[240:241] op_sel:[0,0,0] op_sel_hi:[0,1,1]
    v_pk_fma_f32 v[242:243], v[156:157], v[78:79], v[242:243] op_sel:[0,0,0] op_sel_hi:[0,1,1]
    v_pk_mul_f32 v[240:241], v[240:241], v[242:243]
    v_cvt_pk_bf16_f32 v251, v240, v241
    v_pk_fma_f32 v[236:237], v[130:131], v[220:221], v[224:225] op_sel:[0,0,0] op_sel_hi:[0,1,1] neg_lo:[1,0,0] neg_hi:[1,0,0]
    v_pk_fma_f32 v[238:239], v[130:131], v[222:223], v[226:227] op_sel:[0,0,0] op_sel_hi:[0,1,1] neg_lo:[1,0,0] neg_hi:[1,0,0]
    v_permlane32_swap_b32 v248, v250
    v_permlane32_swap_b32 v249, v251
    v_pk_fma_f32 v[236:237], v[128:129], v[80:81], v[236:237] op_sel:[0,0,0] op_sel_hi:[0,1,1]
    v_pk_fma_f32 v[238:239], v[128:129], v[82:83], v[238:239] op_sel:[0,0,0] op_sel_hi:[0,1,1]
    v_permlane16_swap_b32 v248, v249
    v_permlane16_swap_b32 v250, v251
    buffer_store_dwordx4 v[248:251], v6, s[12:15], s72 offen offset:256 sc1
    v_pk_mul_f32 v[236:237], v[236:237], v[238:239]
    v_cvt_pk_bf16_f32 v244, v236, v237
    v_pk_fma_f32 v[240:241], v[134:135], v[220:221], v[224:225] op_sel:[0,0,0] op_sel_hi:[0,1,1] neg_lo:[1,0,0] neg_hi:[1,0,0]
    v_pk_fma_f32 v[242:243], v[134:135], v[222:223], v[226:227] op_sel:[0,0,0] op_sel_hi:[0,1,1] neg_lo:[1,0,0] neg_hi:[1,0,0]
    v_pk_fma_f32 v[240:241], v[132:133], v[84:85], v[240:241] op_sel:[0,0,0] op_sel_hi:[0,1,1]
    v_pk_fma_f32 v[242:243], v[132:133], v[86:87], v[242:243] op_sel:[0,0,0] op_sel_hi:[0,1,1]
    v_pk_mul_f32 v[240:241], v[240:241], v[242:243]
    v_cvt_pk_bf16_f32 v245, v240, v241
    v_pk_fma_f32 v[236:237], v[138:139], v[220:221], v[224:225] op_sel:[0,0,0] op_sel_hi:[0,1,1] neg_lo:[1,0,0] neg_hi:[1,0,0]
    v_pk_fma_f32 v[238:239], v[138:139], v[222:223], v[226:227] op_sel:[0,0,0] op_sel_hi:[0,1,1] neg_lo:[1,0,0] neg_hi:[1,0,0]
    v_pk_fma_f32 v[236:237], v[136:137], v[88:89], v[236:237] op_sel:[0,0,0] op_sel_hi:[0,1,1]
    v_pk_fma_f32 v[238:239], v[136:137], v[90:91], v[238:239] op_sel:[0,0,0] op_sel_hi:[0,1,1]
    v_pk_mul_f32 v[236:237], v[236:237], v[238:239]
    v_cvt_pk_bf16_f32 v246, v236, v237
    v_pk_fma_f32 v[240:241], v[142:143], v[220:221], v[224:225] op_sel:[0,0,0] op_sel_hi:[0,1,1] neg_lo:[1,0,0] neg_hi:[1,0,0]
    v_pk_fma_f32 v[242:243], v[142:143], v[222:223], v[226:227] op_sel:[0,0,0] op_sel_hi:[0,1,1] neg_lo:[1,0,0] neg_hi:[1,0,0]
    v_pk_fma_f32 v[240:241], v[140:141], v[92:93], v[240:241] op_sel:[0,0,0] op_sel_hi:[0,1,1]
    v_pk_fma_f32 v[242:243], v[140:141], v[94:95], v[242:243] op_sel:[0,0,0] op_sel_hi:[0,1,1]
    v_pk_mul_f32 v[240:241], v[240:241], v[242:243]
    v_cvt_pk_bf16_f32 v247, v240, v241
    v_pk_fma_f32 v[236:237], v[146:147], v[220:221], v[224:225] op_sel:[0,0,0] op_sel_hi:[0,1,1] neg_lo:[1,0,0] neg_hi:[1,0,0]
    v_pk_fma_f32 v[238:239], v[146:147], v[222:223], v[226:227] op_sel:[0,0,0] op_sel_hi:[0,1,1] neg_lo:[1,0,0] neg_hi:[1,0,0]
    v_permlane32_swap_b32 v244, v246
    v_permlane32_swap_b32 v245, v247
    v_pk_fma_f32 v[236:237], v[144:145], v[96:97], v[236:237] op_sel:[0,0,0] op_sel_hi:[0,1,1]
    v_pk_fma_f32 v[238:239], v[144:145], v[98:99], v[238:239] op_sel:[0,0,0] op_sel_hi:[0,1,1]
    v_permlane16_swap_b32 v244, v245
    v_permlane16_swap_b32 v246, v247
    buffer_store_dwordx4 v[244:247], v5, s[12:15], s72 offen offset:512 sc1
    v_pk_mul_f32 v[236:237], v[236:237], v[238:239]
    v_cvt_pk_bf16_f32 v248, v236, v237
    v_pk_fma_f32 v[240:241], v[150:151], v[220:221], v[224:225] op_sel:[0,0,0] op_sel_hi:[0,1,1] neg_lo:[1,0,0] neg_hi:[1,0,0]
    v_pk_fma_f32 v[242:243], v[150:151], v[222:223], v[226:227] op_sel:[0,0,0] op_sel_hi:[0,1,1] neg_lo:[1,0,0] neg_hi:[1,0,0]
    v_pk_fma_f32 v[240:241], v[148:149], v[100:101], v[240:241] op_sel:[0,0,0] op_sel_hi:[0,1,1]
    v_pk_fma_f32 v[242:243], v[148:149], v[102:103], v[242:243] op_sel:[0,0,0] op_sel_hi:[0,1,1]
    v_pk_mul_f32 v[240:241], v[240:241], v[242:243]
    v_cvt_pk_bf16_f32 v249, v240, v241
    v_pk_fma_f32 v[236:237], v[154:155], v[220:221], v[224:225] op_sel:[0,0,0] op_sel_hi:[0,1,1] neg_lo:[1,0,0] neg_hi:[1,0,0]
    v_pk_fma_f32 v[238:239], v[154:155], v[222:223], v[226:227] op_sel:[0,0,0] op_sel_hi:[0,1,1] neg_lo:[1,0,0] neg_hi:[1,0,0]
    v_pk_fma_f32 v[236:237], v[152:153], v[104:105], v[236:237] op_sel:[0,0,0] op_sel_hi:[0,1,1]
    v_pk_fma_f32 v[238:239], v[152:153], v[106:107], v[238:239] op_sel:[0,0,0] op_sel_hi:[0,1,1]
    v_pk_mul_f32 v[236:237], v[236:237], v[238:239]
    v_cvt_pk_bf16_f32 v250, v236, v237
    v_pk_fma_f32 v[240:241], v[158:159], v[220:221], v[224:225] op_sel:[0,0,0] op_sel_hi:[0,1,1] neg_lo:[1,0,0] neg_hi:[1,0,0]
    v_pk_fma_f32 v[242:243], v[158:159], v[222:223], v[226:227] op_sel:[0,0,0] op_sel_hi:[0,1,1] neg_lo:[1,0,0] neg_hi:[1,0,0]
    v_pk_fma_f32 v[240:241], v[156:157], v[108:109], v[240:241] op_sel:[0,0,0] op_sel_hi:[0,1,1]
    v_pk_fma_f32 v[242:243], v[156:157], v[110:111], v[242:243] op_sel:[0,0,0] op_sel_hi:[0,1,1]
    v_pk_mul_f32 v[240:241], v[240:241], v[242:243]
    v_cvt_pk_bf16_f32 v251, v240, v241
    v_pk_fma_f32 v[236:237], v[130:131], v[228:229], v[232:233] op_sel:[0,0,0] op_sel_hi:[0,1,1] neg_lo:[1,0,0] neg_hi:[1,0,0]
    v_pk_fma_f32 v[238:239], v[130:131], v[230:231], v[234:235] op_sel:[0,0,0] op_sel_hi:[0,1,1] neg_lo:[1,0,0] neg_hi:[1,0,0]
    v_permlane32_swap_b32 v248, v250
    v_permlane32_swap_b32 v249, v251
    v_pk_fma_f32 v[236:237], v[128:129], v[112:113], v[236:237] op_sel:[0,0,0] op_sel_hi:[0,1,1]
    v_pk_fma_f32 v[238:239], v[128:129], v[114:115], v[238:239] op_sel:[0,0,0] op_sel_hi:[0,1,1]
    v_permlane16_swap_b32 v248, v249
    v_permlane16_swap_b32 v250, v251
    buffer_store_dwordx4 v[248:251], v6, s[12:15], s72 offen offset:512 sc1
    v_pk_mul_f32 v[236:237], v[236:237], v[238:239]
    v_cvt_pk_bf16_f32 v244, v236, v237
    v_pk_fma_f32 v[240:241], v[134:135], v[228:229], v[232:233] op_sel:[0,0,0] op_sel_hi:[0,1,1] neg_lo:[1,0,0] neg_hi:[1,0,0]
    v_pk_fma_f32 v[242:243], v[134:135], v[230:231], v[234:235] op_sel:[0,0,0] op_sel_hi:[0,1,1] neg_lo:[1,0,0] neg_hi:[1,0,0]
    v_pk_fma_f32 v[240:241], v[132:133], v[116:117], v[240:241] op_sel:[0,0,0] op_sel_hi:[0,1,1]
    v_pk_fma_f32 v[242:243], v[132:133], v[118:119], v[242:243] op_sel:[0,0,0] op_sel_hi:[0,1,1]
    v_pk_mul_f32 v[240:241], v[240:241], v[242:243]
    v_cvt_pk_bf16_f32 v245, v240, v241
    v_pk_fma_f32 v[236:237], v[138:139], v[228:229], v[232:233] op_sel:[0,0,0] op_sel_hi:[0,1,1] neg_lo:[1,0,0] neg_hi:[1,0,0]
    v_pk_fma_f32 v[238:239], v[138:139], v[230:231], v[234:235] op_sel:[0,0,0] op_sel_hi:[0,1,1] neg_lo:[1,0,0] neg_hi:[1,0,0]
    v_pk_fma_f32 v[236:237], v[136:137], v[120:121], v[236:237] op_sel:[0,0,0] op_sel_hi:[0,1,1]
    v_pk_fma_f32 v[238:239], v[136:137], v[122:123], v[238:239] op_sel:[0,0,0] op_sel_hi:[0,1,1]
    v_pk_mul_f32 v[236:237], v[236:237], v[238:239]
    v_cvt_pk_bf16_f32 v246, v236, v237
    v_pk_fma_f32 v[240:241], v[142:143], v[228:229], v[232:233] op_sel:[0,0,0] op_sel_hi:[0,1,1] neg_lo:[1,0,0] neg_hi:[1,0,0]
    v_pk_fma_f32 v[242:243], v[142:143], v[230:231], v[234:235] op_sel:[0,0,0] op_sel_hi:[0,1,1] neg_lo:[1,0,0] neg_hi:[1,0,0]
    v_pk_fma_f32 v[240:241], v[140:141], v[124:125], v[240:241] op_sel:[0,0,0] op_sel_hi:[0,1,1]
    v_pk_fma_f32 v[242:243], v[140:141], v[126:127], v[242:243] op_sel:[0,0,0] op_sel_hi:[0,1,1]
    v_pk_mul_f32 v[240:241], v[240:241], v[242:243]
    v_cvt_pk_bf16_f32 v247, v240, v241
    s_nop 1
    v_permlane32_swap_b32 v244, v246
    v_permlane32_swap_b32 v245, v247
    s_nop 1
    v_permlane16_swap_b32 v244, v245
    v_permlane16_swap_b32 v246, v247
    buffer_store_dwordx4 v[244:247], v5, s[12:15], s73 offen offset:0 sc1
    s_lshr_b32 s10, s68, 1
    s_lshl_b32 s10, s10, 2
    s_add_u32 s10, s10, s4
    s_lshl_b32 s10, s10, 2
    s_lshl_b32 s10, s10, 2
    v_and_b32 v5, 15, v1
    v_add_u32 v5, s10, v5
    v_lshlrev_b32 v5, 7, v5
    v_add_u32 v5, 219136, v5
    s_lshl_b32 s70, s68, 2
    s_mul_i32 s71, s4, 14336
    s_add_u32 s71, s71, 26214400
    s_add_u32 s10, s4, 0
    s_and_b32 s10, s10, 3
    s_add_u32 s11, s10, s70
    s_mul_i32 s11, s11, 57344
    s_add_u32 s11, s11, s71
    v_add_u32 v10, s11, v4
    s_add_u32 s10, s4, 1
    s_and_b32 s10, s10, 3
    s_add_u32 s11, s10, s70
    s_mul_i32 s11, s11, 57344
    s_add_u32 s11, s11, s71
    v_add_u32 v11, s11, v4
    s_mul_i32 s10, s10, 15360
    s_add_u32 s10, s10, 32768
    v_add_u32 v241, s10, v4
    s_add_u32 s10, s4, 2
    s_and_b32 s10, s10, 3
    s_add_u32 s11, s10, s70
    s_mul_i32 s11, s11, 57344
    s_add_u32 s11, s11, s71
    v_add_u32 v12, s11, v4
    s_mul_i32 s10, s10, 15360
    s_add_u32 s10, s10, 37888
    v_add_u32 v242, s10, v4
    s_add_u32 s10, s4, 3
    s_and_b32 s10, s10, 3
    s_add_u32 s11, s10, s70
    s_mul_i32 s11, s11, 57344
    s_add_u32 s11, s11, s71
    v_add_u32 v13, s11, v4
    s_mul_i32 s10, s10, 15360
    s_add_u32 s10, s10, 43008
    v_add_u32 v243, s10, v4
    s_mul_i32 s10, s4, 15360
    s_add_u32 s10, s10, 32768
    v_add_u32 v240, s10, v4
    s_mul_i32 s10, s69, 320
    s_add_u32 s10, s10, 13709824
    v_lshl_add_u32 v6, v2, 5, s10
    v_lshl_add_u32 v7, v2, 4, s10
    v_lshrrev_b32 v8, 2, v3
    v_and_b32 v9, 3, v3
    v_lshlrev_b32 v8, 7, v8
    v_lshl_add_u32 v8, v9, 3, v8
    s_lshl_b32 s10, s4, 5
    v_add_u32 v8, s10, v8
    v_lshl_add_u32 v9, v2, 9, v8
    v_lshl_add_u32 v8, v2, 10, v8
    s_lshl_b32 s10, s68, 6
    s_lshl_b32 s11, s4, 4
    s_add_u32 s10, s10, s11
    v_add_u32 v14, s10, v3
    v_mul_u32_u24 v14, 1280, v14
    s_mul_i32 s10, s69, 160
    v_add_u32 v14, s10, v14
    v_lshl_add_u32 v15, v2, 3, v14
    v_lshl_add_u32 v14, v2, 4, v14
    s_movk_i32 s72, 4096
    s_movk_i32 s73, 8192
    s_movk_i32 s74, 12288
    s_mov_b32 s16, s60
    s_and_b32 s17, s61, 0xffff
    s_mov_b32 s18, 2621440
    s_mov_b32 s19, 0x20000
    s_lshl_b32 s79, s66, 4
    s_add_u32 s79, s79, s67
    s_waitcnt vmcnt(0)
    s_lshl_b32 s79, s79, 2
    s_add_u32 s79, s79, s4
    s_lshl_b32 s10, s79, 7
    s_add_u32 s10, s10, 219136
    v_mov_b32 v252, s8
    v_mov_b32 v253, s9
    s_mov_b64 exec, 1
    buffer_store_dwordx2 v[252:253], off, s[12:15], s10 sc1
    s_mov_b64 exec, -1
    s_barrier
    s_add_u32 s79, s77, 491520
    buffer_load_dwordx4 a[16:19], v4, s[32:35], s79 offen offset:0 sc1
    buffer_load_dwordx4 a[20:23], v4, s[32:35], s79 offen offset:1024 sc1
    buffer_load_dwordx4 a[24:27], v4, s[32:35], s79 offen offset:2048 sc1
    buffer_load_dwordx4 a[28:31], v4, s[32:35], s79 offen offset:3072 sc1
    buffer_load_dwordx4 v[160:163], v202, s[32:35], s79 offen offset:0 sc1
    s_add_u32 s79, s77, 532480
    buffer_load_dwordx4 v[164:167], v4, s[32:35], s79 offen offset:0 sc1
    buffer_load_dwordx4 v[168:171], v4, s[32:35], s79 offen offset:1024 sc1
    buffer_load_dwordx4 v[172:175], v4, s[32:35], s79 offen offset:2048 sc1
    buffer_load_dwordx4 v[176:179], v4, s[32:35], s79 offen offset:3072 sc1
    buffer_load_dwordx4 v[180:183], v202, s[32:35], s79 offen offset:0 sc1
    buffer_load_dwordx2 v[244:245], v5, s[12:15], 0 offen sc1
    s_waitcnt vmcnt(0)
    v_cmp_eq_u64 vcc, s[8:9], v[244:245]
    s_cmp_eq_u64 vcc, exec
    s_cbranch_scc1 L_pok_37
    s_mov_b32 s10, 0
L_plp_38:
    buffer_load_dwordx2 v[244:245], v5, s[12:15], 0 offen sc1
    s_add_u32 s10, s10, 1
    s_waitcnt vmcnt(0)
    v_cmp_eq_u64 vcc, s[8:9], v[244:245]
    s_cmp_eq_u64 vcc, exec
    s_cbranch_scc1 L_pok_37
    s_cmp_lt_u32 s10, 40000
    s_cbranch_scc1 L_plp_38
L_pok_37:
    buffer_load_dwordx4 v[56:59], v11, s[12:15], 0 offen offset:0 sc1
    buffer_load_dwordx4 v[60:63], v11, s[12:15], 0 offen offset:1024 sc1
    buffer_load_dwordx4 v[64:67], v11, s[12:15], 0 offen offset:2048 sc1
    buffer_load_dwordx4 v[68:71], v11, s[12:15], 0 offen offset:3072 sc1
    buffer_load_dwordx4 v[72:75], v11, s[12:15], s72 offen offset:0 sc1
    buffer_load_dwordx4 v[76:79], v11, s[12:15], s72 offen offset:1024 sc1
    buffer_load_dwordx4 v[80:83], v11, s[12:15], s72 offen offset:2048 sc1
    buffer_load_dwordx4 v[84:87], v11, s[12:15], s72 offen offset:3072 sc1
    buffer_load_dwordx4 v[88:91], v11, s[12:15], s73 offen offset:0 sc1
    buffer_load_dwordx4 v[92:95], v11, s[12:15], s73 offen offset:1024 sc1
    buffer_load_dwordx4 v[96:99], v11, s[12:15], s73 offen offset:2048 sc1
    buffer_load_dwordx4 v[100:103], v11, s[12:15], s73 offen offset:3072 sc1
    s_waitcnt vmcnt(11)
    v_mfma_f32_16x16x32_bf16 v[16:19], a[32:35], v[56:59], 0
    buffer_load_dwordx4 v[104:107], v11, s[12:15], s74 offen offset:0 sc1
    v_mfma_f32_16x16x32_bf16 v[20:23], a[36:39], v[56:59], 0
    v_mfma_f32_16x16x32_bf16 v[24:27], a[40:43], v[56:59], 0
    v_mfma_f32_16x16x32_bf16 v[28:31], a[44:47], v[56:59], 0
    v_mfma_f32_16x16x32_bf16 v[32:35], a[48:51], v[56:59], 0
    s_waitcnt vmcnt(11)
    v_mfma_f32_16x16x32_bf16 v[16:19], a[52:55], v[60:63], v[16:19]
    buffer_load_dwordx4 v[108:111], v11, s[12:15], s74 offen offset:1024 sc1
    v_mfma_f32_16x16x32_bf16 v[20:23], a[56:59], v[60:63], v[20:23]
    v_mfma_f32_16x16x32_bf16 v[24:27], a[60:63], v[60:63], v[24:27]
    v_mfma_f32_16x16x32_bf16 v[28:31], a[64:67], v[60:63], v[28:31]
    v_mfma_f32_16x16x32_bf16 v[32:35], a[68:71], v[60:63], v[32:35]
    s_waitcnt vmcnt(11)
    v_mfma_f32_16x16x32_bf16 v[16:19], a[72:75], v[64:67], v[16:19]
    buffer_load_dwordx4 v[112:115], v12, s[12:15], 0 offen offset:0 sc1
    v_mfma_f32_16x16x32_bf16 v[20:23], a[76:79], v[64:67], v[20:23]
    v_mfma_f32_16x16x32_bf16 v[24:27], a[80:83], v[64:67], v[24:27]
    v_mfma_f32_16x16x32_bf16 v[28:31], a[84:87], v[64:67], v[28:31]
    v_mfma_f32_16x16x32_bf16 v[32:35], a[88:91], v[64:67], v[32:35]
    s_waitcnt vmcnt(11)
    v_mfma_f32_16x16x32_bf16 v[16:19], a[92:95], v[68:71], v[16:19]
    buffer_load_dwordx4 v[116:119], v12, s[12:15], 0 offen offset:1024 sc1
    v_mfma_f32_16x16x32_bf16 v[20:23], a[96:99], v[68:71], v[20:23]
    v_mfma_f32_16x16x32_bf16 v[24:27], a[100:103], v[68:71], v[24:27]
    v_mfma_f32_16x16x32_bf16 v[28:31], a[104:107], v[68:71], v[28:31]
    v_mfma_f32_16x16x32_bf16 v[32:35], a[108:111], v[68:71], v[32:35]
    s_waitcnt vmcnt(11)
    v_mfma_f32_16x16x32_bf16 v[16:19], a[112:115], v[72:75], v[16:19]
    buffer_load_dwordx4 v[56:59], v12, s[12:15], 0 offen offset:2048 sc1
    v_mfma_f32_16x16x32_bf16 v[20:23], a[116:119], v[72:75], v[20:23]
    v_mfma_f32_16x16x32_bf16 v[24:27], a[120:123], v[72:75], v[24:27]
    v_mfma_f32_16x16x32_bf16 v[28:31], a[124:127], v[72:75], v[28:31]
    v_mfma_f32_16x16x32_bf16 v[32:35], a[128:131], v[72:75], v[32:35]
    s_waitcnt vmcnt(11)
    v_mfma_f32_16x16x32_bf16 v[16:19], a[132:135], v[76:79], v[16:19]
    buffer_load_dwordx4 v[60:63], v12, s[12:15], 0 offen offset:3072 sc1
    v_mfma_f32_16x16x32_bf16 v[20:23], a[136:139], v[76:79], v[20:23]
    v_mfma_f32_16x16x32_bf16 v[24:27], a[140:143], v[76:79], v[24:27]
    v_mfma_f32_16x16x32_bf16 v[28:31], a[144:147], v[76:79], v[28:31]
    v_mfma_f32_16x16x32_bf16 v[32:35], a[148:151], v[76:79], v[32:35]
    s_waitcnt vmcnt(11)
    v_mfma_f32_16x16x32_bf16 v[16:19], a[152:155], v[80:83], v[16:19]
    buffer_load_dwordx4 v[64:67], v12, s[12:15], s72 offen offset:0 sc1
    v_mfma_f32_16x16x32_bf16 v[20:23], a[156:159], v[80:83], v[20:23]
    v_mfma_f32_16x16x32_bf16 v[24:27], a[160:163], v[80:83], v[24:27]
    v_mfma_f32_16x16x32_bf16 v[28:31], a[164:167], v[80:83], v[28:31]
    v_mfma_f32_16x16x32_bf16 v[32:35], a[168:171], v[80:83], v[32:35]
    s_waitcnt vmcnt(11)
    v_mfma_f32_16x16x32_bf16 v[16:19], a[172:175], v[84:87], v[16:19]
    buffer_load_dwordx4 v[68:71], v12, s[12:15], s72 offen offset:1024 sc1
    v_mfma_f32_16x16x32_bf16 v[20:23], a[176:179], v[84:87], v[20:23]
    v_mfma_f32_16x16x32_bf16 v[24:27], a[180:183], v[84:87], v[24:27]
    v_mfma_f32_16x16x32_bf16 v[28:31], a[184:187], v[84:87], v[28:31]
    v_mfma_f32_16x16x32_bf16 v[32:35], a[188:191], v[84:87], v[32:35]
    s_waitcnt vmcnt(11)
    v_mfma_f32_16x16x32_bf16 v[16:19], a[192:195], v[88:91], v[16:19]
    buffer_load_dwordx4 v[72:75], v12, s[12:15], s72 offen offset:2048 sc1
    v_mfma_f32_16x16x32_bf16 v[20:23], a[196:199], v[88:91], v[20:23]
    v_mfma_f32_16x16x32_bf16 v[24:27], a[200:203], v[88:91], v[24:27]
    v_mfma_f32_16x16x32_bf16 v[28:31], a[204:207], v[88:91], v[28:31]
    v_mfma_f32_16x16x32_bf16 v[32:35], a[208:211], v[88:91], v[32:35]
    s_waitcnt vmcnt(11)
    v_mfma_f32_16x16x32_bf16 v[16:19], a[212:215], v[92:95], v[16:19]
    buffer_load_dwordx4 v[76:79], v12, s[12:15], s72 offen offset:3072 sc1
    v_mfma_f32_16x16x32_bf16 v[20:23], a[216:219], v[92:95], v[20:23]
    v_mfma_f32_16x16x32_bf16 v[24:27], a[220:223], v[92:95], v[24:27]
    v_mfma_f32_16x16x32_bf16 v[28:31], a[224:227], v[92:95], v[28:31]
    v_mfma_f32_16x16x32_bf16 v[32:35], a[228:231], v[92:95], v[32:35]
    s_waitcnt vmcnt(11)
    v_mfma_f32_16x16x32_bf16 v[16:19], a[232:235], v[96:99], v[16:19]
    buffer_load_dwordx4 v[80:83], v12, s[12:15], s73 offen offset:0 sc1
    v_mfma_f32_16x16x32_bf16 v[20:23], a[236:239], v[96:99], v[20:23]
    v_mfma_f32_16x16x32_bf16 v[24:27], a[240:243], v[96:99], v[24:27]
    v_mfma_f32_16x16x32_bf16 v[28:31], a[244:247], v[96:99], v[28:31]
    v_mfma_f32_16x16x32_bf16 v[32:35], a[248:251], v[96:99], v[32:35]
    s_waitcnt vmcnt(11)
    v_mfma_f32_16x16x32_bf16 v[16:19], a[252:255], v[100:103], v[16:19]
    buffer_load_dwordx4 v[84:87], v12, s[12:15], s73 offen offset:1024 sc1
    v_mfma_f32_16x16x32_bf16 v[20:23], a[0:3], v[100:103], v[20:23]
    v_mfma_f32_16x16x32_bf16 v[24:27], a[4:7], v[100:103], v[24:27]
    v_mfma_f32_16x16x32_bf16 v[28:31], a[8:11], v[100:103], v[28:31]
    v_mfma_f32_16x16x32_bf16 v[32:35], a[12:15], v[100:103], v[32:35]
    s_waitcnt vmcnt(11)
    v_mfma_f32_16x16x32_bf16 v[16:19], a[16:19], v[104:107], v[16:19]
    buffer_load_dwordx4 v[88:91], v12, s[12:15], s73 offen offset:2048 sc1
    v_mfma_f32_16x16x32_bf16 v[20:23], a[20:23], v[104:107], v[20:23]
    v_mfma_f32_16x16x32_bf16 v[24:27], a[24:27], v[104:107], v[24:27]
    v_mfma_f32_16x16x32_bf16 v[28:31], a[28:31], v[104:107], v[28:31]
    v_mfma_f32_16x16x32_bf16 v[32:35], v[160:163], v[104:107], v[32:35]
    s_waitcnt vmcnt(11)
    v_mfma_f32_16x16x32_bf16 v[16:19], v[164:167], v[108:111], v[16:19]
    buffer_load_dwordx4 v[92:95], v12, s[12:15], s73 offen offset:3072 sc1
    v_mfma_f32_16x16x32_bf16 v[20:23], v[168:171], v[108:111], v[20:23]
    v_mfma_f32_16x16x32_bf16 v[24:27], v[172:175], v[108:111], v[24:27]
    v_mfma_f32_16x16x32_bf16 v[28:31], v[176:179], v[108:111], v[28:31]
    v_mfma_f32_16x16x32_bf16 v[32:35], v[180:183], v[108:111], v[32:35]
    s_waitcnt vmcnt(11)
    v_mfma_f32_16x16x32_bf16 v[36:39], a[32:35], v[112:115], 0
    buffer_load_dwordx4 v[96:99], v12, s[12:15], s74 offen offset:0 sc1
    v_mfma_f32_16x16x32_bf16 v[40:43], a[36:39], v[112:115], 0
    v_mfma_f32_16x16x32_bf16 v[44:47], a[40:43], v[112:115], 0
    v_mfma_f32_16x16x32_bf16 v[48:51], a[44:47], v[112:115], 0
    v_mfma_f32_16x16x32_bf16 v[52:55], a[48:51], v[112:115], 0
    s_waitcnt vmcnt(11)
    v_mfma_f32_16x16x32_bf16 v[36:39], a[52:55], v[116:119], v[36:39]
    buffer_load_dwordx4 v[100:103], v12, s[12:15], s74 offen offset:1024 sc1
    v_mfma_f32_16x16x32_bf16 v[40:43], a[56:59], v[116:119], v[40:43]
    v_mfma_f32_16x16x32_bf16 v[44:47], a[60:63], v[116:119], v[44:47]
    v_mfma_f32_16x16x32_bf16 v[48:51], a[64:67], v[116:119], v[48:51]
    v_mfma_f32_16x16x32_bf16 v[52:55], a[68:71], v[116:119], v[52:55]
    s_waitcnt vmcnt(11)
    v_mfma_f32_16x16x32_bf16 v[36:39], a[72:75], v[56:59], v[36:39]
    ds_write_b128 v241, v[16:19] offset:0
    buffer_load_dwordx4 v[104:107], v13, s[12:15], 0 offen offset:0 sc1
    v_mfma_f32_16x16x32_bf16 v[40:43], a[76:79], v[56:59], v[40:43]
    v_mfma_f32_16x16x32_bf16 v[44:47], a[80:83], v[56:59], v[44:47]
    v_mfma_f32_16x16x32_bf16 v[48:51], a[84:87], v[56:59], v[48:51]
    ds_write_b128 v241, v[20:23] offset:1024
    v_mfma_f32_16x16x32_bf16 v[52:55], a[88:91], v[56:59], v[52:55]
    s_waitcnt vmcnt(11)
    v_mfma_f32_16x16x32_bf16 v[36:39], a[92:95], v[60:63], v[36:39]
    ds_write_b128 v241, v[24:27] offset:2048
    buffer_load_dwordx4 v[108:111], v13, s[12:15], 0 offen offset:1024 sc1
    v_mfma_f32_16x16x32_bf16 v[40:43], a[96:99], v[60:63], v[40:43]
    v_mfma_f32_16x16x32_bf16 v[44:47], a[100:103], v[60:63], v[44:47]
    v_mfma_f32_16x16x32_bf16 v[48:51], a[104:107], v[60:63], v[48:51]
    ds_write_b128 v241, v[28:31] offset:3072
    v_mfma_f32_16x16x32_bf16 v[52:55], a[108:111], v[60:63], v[52:55]
    s_waitcnt vmcnt(11)
    v_mfma_f32_16x16x32_bf16 v[36:39], a[112:115], v[64:67], v[36:39]
    ds_write_b128 v241, v[32:35] offset:4096
    buffer_load_dwordx4 v[112:115], v13, s[12:15], 0 offen offset:2048 sc1
    v_mfma_f32_16x16x32_bf16 v[40:43], a[116:119], v[64:67], v[40:43]
    v_mfma_f32_16x16x32_bf16 v[44:47], a[120:123], v[64:67], v[44:47]
    v_mfma_f32_16x16x32_bf16 v[48:51], a[124:127], v[64:67], v[48:51]
    v_mfma_f32_16x16x32_bf16 v[52:55], a[128:131], v[64:67], v[52:55]
    s_waitcnt vmcnt(11)
    v_mfma_f32_16x16x32_bf16 v[36:39], a[132:135], v[68:71], v[36:39]
    buffer_load_dwordx4 v[116:119], v13, s[12:15], 0 offen offset:3072 sc1
    v_mfma_f32_16x16x32_bf16 v[40:43], a[136:139], v[68:71], v[40:43]
    v_mfma_f32_16x16x32_bf16 v[44:47], a[140:143], v[68:71], v[44:47]
    v_mfma_f32_16x16x32_bf16 v[48:51], a[144:147], v[68:71], v[48:51]
    v_mfma_f32_16x16x32_bf16 v[52:55], a[148:151], v[68:71], v[52:55]
    s_waitcnt vmcnt(11)
    v_mfma_f32_16x16x32_bf16 v[36:39], a[152:155], v[72:75], v[36:39]
    buffer_load_dwordx4 v[56:59], v13, s[12:15], s72 offen offset:0 sc1
    v_mfma_f32_16x16x32_bf16 v[40:43], a[156:159], v[72:75], v[40:43]
    v_mfma_f32_16x16x32_bf16 v[44:47], a[160:163], v[72:75], v[44:47]
    v_mfma_f32_16x16x32_bf16 v[48:51], a[164:167], v[72:75], v[48:51]
    v_mfma_f32_16x16x32_bf16 v[52:55], a[168:171], v[72:75], v[52:55]
    s_waitcnt vmcnt(11)
    v_mfma_f32_16x16x32_bf16 v[36:39], a[172:175], v[76:79], v[36:39]
    buffer_load_dwordx4 v[60:63], v13, s[12:15], s72 offen offset:1024 sc1
    v_mfma_f32_16x16x32_bf16 v[40:43], a[176:179], v[76:79], v[40:43]
    v_mfma_f32_16x16x32_bf16 v[44:47], a[180:183], v[76:79], v[44:47]
    v_mfma_f32_16x16x32_bf16 v[48:51], a[184:187], v[76:79], v[48:51]
    v_mfma_f32_16x16x32_bf16 v[52:55], a[188:191], v[76:79], v[52:55]
    s_waitcnt vmcnt(11)
    v_mfma_f32_16x16x32_bf16 v[36:39], a[192:195], v[80:83], v[36:39]
    buffer_load_dwordx4 v[64:67], v13, s[12:15], s72 offen offset:2048 sc1
    v_mfma_f32_16x16x32_bf16 v[40:43], a[196:199], v[80:83], v[40:43]
    v_mfma_f32_16x16x32_bf16 v[44:47], a[200:203], v[80:83], v[44:47]
    v_mfma_f32_16x16x32_bf16 v[48:51], a[204:207], v[80:83], v[48:51]
    v_mfma_f32_16x16x32_bf16 v[52:55], a[208:211], v[80:83], v[52:55]
    s_waitcnt vmcnt(11)
    v_mfma_f32_16x16x32_bf16 v[36:39], a[212:215], v[84:87], v[36:39]
    buffer_load_dwordx4 v[68:71], v13, s[12:15], s72 offen offset:3072 sc1
    v_mfma_f32_16x16x32_bf16 v[40:43], a[216:219], v[84:87], v[40:43]
    v_mfma_f32_16x16x32_bf16 v[44:47], a[220:223], v[84:87], v[44:47]
    v_mfma_f32_16x16x32_bf16 v[48:51], a[224:227], v[84:87], v[48:51]
    v_mfma_f32_16x16x32_bf16 v[52:55], a[228:231], v[84:87], v[52:55]
    s_waitcnt vmcnt(11)
    v_mfma_f32_16x16x32_bf16 v[36:39], a[232:235], v[88:91], v[36:39]
    buffer_load_dwordx4 v[72:75], v13, s[12:15], s73 offen offset:0 sc1
    v_mfma_f32_16x16x32_bf16 v[40:43], a[236:239], v[88:91], v[40:43]
    v_mfma_f32_16x16x32_bf16 v[44:47], a[240:243], v[88:91], v[44:47]
    v_mfma_f32_16x16x32_bf16 v[48:51], a[244:247], v[88:91], v[48:51]
    v_mfma_f32_16x16x32_bf16 v[52:55], a[248:251], v[88:91], v[52:55]
    s_waitcnt vmcnt(11)
    v_mfma_f32_16x16x32_bf16 v[36:39], a[252:255], v[92:95], v[36:39]
    buffer_load_dwordx4 v[76:79], v13, s[12:15], s73 offen offset:1024 sc1
    v_mfma_f32_16x16x32_bf16 v[40:43], a[0:3], v[92:95], v[40:43]
    v_mfma_f32_16x16x32_bf16 v[44:47], a[4:7], v[92:95], v[44:47]
    v_mfma_f32_16x16x32_bf16 v[48:51], a[8:11], v[92:95], v[48:51]
    v_mfma_f32_16x16x32_bf16 v[52:55], a[12:15], v[92:95], v[52:55]
    s_waitcnt vmcnt(11)
    v_mfma_f32_16x16x32_bf16 v[36:39], a[16:19], v[96:99], v[36:39]
    buffer_load_dwordx4 v[80:83], v13, s[12:15], s73 offen offset:2048 sc1
    v_mfma_f32_16x16x32_bf16 v[40:43], a[20:23], v[96:99], v[40:43]
    v_mfma_f32_16x16x32_bf16 v[44:47], a[24:27], v[96:99], v[44:47]
    v_mfma_f32_16x16x32_bf16 v[48:51], a[28:31], v[96:99], v[48:51]
    v_mfma_f32_16x16x32_bf16 v[52:55], v[160:163], v[96:99], v[52:55]
    s_waitcnt vmcnt(11)
    v_mfma_f32_16x16x32_bf16 v[36:39], v[164:167], v[100:103], v[36:39]
    buffer_load_dwordx4 v[84:87], v13, s[12:15], s73 offen offset:3072 sc1
    v_mfma_f32_16x16x32_bf16 v[40:43], v[168:171], v[100:103], v[40:43]
    v_mfma_f32_16x16x32_bf16 v[44:47], v[172:175], v[100:103], v[44:47]
    v_mfma_f32_16x16x32_bf16 v[48:51], v[176:179], v[100:103], v[48:51]
    v_mfma_f32_16x16x32_bf16 v[52:55], v[180:183], v[100:103], v[52:55]
    s_waitcnt vmcnt(11)
    v_mfma_f32_16x16x32_bf16 v[16:19], a[32:35], v[104:107], 0
    buffer_load_dwordx4 v[88:91], v13, s[12:15], s74 offen offset:0 sc1
    v_mfma_f32_16x16x32_bf16 v[20:23], a[36:39], v[104:107], 0
    v_mfma_f32_16x16x32_bf16 v[24:27], a[40:43], v[104:107], 0
    v_mfma_f32_16x16x32_bf16 v[28:31], a[44:47], v[104:107], 0
    v_mfma_f32_16x16x32_bf16 v[32:35], a[48:51], v[104:107], 0
    s_waitcnt vmcnt(11)
    v_mfma_f32_16x16x32_bf16 v[16:19], a[52:55], v[108:111], v[16:19]
    buffer_load_dwordx4 v[92:95], v13, s[12:15], s74 offen offset:1024 sc1
    v_mfma_f32_16x16x32_bf16 v[20:23], a[56:59], v[108:111], v[20:23]
    v_mfma_f32_16x16x32_bf16 v[24:27], a[60:63], v[108:111], v[24:27]
    v_mfma_f32_16x16x32_bf16 v[28:31], a[64:67], v[108:111], v[28:31]
    v_mfma_f32_16x16x32_bf16 v[32:35], a[68:71], v[108:111], v[32:35]
    s_waitcnt vmcnt(11)
    v_mfma_f32_16x16x32_bf16 v[16:19], a[72:75], v[112:115], v[16:19]
    ds_write_b128 v242, v[36:39] offset:0
    buffer_load_dwordx4 v[96:99], v10, s[12:15], 0 offen offset:0 sc1
    v_mfma_f32_16x16x32_bf16 v[20:23], a[76:79], v[112:115], v[20:23]
    v_mfma_f32_16x16x32_bf16 v[24:27], a[80:83], v[112:115], v[24:27]
    v_mfma_f32_16x16x32_bf16 v[28:31], a[84:87], v[112:115], v[28:31]
    ds_write_b128 v242, v[40:43] offset:1024
    v_mfma_f32_16x16x32_bf16 v[32:35], a[88:91], v[112:115], v[32:35]
    s_waitcnt vmcnt(11)
    v_mfma_f32_16x16x32_bf16 v[16:19], a[92:95], v[116:119], v[16:19]
    ds_write_b128 v242, v[44:47] offset:2048
    buffer_load_dwordx4 v[100:103], v10, s[12:15], 0 offen offset:1024 sc1
    v_mfma_f32_16x16x32_bf16 v[20:23], a[96:99], v[116:119], v[20:23]
    v_mfma_f32_16x16x32_bf16 v[24:27], a[100:103], v[116:119], v[24:27]
    v_mfma_f32_16x16x32_bf16 v[28:31], a[104:107], v[116:119], v[28:31]
    ds_write_b128 v242, v[48:51] offset:3072
    v_mfma_f32_16x16x32_bf16 v[32:35], a[108:111], v[116:119], v[32:35]
    s_waitcnt vmcnt(11)
    v_mfma_f32_16x16x32_bf16 v[16:19], a[112:115], v[56:59], v[16:19]
    ds_write_b128 v242, v[52:55] offset:4096
    buffer_load_dwordx4 v[104:107], v10, s[12:15], 0 offen offset:2048 sc1
    v_mfma_f32_16x16x32_bf16 v[20:23], a[116:119], v[56:59], v[20:23]
    v_mfma_f32_16x16x32_bf16 v[24:27], a[120:123], v[56:59], v[24:27]
    v_mfma_f32_16x16x32_bf16 v[28:31], a[124:127], v[56:59], v[28:31]
    v_mfma_f32_16x16x32_bf16 v[32:35], a[128:131], v[56:59], v[32:35]
    s_waitcnt vmcnt(11)
    v_mfma_f32_16x16x32_bf16 v[16:19], a[132:135], v[60:63], v[16:19]
    buffer_load_dwordx4 v[108:111], v10, s[12:15], 0 offen offset:3072 sc1
    v_mfma_f32_16x16x32_bf16 v[20:23], a[136:139], v[60:63], v[20:23]
    v_mfma_f32_16x16x32_bf16 v[24:27], a[140:143], v[60:63], v[24:27]
    v_mfma_f32_16x16x32_bf16 v[28:31], a[144:147], v[60:63], v[28:31]
    v_mfma_f32_16x16x32_bf16 v[32:35], a[148:151], v[60:63], v[32:35]
    s_waitcnt vmcnt(11)
    v_mfma_f32_16x16x32_bf16 v[16:19], a[152:155], v[64:67], v[16:19]
    buffer_load_dwordx4 v[112:115], v10, s[12:15], s72 offen offset:0 sc1
    v_mfma_f32_16x16x32_bf16 v[20:23], a[156:159], v[64:67], v[20:23]
    v_mfma_f32_16x16x32_bf16 v[24:27], a[160:163], v[64:67], v[24:27]
    v_mfma_f32_16x16x32_bf16 v[28:31], a[164:167], v[64:67], v[28:31]
    v_mfma_f32_16x16x32_bf16 v[32:35], a[168:171], v[64:67], v[32:35]
    s_waitcnt vmcnt(11)
    v_mfma_f32_16x16x32_bf16 v[16:19], a[172:175], v[68:71], v[16:19]
    buffer_load_dwordx4 v[116:119], v10, s[12:15], s72 offen offset:1024 sc1
    v_mfma_f32_16x16x32_bf16 v[20:23], a[176:179], v[68:71], v[20:23]
    v_mfma_f32_16x16x32_bf16 v[24:27], a[180:183], v[68:71], v[24:27]
    v_mfma_f32_16x16x32_bf16 v[28:31], a[184:187], v[68:71], v[28:31]
    v_mfma_f32_16x16x32_bf16 v[32:35], a[188:191], v[68:71], v[32:35]
    s_waitcnt vmcnt(11)
    v_mfma_f32_16x16x32_bf16 v[16:19], a[192:195], v[72:75], v[16:19]
    buffer_load_dwordx4 v[56:59], v10, s[12:15], s72 offen offset:2048 sc1
    v_mfma_f32_16x16x32_bf16 v[20:23], a[196:199], v[72:75], v[20:23]
    v_mfma_f32_16x16x32_bf16 v[24:27], a[200:203], v[72:75], v[24:27]
    v_mfma_f32_16x16x32_bf16 v[28:31], a[204:207], v[72:75], v[28:31]
    v_mfma_f32_16x16x32_bf16 v[32:35], a[208:211], v[72:75], v[32:35]
    s_waitcnt vmcnt(11)
    v_mfma_f32_16x16x32_bf16 v[16:19], a[212:215], v[76:79], v[16:19]
    buffer_load_dwordx4 v[60:63], v10, s[12:15], s72 offen offset:3072 sc1
    v_mfma_f32_16x16x32_bf16 v[20:23], a[216:219], v[76:79], v[20:23]
    v_mfma_f32_16x16x32_bf16 v[24:27], a[220:223], v[76:79], v[24:27]
    v_mfma_f32_16x16x32_bf16 v[28:31], a[224:227], v[76:79], v[28:31]
    v_mfma_f32_16x16x32_bf16 v[32:35], a[228:231], v[76:79], v[32:35]
    s_waitcnt vmcnt(11)
    v_mfma_f32_16x16x32_bf16 v[16:19], a[232:235], v[80:83], v[16:19]
    buffer_load_dwordx4 v[64:67], v10, s[12:15], s73 offen offset:0 sc1
    v_mfma_f32_16x16x32_bf16 v[20:23], a[236:239], v[80:83], v[20:23]
    v_mfma_f32_16x16x32_bf16 v[24:27], a[240:243], v[80:83], v[24:27]
    v_mfma_f32_16x16x32_bf16 v[28:31], a[244:247], v[80:83], v[28:31]
    v_mfma_f32_16x16x32_bf16 v[32:35], a[248:251], v[80:83], v[32:35]
    s_waitcnt vmcnt(11)
    v_mfma_f32_16x16x32_bf16 v[16:19], a[252:255], v[84:87], v[16:19]
    buffer_load_dwordx4 v[68:71], v10, s[12:15], s73 offen offset:1024 sc1
    v_mfma_f32_16x16x32_bf16 v[20:23], a[0:3], v[84:87], v[20:23]
    v_mfma_f32_16x16x32_bf16 v[24:27], a[4:7], v[84:87], v[24:27]
    v_mfma_f32_16x16x32_bf16 v[28:31], a[8:11], v[84:87], v[28:31]
    v_mfma_f32_16x16x32_bf16 v[32:35], a[12:15], v[84:87], v[32:35]
    s_waitcnt vmcnt(11)
    v_mfma_f32_16x16x32_bf16 v[16:19], a[16:19], v[88:91], v[16:19]
    buffer_load_dwordx4 v[72:75], v10, s[12:15], s73 offen offset:2048 sc1
    v_mfma_f32_16x16x32_bf16 v[20:23], a[20:23], v[88:91], v[20:23]
    v_mfma_f32_16x16x32_bf16 v[24:27], a[24:27], v[88:91], v[24:27]
    v_mfma_f32_16x16x32_bf16 v[28:31], a[28:31], v[88:91], v[28:31]
    v_mfma_f32_16x16x32_bf16 v[32:35], v[160:163], v[88:91], v[32:35]
    s_waitcnt vmcnt(11)
    v_mfma_f32_16x16x32_bf16 v[16:19], v[164:167], v[92:95], v[16:19]
    buffer_load_dwordx4 v[76:79], v10, s[12:15], s73 offen offset:3072 sc1
    v_mfma_f32_16x16x32_bf16 v[20:23], v[168:171], v[92:95], v[20:23]
    v_mfma_f32_16x16x32_bf16 v[24:27], v[172:175], v[92:95], v[24:27]
    v_mfma_f32_16x16x32_bf16 v[28:31], v[176:179], v[92:95], v[28:31]
    v_mfma_f32_16x16x32_bf16 v[32:35], v[180:183], v[92:95], v[32:35]
    s_waitcnt vmcnt(11)
    v_mfma_f32_16x16x32_bf16 v[36:39], a[32:35], v[96:99], 0
    buffer_load_dwordx4 v[80:83], v10, s[12:15], s74 offen offset:0 sc1
    v_mfma_f32_16x16x32_bf16 v[40:43], a[36:39], v[96:99], 0
    v_mfma_f32_16x16x32_bf16 v[44:47], a[40:43], v[96:99], 0
    v_mfma_f32_16x16x32_bf16 v[48:51], a[44:47], v[96:99], 0
    v_mfma_f32_16x16x32_bf16 v[52:55], a[48:51], v[96:99], 0
    s_waitcnt vmcnt(11)
    v_mfma_f32_16x16x32_bf16 v[36:39], a[52:55], v[100:103], v[36:39]
    buffer_load_dwordx4 v[84:87], v10, s[12:15], s74 offen offset:1024 sc1
    v_mfma_f32_16x16x32_bf16 v[40:43], a[56:59], v[100:103], v[40:43]
    v_mfma_f32_16x16x32_bf16 v[44:47], a[60:63], v[100:103], v[44:47]
    v_mfma_f32_16x16x32_bf16 v[48:51], a[64:67], v[100:103], v[48:51]
    v_mfma_f32_16x16x32_bf16 v[52:55], a[68:71], v[100:103], v[52:55]
    s_waitcnt vmcnt(11)
    v_mfma_f32_16x16x32_bf16 v[36:39], a[72:75], v[104:107], v[36:39]
    ds_write_b128 v243, v[16:19] offset:0
    buffer_load_dwordx4 v[220:223], v6, s[12:15], 0 offen offset:0 sc1
    v_mfma_f32_16x16x32_bf16 v[40:43], a[76:79], v[104:107], v[40:43]
    v_mfma_f32_16x16x32_bf16 v[44:47], a[80:83], v[104:107], v[44:47]
    v_mfma_f32_16x16x32_bf16 v[48:51], a[84:87], v[104:107], v[48:51]
    ds_write_b128 v243, v[20:23] offset:1024
    v_mfma_f32_16x16x32_bf16 v[52:55], a[88:91], v[104:107], v[52:55]
    s_waitcnt vmcnt(11)
    v_mfma_f32_16x16x32_bf16 v[36:39], a[92:95], v[108:111], v[36:39]
    ds_write_b128 v243, v[24:27] offset:2048
    buffer_load_dwordx4 v[224:227], v6, s[12:15], 0 offen offset:16 sc1
    v_mfma_f32_16x16x32_bf16 v[40:43], a[96:99], v[108:111], v[40:43]
    v_mfma_f32_16x16x32_bf16 v[44:47], a[100:103], v[108:111], v[44:47]
    v_mfma_f32_16x16x32_bf16 v[48:51], a[104:107], v[108:111], v[48:51]
    ds_write_b128 v243, v[28:31] offset:3072
    v_mfma_f32_16x16x32_bf16 v[52:55], a[108:111], v[108:111], v[52:55]
    s_waitcnt vmcnt(11)
    v_mfma_f32_16x16x32_bf16 v[36:39], a[112:115], v[112:115], v[36:39]
    ds_write_b128 v243, v[32:35] offset:4096
    buffer_load_dwordx4 v[228:231], v6, s[12:15], 0 offen offset:128 sc1
    v_mfma_f32_16x16x32_bf16 v[40:43], a[116:119], v[112:115], v[40:43]
    v_mfma_f32_16x16x32_bf16 v[44:47], a[120:123], v[112:115], v[44:47]
    v_mfma_f32_16x16x32_bf16 v[48:51], a[124:127], v[112:115], v[48:51]
    v_mfma_f32_16x16x32_bf16 v[52:55], a[128:131], v[112:115], v[52:55]
    s_waitcnt vmcnt(11)
    v_mfma_f32_16x16x32_bf16 v[36:39], a[132:135], v[116:119], v[36:39]
    buffer_load_dwordx4 v[232:235], v6, s[12:15], 0 offen offset:144 sc1
    v_mfma_f32_16x16x32_bf16 v[40:43], a[136:139], v[116:119], v[40:43]
    v_mfma_f32_16x16x32_bf16 v[44:47], a[140:143], v[116:119], v[44:47]
    v_mfma_f32_16x16x32_bf16 v[48:51], a[144:147], v[116:119], v[48:51]
    v_mfma_f32_16x16x32_bf16 v[52:55], a[148:151], v[116:119], v[52:55]
    s_waitcnt vmcnt(11)
    s_waitcnt lgkmcnt(0)
    s_barrier
    v_mfma_f32_16x16x32_bf16 v[36:39], a[152:155], v[56:59], v[36:39]
    ds_read_b128 v[120:123], v240 offset:0
    buffer_load_dwordx4 v[236:239], v7, s[12:15], 0 offen offset:256 sc1
    v_mfma_f32_16x16x32_bf16 v[40:43], a[156:159], v[56:59], v[40:43]
    ds_read_b128 v[124:127], v240 offset:1024
    v_mfma_f32_16x16x32_bf16 v[44:47], a[160:163], v[56:59], v[44:47]
    ds_read_b128 v[128:131], v240 offset:2048
    v_mfma_f32_16x16x32_bf16 v[48:51], a[164:167], v[56:59], v[48:51]
    ds_read_b128 v[132:135], v240 offset:3072
    v_mfma_f32_16x16x32_bf16 v[52:55], a[168:171], v[56:59], v[52:55]
    s_waitcnt vmcnt(11)
    v_mfma_f32_16x16x32_bf16 v[36:39], a[172:175], v[60:63], v[36:39]
    ds_read_b128 v[136:139], v240 offset:4096
    v_mfma_f32_16x16x32_bf16 v[40:43], a[176:179], v[60:63], v[40:43]
    ds_read_b128 v[140:143], v240 offset:5120
    v_mfma_f32_16x16x32_bf16 v[44:47], a[180:183], v[60:63], v[44:47]
    ds_read_b128 v[144:147], v240 offset:6144
    v_mfma_f32_16x16x32_bf16 v[48:51], a[184:187], v[60:63], v[48:51]
    ds_read_b128 v[148:151], v240 offset:7168
    v_mfma_f32_16x16x32_bf16 v[52:55], a[188:191], v[60:63], v[52:55]
    s_waitcnt vmcnt(10)
    v_mfma_f32_16x16x32_bf16 v[36:39], a[192:195], v[64:67], v[36:39]
    ds_read_b128 v[152:155], v240 offset:8192
    v_mfma_f32_16x16x32_bf16 v[40:43], a[196:199], v[64:67], v[40:43]
    ds_read_b128 v[156:159], v240 offset:9216
    v_mfma_f32_16x16x32_bf16 v[44:47], a[200:203], v[64:67], v[44:47]
    ds_read_b128 v[184:187], v240 offset:10240
    v_mfma_f32_16x16x32_bf16 v[48:51], a[204:207], v[64:67], v[48:51]
    ds_read_b128 v[188:191], v240 offset:11264
    v_mfma_f32_16x16x32_bf16 v[52:55], a[208:211], v[64:67], v[52:55]
    s_waitcnt vmcnt(9)
    v_mfma_f32_16x16x32_bf16 v[36:39], a[212:215], v[68:71], v[36:39]
    ds_read_b128 v[192:195], v240 offset:12288
    v_mfma_f32_16x16x32_bf16 v[40:43], a[216:219], v[68:71], v[40:43]
    ds_read_b128 v[196:199], v240 offset:13312
    v_mfma_f32_16x16x32_bf16 v[44:47], a[220:223], v[68:71], v[44:47]
    ds_read_b128 v[200:203], v240 offset:14336
    v_mfma_f32_16x16x32_bf16 v[48:51], a[224:227], v[68:71], v[48:51]
    v_mfma_f32_16x16x32_bf16 v[52:55], a[228:231], v[68:71], v[52:55]
    s_waitcnt vmcnt(8)
    v_mfma_f32_16x16x32_bf16 v[36:39], a[232:235], v[72:75], v[36:39]
    ds_read_b64_tr_b16 v[244:245], v8 offset:0
    v_mfma_f32_16x16x32_bf16 v[40:43], a[236:239], v[72:75], v[40:43]
    ds_read_b64_tr_b16 v[246:247], v8 offset:512
    v_mfma_f32_16x16x32_bf16 v[44:47], a[240:243], v[72:75], v[44:47]
    ds_read_b64_tr_b16 v[248:249], v8 offset:4096
    v_mfma_f32_16x16x32_bf16 v[48:51], a[244:247], v[72:75], v[48:51]
    ds_read_b64_tr_b16 v[250:251], v8 offset:4608
    v_mfma_f32_16x16x32_bf16 v[52:55], a[248:251], v[72:75], v[52:55]
    ds_read_b64_tr_b16 v[252:253], v9 offset:8192
    s_waitcnt vmcnt(7)
    s_waitcnt lgkmcnt(5)
    v_mfma_f32_16x16x32_bf16 v[36:39], a[252:255], v[76:79], v[36:39]
    v_add_f32 v120, v120, v140
    v_add_f32 v121, v121, v141
    v_mfma_f32_16x16x32_bf16 v[40:43], a[0:3], v[76:79], v[40:43]
    v_add_f32 v122, v122, v142
    v_add_f32 v123, v123, v143
    v_mfma_f32_16x16x32_bf16 v[44:47], a[4:7], v[76:79], v[44:47]
    v_add_f32 v124, v124, v144
    v_add_f32 v125, v125, v145
    v_mfma_f32_16x16x32_bf16 v[48:51], a[8:11], v[76:79], v[48:51]
    v_add_f32 v126, v126, v146
    v_add_f32 v127, v127, v147
    v_mfma_f32_16x16x32_bf16 v[52:55], a[12:15], v[76:79], v[52:55]
    v_add_f32 v128, v128, v148
    v_add_f32 v129, v129, v149
    s_waitcnt vmcnt(6)
    v_mfma_f32_16x16x32_bf16 v[36:39], a[16:19], v[80:83], v[36:39]
    v_add_f32 v130, v130, v150
    v_add_f32 v131, v131, v151
    v_mfma_f32_16x16x32_bf16 v[40:43], a[20:23], v[80:83], v[40:43]
    v_add_f32 v132, v132, v152
    v_add_f32 v133, v133, v153
    v_mfma_f32_16x16x32_bf16 v[44:47], a[24:27], v[80:83], v[44:47]
    v_add_f32 v134, v134, v154
    v_add_f32 v135, v135, v155
    v_mfma_f32_16x16x32_bf16 v[48:51], a[28:31], v[80:83], v[48:51]
    v_add_f32 v136, v136, v156
    v_add_f32 v137, v137, v157
    v_mfma_f32_16x16x32_bf16 v[52:55], v[160:163], v[80:83], v[52:55]
    v_add_f32 v138, v138, v158
    v_add_f32 v139, v139, v159
    s_waitcnt vmcnt(5)
    v_mfma_f32_16x16x32_bf16 v[36:39], v[164:167], v[84:87], v[36:39]
    v_add_f32 v120, v120, v184
    v_add_f32 v121, v121, v185
    v_mfma_f32_16x16x32_bf16 v[40:43], v[168:171], v[84:87], v[40:43]
    v_add_f32 v122, v122, v186
    v_add_f32 v123, v123, v187
    v_mfma_f32_16x16x32_bf16 v[44:47], v[172:175], v[84:87], v[44:47]
    v_add_f32 v124, v124, v188
    v_add_f32 v125, v125, v189
    v_mfma_f32_16x16x32_bf16 v[48:51], v[176:179], v[84:87], v[48:51]
    v_add_f32 v126, v126, v190
    v_add_f32 v127, v127, v191
    v_mfma_f32_16x16x32_bf16 v[52:55], v[180:183], v[84:87], v[52:55]
    v_add_f32 v128, v128, v192
    v_add_f32 v129, v129, v193
    s_waitcnt vmcnt(0)
    s_waitcnt lgkmcnt(0)
    v_add_f32 v130, v130, v194
    v_add_f32 v131, v131, v195
    v_add_f32 v132, v132, v196
    v_add_f32 v133, v133, v197
    v_add_f32 v134, v134, v198
    v_add_f32 v135, v135, v199
    v_add_f32 v136, v136, v200
    v_add_f32 v137, v137, v201
    v_add_f32 v138, v138, v202
    v_add_f32 v139, v139, v203
    v_lshlrev_b32 v56, 16, v244
    v_and_b32 v57, 0xffff0000, v244
    v_lshlrev_b32 v58, 16, v245
    v_and_b32 v59, 0xffff0000, v245
    v_lshlrev_b32 v60, 16, v246
    v_and_b32 v61, 0xffff0000, v246
    v_lshlrev_b32 v62, 16, v247
    v_and_b32 v63, 0xffff0000, v247
    v_lshlrev_b32 v64, 16, v248
    v_and_b32 v65, 0xffff0000, v248
    v_lshlrev_b32 v66, 16, v249
    v_and_b32 v67, 0xffff0000, v249
    v_lshlrev_b32 v68, 16, v250
    v_and_b32 v69, 0xffff0000, v250
    v_lshlrev_b32 v70, 16, v251
    v_and_b32 v71, 0xffff0000, v251
    v_lshlrev_b32 v72, 16, v252
    v_and_b32 v73, 0xffff0000, v252
    v_lshlrev_b32 v74, 16, v253
    v_and_b32 v75, 0xffff0000, v253
    v_pk_add_f32 v[120:121], v[120:121], v[36:37]
    v_pk_add_f32 v[122:123], v[122:123], v[38:39]
    v_pk_add_f32 v[124:125], v[124:125], v[40:41]
    v_pk_add_f32 v[126:127], v[126:127], v[42:43]
    v_pk_add_f32 v[128:129], v[128:129], v[44:45]
    v_pk_add_f32 v[130:131], v[130:131], v[46:47]
    v_pk_add_f32 v[132:133], v[132:133], v[48:49]
    v_pk_add_f32 v[134:135], v[134:135], v[50:51]
    v_pk_add_f32 v[136:137], v[136:137], v[52:53]
    v_pk_add_f32 v[138:139], v[138:139], v[54:55]
    v_pk_fma_f32 v[120:121], v[120:121], v[220:221], v[56:57]
    v_cvt_pk_bf16_f32 v16, v120, v121
    v_pk_fma_f32 v[122:123], v[122:123], v[222:223], v[58:59]
    v_cvt_pk_bf16_f32 v17, v122, v123
    v_pk_fma_f32 v[124:125], v[124:125], v[224:225], v[60:61]
    v_cvt_pk_bf16_f32 v18, v124, v125
    v_pk_fma_f32 v[126:127], v[126:127], v[226:227], v[62:63]
    v_cvt_pk_bf16_f32 v19, v126, v127
    buffer_store_dwordx4 v[16:19], v14, s[16:19], 0 offen
    v_pk_fma_f32 v[128:129], v[128:129], v[228:229], v[64:65]
    v_cvt_pk_bf16_f32 v20, v128, v129
    v_pk_fma_f32 v[130:131], v[130:131], v[230:231], v[66:67]
    v_cvt_pk_bf16_f32 v21, v130, v131
    v_pk_fma_f32 v[132:133], v[132:133], v[232:233], v[68:69]
    v_cvt_pk_bf16_f32 v22, v132, v133
    v_pk_fma_f32 v[134:135], v[134:135], v[234:235], v[70:71]
    v_cvt_pk_bf16_f32 v23, v134, v135
    buffer_store_dwordx4 v[20:23], v14, s[16:19], 0 offen offset:64
    v_pk_fma_f32 v[136:137], v[136:137], v[236:237], v[72:73]
    v_cvt_pk_bf16_f32 v24, v136, v137
    v_pk_fma_f32 v[138:139], v[138:139], v[238:239], v[74:75]
    v_cvt_pk_bf16_f32 v25, v138, v139
    buffer_store_dwordx2 v[24:25], v15, s[16:19], 0 offen offset:128
L_padz_b1:
L_fin:
L_end:
    s_endpgm
.section .rodata,"a"
.p2align 6
.amdhsa_kernel adaLN_cond__ssm_conv_h3__glu_gated_bilinear__prompt_kernel
  .amdhsa_next_free_vgpr 512
  .amdhsa_next_free_sgpr 102
  .amdhsa_accum_offset 256
  .amdhsa_group_segment_fixed_size 0
  .amdhsa_kernarg_size 120
  .amdhsa_user_sgpr_count 2
  .amdhsa_user_sgpr_kernarg_segment_ptr 1
  .amdhsa_system_sgpr_workgroup_id_x 1
  .amdhsa_float_denorm_mode_32 3
.end_amdhsa_kernel
```
